```python
import torch

def _softmax(x, axis=-1):
    return torch.softmax(x, dim=axis)
def _gelu(x):
    return torch.nn.functional.gelu(x, approximate="tanh")
def _silu(x):
    return torch.nn.functional.silu(x)
def _sigmoid(x):
    return torch.sigmoid(x)
def _layernorm(x, axis=-1, eps=1e-5):
    m = x.mean(dim=axis, keepdim=True)
    v = x.var(dim=axis, keepdim=True, unbiased=False)
    return (x - m) / torch.sqrt(v + eps)
def _scatter_add(tgt, idx, src, axis=0):
    return tgt.clone().index_add_(axis, idx, src)
def _segment_sum(src, seg, n):
    out = torch.zeros((n,) + src.shape[1:], dtype=src.dtype)
    return out.index_add_(0, seg, src)
def _pad(x, pw):
    flat = tuple(v for pair in reversed(pw) for v in pair)
    return torch.nn.functional.pad(x, flat)

kernel_name = 'sequential_preLN__spectral_gfnet__dense_activation_gelu__prompt'

def setup_inputs():

    _w = (lambda a: (lambda t: t.to(torch.bfloat16) if t.is_floating_point() else t)(torch.as_tensor(a)))
    def _A_setup():
        B, S, D = 1, 2048, 576
        Df = D // 2 + 1
        return {
            "x": _w((lambda *s: torch.randn(*s, dtype=torch.bfloat16) * 0.05)(B, S, D)),
            "w_r": _w((lambda *s: torch.randn(*s, dtype=torch.bfloat16) * 0.8)(S, Df) * 0.02),
            "w_i": _w((lambda *s: torch.randn(*s, dtype=torch.bfloat16) * 0.8)(S, Df) * 0.02),
        }
    _A_in = _A_setup()

    def _B_setup():
        B, S, D, F = 1, 2048, 576, 4608
        return {
            "x": _w((lambda *s: torch.randn(*s, dtype=torch.bfloat16) * 0.05)(B, S, D)),
            "w1": _w((lambda *s: torch.randn(*s, dtype=torch.bfloat16) * 0.8)(D, F) * (D ** -0.5)),
            "b1": _w((lambda *s: torch.randn(*s, dtype=torch.bfloat16) * 12.8)(F) * 0.01),
            "w2": _w((lambda *s: torch.randn(*s, dtype=torch.bfloat16) * 0.2)(F, D) * (F ** -0.5)),
            "b2": _w((lambda *s: torch.randn(*s, dtype=torch.bfloat16) * 3.2)(D) * 0.01),
        }
    _B_in = _B_setup()

    return {
        "A_x": _A_in["x"],
        "A_w_r": _A_in["w_r"],
        "A_w_i": _A_in["w_i"],
        "B_x": _B_in["x"],
        "B_w1": _B_in["w1"],
        "B_b1": _B_in["b1"],
        "B_w2": _B_in["w2"],
        "B_b2": _B_in["b2"],
    }

def reference(A_x, A_w_r, A_w_i, B_x, B_w1, B_b1, B_w2, B_b2):
    def _A_ref(x, w_r, w_i):
        B, S, D = x.shape
        X = (lambda x, axes=(-2,-1): torch.fft.rfft2(x.float(), dim=axes))(x, axes=(-2, -1))
        W = w_r + 1j * w_i
        X = X * W
        y = (lambda x, s, axes=(-2,-1): torch.fft.irfft2(x, s=s, dim=axes).to(torch.bfloat16))(X, (S, D), axes=(-2, -1))
        return y

    def _B_ref(x, w1, b1, w2, b2):
        h = torch.einsum("bsd,df->bsf", x, w1) + b1
        h = _gelu(h)
        return torch.einsum("bsf,fd->bsd", h, w2) + b2

    x = A_x
    h = x + _A_ref(_layernorm(x, axis=-1), A_w_r, A_w_i)
    h2 = h + _B_ref(_layernorm(h, axis=-1), B_w1, B_b1, B_w2, B_b2)
    return h2
```

```asm
; @launch kernel=k1_kernel grid=(482,1,1) block=(256,1,1) lds=37888
; @launch kernel=k2_kernel grid=(432,1,1) block=(256,1,1) lds=36864
; @launch kernel=k3_kernel grid=(192,1,1) block=(256,1,1) lds=73728
; @launch kernel=k4_kernel grid=(256,1,1) block=(256,1,1) lds=147968
.amdgcn_target "amdgcn-amd-amdhsa--gfx950"
.text
.globl k1_kernel
.p2align 8
.type k1_kernel,@function
k1_kernel:
  s_cmp_ge_u32 s2, 482
  s_cbranch_scc1 k1_kernel_end
  s_add_u32 s58, s2, 256
  s_sub_u32 s59, s2, 226
  s_cmp_lt_u32 s2, 226
  s_cselect_b32 s2, s58, s59
  s_load_dwordx2 s[4:5], s[0:1], 80
  s_load_dwordx2 s[6:7], s[0:1], 0
  s_load_dwordx4 s[36:39], s[0:1], 8
  s_load_dwordx2 s[44:45], s[0:1], 32
  s_load_dwordx2 s[46:47], s[0:1], 48
  s_load_dwordx2 s[56:57], s[0:1], 48
  v_and_b32 v1, 63, v0
  s_getpc_b64 s[40:41]
k1_kernel_pc0:
  s_sub_u32 s40, s40, k1_kernel_pc0 - k1_kernel
  s_subb_u32 s41, s41, 0
  v_lshlrev_b32 v213, 7, v1
  global_load_dword v212, v213, s[40:41]
  v_add_u32 v213, 0x2000, v213
  global_load_dword v212, v213, s[40:41]
  v_lshrrev_b32 v2, 6, v0
  s_nop 0
  v_readfirstlane_b32 s18, v2
  s_cmp_ge_u32 s2, 256
  s_cbranch_scc1 k1_kernel_wt
  s_setprio 3
  s_and_b32 s16, s2, 7
  s_lshr_b32 s17, s2, 3
  s_and_b32 s19, s17, 3
  s_lshr_b32 s17, s17, 2
  s_lshl_b32 s17, s17, 3
  s_add_u32 s17, s17, s16
  v_and_b32 v2, 15, v1
  v_lshrrev_b32 v3, 4, v1
  v_lshrrev_b32 v22, 1, v2
  v_xor_b32 v22, v3, v22
  v_lshlrev_b32 v22, 4, v22
  v_lshl_add_u32 v4, v2, 7, v22
  v_xor_b32 v5, 64, v4
  v_lshrrev_b32 v22, 3, v1
  s_lshl_b32 s20, s18, 3
  v_add_u32 v22, s20, v22
  s_movk_i32 s21, 1152
  v_mul_lo_u32 v22, v22, s21
  s_lshl_b32 s20, s18, 2
  v_add_u32 v23, s20, v3
  v_and_b32 v23, 7, v23
  v_and_b32 v6, 7, v1
  v_xor_b32 v6, v6, v23
  v_lshl_add_u32 v6, v6, 4, v22
  s_waitcnt lgkmcnt(0)
  s_mov_b32 s8, s4
  s_mov_b32 s9, s5
  s_mov_b32 s10, 0x10000000
  s_mov_b32 s11, 0x20000
  s_mov_b32 s12, s6
  s_mov_b32 s13, s7
  s_mov_b32 s14, 2359296
  s_mov_b32 s15, 0x20000
  s_mul_i32 s23, s17, 36864
  s_lshl_b32 s24, s18, 10
  s_add_u32 m0, s24, 0
  s_nop 0
  buffer_load_dwordx4 v6, s[12:15], s23 offen lds
  s_add_u32 m0, s24, 4096
  s_add_u32 s23, s23, 128
  buffer_load_dwordx4 v6, s[12:15], s23 offen lds
  s_add_u32 m0, s24, 8192
  s_add_u32 s23, s23, 128
  buffer_load_dwordx4 v6, s[12:15], s23 offen lds
  s_add_u32 m0, s24, 12288
  s_add_u32 s23, s23, 128
  buffer_load_dwordx4 v6, s[12:15], s23 offen lds
  s_add_u32 m0, s24, 16384
  s_add_u32 s23, s23, 128
  buffer_load_dwordx4 v6, s[12:15], s23 offen lds
  s_add_u32 m0, s24, 20480
  s_add_u32 s23, s23, 128
  buffer_load_dwordx4 v6, s[12:15], s23 offen lds
  s_add_u32 m0, s24, 24576
  s_add_u32 s23, s23, 128
  buffer_load_dwordx4 v6, s[12:15], s23 offen lds
  s_add_u32 m0, s24, 28672
  s_add_u32 s23, s23, 128
  buffer_load_dwordx4 v6, s[12:15], s23 offen lds
  s_add_u32 m0, s24, 32768
  s_add_u32 s23, s23, 128
  buffer_load_dwordx4 v6, s[12:15], s23 offen lds
  s_cmp_eq_u32 s18, 3
  s_cbranch_scc1 k1_kernel_stats
  s_mul_i32 s20, s19, 144
  s_mul_i32 s21, s18, 48
  s_add_u32 s20, s20, s21
  v_add_u32 v22, s20, v2
  v_lshlrev_b32 v19, 12, v22
  v_lshrrev_b32 v23, 1, v22
  v_and_b32 v22, 1, v22
  v_and_b32 v7, 1, v23
  v_lshlrev_b32 v7, 31, v7
  v_or_b32 v7, 1.0, v7
  v_cmp_eq_u32 vcc, 0, v23
  v_mov_b32 v10, 0x120
  v_cvt_f32_u32 v22, v22
  v_cndmask_b32 v23, v23, v10, vcc
  v_cvt_f32_u32 v23, v23
  v_mul_f32 v10, 0x3ae38e39, v23
  v_cvt_f32_u32 v23, v3
  v_mul_f32 v23, 0x41000000, v23
  v_mul_f32 v22, 0x3e800000, v22
  v_fma_f32 v13, v10, v23, v22
  v_mul_f32 v22, 0x42000000, v10
  v_fract_f32 v22, v22
  v_cos_f32 v22, v22
  s_nop 0
  v_add_f32 v16, v22, v22
  v_add_u32 v22, s20, v2
  v_add_u32 v22, 16, v22
  v_lshlrev_b32 v20, 12, v22
  v_lshrrev_b32 v23, 1, v22
  v_and_b32 v22, 1, v22
  v_and_b32 v8, 1, v23
  v_lshlrev_b32 v8, 31, v8
  v_or_b32 v8, 1.0, v8
  v_cmp_eq_u32 vcc, 0, v23
  v_mov_b32 v11, 0x120
  v_cvt_f32_u32 v22, v22
  v_cndmask_b32 v23, v23, v11, vcc
  v_cvt_f32_u32 v23, v23
  v_mul_f32 v11, 0x3ae38e39, v23
  v_cvt_f32_u32 v23, v3
  v_mul_f32 v23, 0x41000000, v23
  v_mul_f32 v22, 0x3e800000, v22
  v_fma_f32 v14, v11, v23, v22
  v_mul_f32 v22, 0x42000000, v11
  v_fract_f32 v22, v22
  v_cos_f32 v22, v22
  s_nop 0
  v_add_f32 v17, v22, v22
  v_add_u32 v22, s20, v2
  v_add_u32 v22, 32, v22
  v_lshlrev_b32 v21, 12, v22
  v_lshrrev_b32 v23, 1, v22
  v_and_b32 v22, 1, v22
  v_and_b32 v9, 1, v23
  v_lshlrev_b32 v9, 31, v9
  v_or_b32 v9, 1.0, v9
  v_cmp_eq_u32 vcc, 0, v23
  v_mov_b32 v12, 0x120
  v_cvt_f32_u32 v22, v22
  v_cndmask_b32 v23, v23, v12, vcc
  v_cvt_f32_u32 v23, v23
  v_mul_f32 v12, 0x3ae38e39, v23
  v_cvt_f32_u32 v23, v3
  v_mul_f32 v23, 0x41000000, v23
  v_mul_f32 v22, 0x3e800000, v22
  v_fma_f32 v15, v12, v23, v22
  v_mul_f32 v22, 0x42000000, v12
  v_fract_f32 v22, v22
  v_cos_f32 v22, v22
  s_nop 0
  v_add_f32 v18, v22, v22
  s_lshl_b32 s21, s17, 6
  v_lshlrev_b32 v22, 3, v3
  v_add_u32 v22, s21, v22
  v_add_u32 v19, v19, v22
  v_add_u32 v20, v20, v22
  v_add_u32 v21, v21, v22
  v_cos_f32 v24, v13
  v_fmamk_f32 v25, v10, 0x3f800000, v13
  v_fmamk_f32 v26, v10, 0x40000000, v13
  v_fmamk_f32 v27, v10, 0x40400000, v13
  v_fmamk_f32 v28, v10, 0x40800000, v13
  v_fmamk_f32 v29, v10, 0x40a00000, v13
  v_fmamk_f32 v30, v10, 0x40c00000, v13
  v_fmamk_f32 v31, v10, 0x40e00000, v13
  v_cos_f32 v25, v25
  v_cos_f32 v26, v26
  v_cos_f32 v27, v27
  v_cos_f32 v28, v28
  v_cos_f32 v29, v29
  v_cos_f32 v30, v30
  v_cos_f32 v31, v31
  v_cos_f32 v32, v14
  v_fmamk_f32 v33, v11, 0x3f800000, v14
  v_fmamk_f32 v34, v11, 0x40000000, v14
  v_fmamk_f32 v35, v11, 0x40400000, v14
  v_fmamk_f32 v36, v11, 0x40800000, v14
  v_fmamk_f32 v37, v11, 0x40a00000, v14
  v_fmamk_f32 v38, v11, 0x40c00000, v14
  v_fmamk_f32 v39, v11, 0x40e00000, v14
  v_cos_f32 v33, v33
  v_cos_f32 v34, v34
  v_cos_f32 v35, v35
  v_cos_f32 v36, v36
  v_cos_f32 v37, v37
  v_cos_f32 v38, v38
  v_cos_f32 v39, v39
  v_cos_f32 v40, v15
  v_fmamk_f32 v41, v12, 0x3f800000, v15
  v_fmamk_f32 v42, v12, 0x40000000, v15
  v_fmamk_f32 v43, v12, 0x40400000, v15
  v_fmamk_f32 v44, v12, 0x40800000, v15
  v_fmamk_f32 v45, v12, 0x40a00000, v15
  v_fmamk_f32 v46, v12, 0x40c00000, v15
  v_fmamk_f32 v47, v12, 0x40e00000, v15
  v_cos_f32 v41, v41
  v_cos_f32 v42, v42
  v_cos_f32 v43, v43
  v_cos_f32 v44, v44
  v_cos_f32 v45, v45
  v_cos_f32 v46, v46
  v_cos_f32 v47, v47
  s_nop 0
  v_cvt_pk_bf16_f32 v72, v24, v25
  v_cvt_pk_bf16_f32 v73, v26, v27
  v_cvt_pk_bf16_f32 v74, v28, v29
  v_cvt_pk_bf16_f32 v75, v30, v31
  v_cvt_pk_bf16_f32 v76, v32, v33
  v_cvt_pk_bf16_f32 v77, v34, v35
  v_cvt_pk_bf16_f32 v78, v36, v37
  v_cvt_pk_bf16_f32 v79, v38, v39
  v_cvt_pk_bf16_f32 v80, v40, v41
  v_cvt_pk_bf16_f32 v81, v42, v43
  v_cvt_pk_bf16_f32 v82, v44, v45
  v_cvt_pk_bf16_f32 v83, v46, v47
  v_fmamk_f32 v48, v10, 0x42000000, v13
  v_fmamk_f32 v49, v10, 0x42040000, v13
  v_fmamk_f32 v50, v10, 0x42080000, v13
  v_fmamk_f32 v51, v10, 0x420c0000, v13
  v_fmamk_f32 v52, v10, 0x42100000, v13
  v_fmamk_f32 v53, v10, 0x42140000, v13
  v_fmamk_f32 v54, v10, 0x42180000, v13
  v_fmamk_f32 v55, v10, 0x421c0000, v13
  v_cos_f32 v48, v48
  v_cos_f32 v49, v49
  v_cos_f32 v50, v50
  v_cos_f32 v51, v51
  v_cos_f32 v52, v52
  v_cos_f32 v53, v53
  v_cos_f32 v54, v54
  v_cos_f32 v55, v55
  v_fmamk_f32 v56, v11, 0x42000000, v14
  v_fmamk_f32 v57, v11, 0x42040000, v14
  v_fmamk_f32 v58, v11, 0x42080000, v14
  v_fmamk_f32 v59, v11, 0x420c0000, v14
  v_fmamk_f32 v60, v11, 0x42100000, v14
  v_fmamk_f32 v61, v11, 0x42140000, v14
  v_fmamk_f32 v62, v11, 0x42180000, v14
  v_fmamk_f32 v63, v11, 0x421c0000, v14
  v_cos_f32 v56, v56
  v_cos_f32 v57, v57
  v_cos_f32 v58, v58
  v_cos_f32 v59, v59
  v_cos_f32 v60, v60
  v_cos_f32 v61, v61
  v_cos_f32 v62, v62
  v_cos_f32 v63, v63
  v_fmamk_f32 v64, v12, 0x42000000, v15
  v_fmamk_f32 v65, v12, 0x42040000, v15
  v_fmamk_f32 v66, v12, 0x42080000, v15
  v_fmamk_f32 v67, v12, 0x420c0000, v15
  v_fmamk_f32 v68, v12, 0x42100000, v15
  v_fmamk_f32 v69, v12, 0x42140000, v15
  v_fmamk_f32 v70, v12, 0x42180000, v15
  v_fmamk_f32 v71, v12, 0x421c0000, v15
  v_cos_f32 v64, v64
  v_cos_f32 v65, v65
  v_cos_f32 v66, v66
  v_cos_f32 v67, v67
  v_cos_f32 v68, v68
  v_cos_f32 v69, v69
  v_cos_f32 v70, v70
  v_cos_f32 v71, v71
  s_nop 0
  v_cvt_pk_bf16_f32 v84, v48, v49
  v_cvt_pk_bf16_f32 v85, v50, v51
  v_cvt_pk_bf16_f32 v86, v52, v53
  v_cvt_pk_bf16_f32 v87, v54, v55
  v_cvt_pk_bf16_f32 v88, v56, v57
  v_cvt_pk_bf16_f32 v89, v58, v59
  v_cvt_pk_bf16_f32 v90, v60, v61
  v_cvt_pk_bf16_f32 v91, v62, v63
  v_cvt_pk_bf16_f32 v92, v64, v65
  v_cvt_pk_bf16_f32 v93, v66, v67
  v_cvt_pk_bf16_f32 v94, v68, v69
  v_cvt_pk_bf16_f32 v95, v70, v71
  v_fma_f32 v24, v16, v48, -v24
  v_fma_f32 v25, v16, v49, -v25
  v_fma_f32 v26, v16, v50, -v26
  v_fma_f32 v27, v16, v51, -v27
  v_fma_f32 v28, v16, v52, -v28
  v_fma_f32 v29, v16, v53, -v29
  v_fma_f32 v30, v16, v54, -v30
  v_fma_f32 v31, v16, v55, -v31
  v_fma_f32 v32, v17, v56, -v32
  v_fma_f32 v33, v17, v57, -v33
  v_fma_f32 v34, v17, v58, -v34
  v_fma_f32 v35, v17, v59, -v35
  v_fma_f32 v36, v17, v60, -v36
  v_fma_f32 v37, v17, v61, -v37
  v_fma_f32 v38, v17, v62, -v38
  v_fma_f32 v39, v17, v63, -v39
  v_fma_f32 v40, v18, v64, -v40
  v_fma_f32 v41, v18, v65, -v41
  v_fma_f32 v42, v18, v66, -v42
  v_fma_f32 v43, v18, v67, -v43
  v_fma_f32 v44, v18, v68, -v44
  v_fma_f32 v45, v18, v69, -v45
  v_fma_f32 v46, v18, v70, -v46
  v_fma_f32 v47, v18, v71, -v47
  v_cvt_pk_bf16_f32 v96, v24, v25
  v_cvt_pk_bf16_f32 v97, v26, v27
  v_cvt_pk_bf16_f32 v98, v28, v29
  v_cvt_pk_bf16_f32 v99, v30, v31
  v_cvt_pk_bf16_f32 v100, v32, v33
  v_cvt_pk_bf16_f32 v101, v34, v35
  v_cvt_pk_bf16_f32 v102, v36, v37
  v_cvt_pk_bf16_f32 v103, v38, v39
  v_cvt_pk_bf16_f32 v104, v40, v41
  v_cvt_pk_bf16_f32 v105, v42, v43
  v_cvt_pk_bf16_f32 v106, v44, v45
  v_cvt_pk_bf16_f32 v107, v46, v47
  v_fma_f32 v48, v16, v24, -v48
  v_fma_f32 v49, v16, v25, -v49
  v_fma_f32 v50, v16, v26, -v50
  v_fma_f32 v51, v16, v27, -v51
  v_fma_f32 v52, v16, v28, -v52
  v_fma_f32 v53, v16, v29, -v53
  v_fma_f32 v54, v16, v30, -v54
  v_fma_f32 v55, v16, v31, -v55
  v_fma_f32 v56, v17, v32, -v56
  v_fma_f32 v57, v17, v33, -v57
  v_fma_f32 v58, v17, v34, -v58
  v_fma_f32 v59, v17, v35, -v59
  v_fma_f32 v60, v17, v36, -v60
  v_fma_f32 v61, v17, v37, -v61
  v_fma_f32 v62, v17, v38, -v62
  v_fma_f32 v63, v17, v39, -v63
  v_fma_f32 v64, v18, v40, -v64
  v_fma_f32 v65, v18, v41, -v65
  v_fma_f32 v66, v18, v42, -v66
  v_fma_f32 v67, v18, v43, -v67
  v_fma_f32 v68, v18, v44, -v68
  v_fma_f32 v69, v18, v45, -v69
  v_fma_f32 v70, v18, v46, -v70
  v_fma_f32 v71, v18, v47, -v71
  v_cvt_pk_bf16_f32 v108, v48, v49
  v_cvt_pk_bf16_f32 v109, v50, v51
  v_cvt_pk_bf16_f32 v110, v52, v53
  v_cvt_pk_bf16_f32 v111, v54, v55
  v_cvt_pk_bf16_f32 v112, v56, v57
  v_cvt_pk_bf16_f32 v113, v58, v59
  v_cvt_pk_bf16_f32 v114, v60, v61
  v_cvt_pk_bf16_f32 v115, v62, v63
  v_cvt_pk_bf16_f32 v116, v64, v65
  v_cvt_pk_bf16_f32 v117, v66, v67
  v_cvt_pk_bf16_f32 v118, v68, v69
  v_cvt_pk_bf16_f32 v119, v70, v71
  v_fma_f32 v24, v16, v48, -v24
  v_fma_f32 v25, v16, v49, -v25
  v_fma_f32 v26, v16, v50, -v26
  v_fma_f32 v27, v16, v51, -v27
  v_fma_f32 v28, v16, v52, -v28
  v_fma_f32 v29, v16, v53, -v29
  v_fma_f32 v30, v16, v54, -v30
  v_fma_f32 v31, v16, v55, -v31
  v_fma_f32 v32, v17, v56, -v32
  v_fma_f32 v33, v17, v57, -v33
  v_fma_f32 v34, v17, v58, -v34
  v_fma_f32 v35, v17, v59, -v35
  v_fma_f32 v36, v17, v60, -v36
  v_fma_f32 v37, v17, v61, -v37
  v_fma_f32 v38, v17, v62, -v38
  v_fma_f32 v39, v17, v63, -v39
  v_fma_f32 v40, v18, v64, -v40
  v_fma_f32 v41, v18, v65, -v41
  v_fma_f32 v42, v18, v66, -v42
  v_fma_f32 v43, v18, v67, -v43
  v_fma_f32 v44, v18, v68, -v44
  v_fma_f32 v45, v18, v69, -v45
  v_fma_f32 v46, v18, v70, -v46
  v_fma_f32 v47, v18, v71, -v47
  v_cvt_pk_bf16_f32 v120, v24, v25
  v_cvt_pk_bf16_f32 v121, v26, v27
  v_cvt_pk_bf16_f32 v122, v28, v29
  v_cvt_pk_bf16_f32 v123, v30, v31
  v_cvt_pk_bf16_f32 v124, v32, v33
  v_cvt_pk_bf16_f32 v125, v34, v35
  v_cvt_pk_bf16_f32 v126, v36, v37
  v_cvt_pk_bf16_f32 v127, v38, v39
  v_cvt_pk_bf16_f32 v128, v40, v41
  v_cvt_pk_bf16_f32 v129, v42, v43
  v_cvt_pk_bf16_f32 v130, v44, v45
  v_cvt_pk_bf16_f32 v131, v46, v47
  v_fma_f32 v48, v16, v24, -v48
  v_fma_f32 v49, v16, v25, -v49
  v_fma_f32 v50, v16, v26, -v50
  v_fma_f32 v51, v16, v27, -v51
  v_fma_f32 v52, v16, v28, -v52
  v_fma_f32 v53, v16, v29, -v53
  v_fma_f32 v54, v16, v30, -v54
  v_fma_f32 v55, v16, v31, -v55
  v_fma_f32 v56, v17, v32, -v56
  v_fma_f32 v57, v17, v33, -v57
  v_fma_f32 v58, v17, v34, -v58
  v_fma_f32 v59, v17, v35, -v59
  v_fma_f32 v60, v17, v36, -v60
  v_fma_f32 v61, v17, v37, -v61
  v_fma_f32 v62, v17, v38, -v62
  v_fma_f32 v63, v17, v39, -v63
  v_fma_f32 v64, v18, v40, -v64
  v_fma_f32 v65, v18, v41, -v65
  v_fma_f32 v66, v18, v42, -v66
  v_fma_f32 v67, v18, v43, -v67
  v_fma_f32 v68, v18, v44, -v68
  v_fma_f32 v69, v18, v45, -v69
  v_fma_f32 v70, v18, v46, -v70
  v_fma_f32 v71, v18, v47, -v71
  v_cvt_pk_bf16_f32 v132, v48, v49
  v_cvt_pk_bf16_f32 v133, v50, v51
  v_cvt_pk_bf16_f32 v134, v52, v53
  v_cvt_pk_bf16_f32 v135, v54, v55
  v_cvt_pk_bf16_f32 v136, v56, v57
  v_cvt_pk_bf16_f32 v137, v58, v59
  v_cvt_pk_bf16_f32 v138, v60, v61
  v_cvt_pk_bf16_f32 v139, v62, v63
  v_cvt_pk_bf16_f32 v140, v64, v65
  v_cvt_pk_bf16_f32 v141, v66, v67
  v_cvt_pk_bf16_f32 v142, v68, v69
  v_cvt_pk_bf16_f32 v143, v70, v71
  v_fma_f32 v24, v16, v48, -v24
  v_fma_f32 v25, v16, v49, -v25
  v_fma_f32 v26, v16, v50, -v26
  v_fma_f32 v27, v16, v51, -v27
  v_fma_f32 v28, v16, v52, -v28
  v_fma_f32 v29, v16, v53, -v29
  v_fma_f32 v30, v16, v54, -v30
  v_fma_f32 v31, v16, v55, -v31
  v_fma_f32 v32, v17, v56, -v32
  v_fma_f32 v33, v17, v57, -v33
  v_fma_f32 v34, v17, v58, -v34
  v_fma_f32 v35, v17, v59, -v35
  v_fma_f32 v36, v17, v60, -v36
  v_fma_f32 v37, v17, v61, -v37
  v_fma_f32 v38, v17, v62, -v38
  v_fma_f32 v39, v17, v63, -v39
  v_fma_f32 v40, v18, v64, -v40
  v_fma_f32 v41, v18, v65, -v41
  v_fma_f32 v42, v18, v66, -v42
  v_fma_f32 v43, v18, v67, -v43
  v_fma_f32 v44, v18, v68, -v44
  v_fma_f32 v45, v18, v69, -v45
  v_fma_f32 v46, v18, v70, -v46
  v_fma_f32 v47, v18, v71, -v47
  v_cvt_pk_bf16_f32 v144, v24, v25
  v_cvt_pk_bf16_f32 v145, v26, v27
  v_cvt_pk_bf16_f32 v146, v28, v29
  v_cvt_pk_bf16_f32 v147, v30, v31
  v_cvt_pk_bf16_f32 v148, v32, v33
  v_cvt_pk_bf16_f32 v149, v34, v35
  v_cvt_pk_bf16_f32 v150, v36, v37
  v_cvt_pk_bf16_f32 v151, v38, v39
  v_cvt_pk_bf16_f32 v152, v40, v41
  v_cvt_pk_bf16_f32 v153, v42, v43
  v_cvt_pk_bf16_f32 v154, v44, v45
  v_cvt_pk_bf16_f32 v155, v46, v47
  v_fma_f32 v48, v16, v24, -v48
  v_fma_f32 v49, v16, v25, -v49
  v_fma_f32 v50, v16, v26, -v50
  v_fma_f32 v51, v16, v27, -v51
  v_fma_f32 v52, v16, v28, -v52
  v_fma_f32 v53, v16, v29, -v53
  v_fma_f32 v54, v16, v30, -v54
  v_fma_f32 v55, v16, v31, -v55
  v_fma_f32 v56, v17, v32, -v56
  v_fma_f32 v57, v17, v33, -v57
  v_fma_f32 v58, v17, v34, -v58
  v_fma_f32 v59, v17, v35, -v59
  v_fma_f32 v60, v17, v36, -v60
  v_fma_f32 v61, v17, v37, -v61
  v_fma_f32 v62, v17, v38, -v62
  v_fma_f32 v63, v17, v39, -v63
  v_fma_f32 v64, v18, v40, -v64
  v_fma_f32 v65, v18, v41, -v65
  v_fma_f32 v66, v18, v42, -v66
  v_fma_f32 v67, v18, v43, -v67
  v_fma_f32 v68, v18, v44, -v68
  v_fma_f32 v69, v18, v45, -v69
  v_fma_f32 v70, v18, v46, -v70
  v_fma_f32 v71, v18, v47, -v71
  v_cvt_pk_bf16_f32 v156, v48, v49
  v_cvt_pk_bf16_f32 v157, v50, v51
  v_cvt_pk_bf16_f32 v158, v52, v53
  v_cvt_pk_bf16_f32 v159, v54, v55
  v_cvt_pk_bf16_f32 v160, v56, v57
  v_cvt_pk_bf16_f32 v161, v58, v59
  v_cvt_pk_bf16_f32 v162, v60, v61
  v_cvt_pk_bf16_f32 v163, v62, v63
  v_cvt_pk_bf16_f32 v164, v64, v65
  v_cvt_pk_bf16_f32 v165, v66, v67
  v_cvt_pk_bf16_f32 v166, v68, v69
  v_cvt_pk_bf16_f32 v167, v70, v71
  v_fma_f32 v24, v16, v48, -v24
  v_fma_f32 v25, v16, v49, -v25
  v_fma_f32 v26, v16, v50, -v26
  v_fma_f32 v27, v16, v51, -v27
  v_fma_f32 v28, v16, v52, -v28
  v_fma_f32 v29, v16, v53, -v29
  v_fma_f32 v30, v16, v54, -v30
  v_fma_f32 v31, v16, v55, -v31
  v_fma_f32 v32, v17, v56, -v32
  v_fma_f32 v33, v17, v57, -v33
  v_fma_f32 v34, v17, v58, -v34
  v_fma_f32 v35, v17, v59, -v35
  v_fma_f32 v36, v17, v60, -v36
  v_fma_f32 v37, v17, v61, -v37
  v_fma_f32 v38, v17, v62, -v38
  v_fma_f32 v39, v17, v63, -v39
  v_fma_f32 v40, v18, v64, -v40
  v_fma_f32 v41, v18, v65, -v41
  v_fma_f32 v42, v18, v66, -v42
  v_fma_f32 v43, v18, v67, -v43
  v_fma_f32 v44, v18, v68, -v44
  v_fma_f32 v45, v18, v69, -v45
  v_fma_f32 v46, v18, v70, -v46
  v_fma_f32 v47, v18, v71, -v47
  v_cvt_pk_bf16_f32 v168, v24, v25
  v_cvt_pk_bf16_f32 v169, v26, v27
  v_cvt_pk_bf16_f32 v170, v28, v29
  v_cvt_pk_bf16_f32 v171, v30, v31
  v_cvt_pk_bf16_f32 v172, v32, v33
  v_cvt_pk_bf16_f32 v173, v34, v35
  v_cvt_pk_bf16_f32 v174, v36, v37
  v_cvt_pk_bf16_f32 v175, v38, v39
  v_cvt_pk_bf16_f32 v176, v40, v41
  v_cvt_pk_bf16_f32 v177, v42, v43
  v_cvt_pk_bf16_f32 v178, v44, v45
  v_cvt_pk_bf16_f32 v179, v46, v47
  s_waitcnt vmcnt(0)
  s_barrier
  ds_read_b128 v[180:183], v4 offset:0
  ds_read_b128 v[184:187], v4 offset:2048
  ds_read_b128 v[188:191], v5 offset:16384
  ds_read_b128 v[192:195], v5 offset:18432
  ds_read_b128 v[196:199], v5 offset:0
  ds_read_b128 v[200:203], v5 offset:2048
  ds_read_b128 v[204:207], v4 offset:20480
  ds_read_b128 v[208:211], v4 offset:22528
  s_waitcnt lgkmcnt(4)
  v_mfma_f32_16x16x32_bf16 v[24:27], v[180:183], v[72:75], 0
  v_mfma_f32_16x16x32_bf16 v[28:31], v[180:183], v[76:79], 0
  v_mfma_f32_16x16x32_bf16 v[32:35], v[180:183], v[80:83], 0
  v_mfma_f32_16x16x32_bf16 v[36:39], v[184:187], v[72:75], 0
  v_mfma_f32_16x16x32_bf16 v[40:43], v[184:187], v[76:79], 0
  v_mfma_f32_16x16x32_bf16 v[44:47], v[184:187], v[80:83], 0
  v_mfma_f32_16x16x32_bf16 v[48:51], v[188:191], v[72:75], 0
  v_mfma_f32_16x16x32_bf16 v[52:55], v[188:191], v[76:79], 0
  v_mfma_f32_16x16x32_bf16 v[56:59], v[188:191], v[80:83], 0
  v_mfma_f32_16x16x32_bf16 v[60:63], v[192:195], v[72:75], 0
  v_mfma_f32_16x16x32_bf16 v[64:67], v[192:195], v[76:79], 0
  v_mfma_f32_16x16x32_bf16 v[68:71], v[192:195], v[80:83], 0
  ds_read_b128 v[180:183], v4 offset:4096
  ds_read_b128 v[184:187], v4 offset:6144
  ds_read_b128 v[188:191], v5 offset:20480
  ds_read_b128 v[192:195], v5 offset:22528
  s_waitcnt lgkmcnt(4)
  v_mfma_f32_16x16x32_bf16 v[24:27], v[196:199], v[84:87], v[24:27]
  v_mfma_f32_16x16x32_bf16 v[28:31], v[196:199], v[88:91], v[28:31]
  v_mfma_f32_16x16x32_bf16 v[32:35], v[196:199], v[92:95], v[32:35]
  v_mfma_f32_16x16x32_bf16 v[36:39], v[200:203], v[84:87], v[36:39]
  v_mfma_f32_16x16x32_bf16 v[40:43], v[200:203], v[88:91], v[40:43]
  v_mfma_f32_16x16x32_bf16 v[44:47], v[200:203], v[92:95], v[44:47]
  v_mfma_f32_16x16x32_bf16 v[48:51], v[204:207], v[84:87], v[48:51]
  v_mfma_f32_16x16x32_bf16 v[52:55], v[204:207], v[88:91], v[52:55]
  v_mfma_f32_16x16x32_bf16 v[56:59], v[204:207], v[92:95], v[56:59]
  v_mfma_f32_16x16x32_bf16 v[60:63], v[208:211], v[84:87], v[60:63]
  v_mfma_f32_16x16x32_bf16 v[64:67], v[208:211], v[88:91], v[64:67]
  v_mfma_f32_16x16x32_bf16 v[68:71], v[208:211], v[92:95], v[68:71]
  ds_read_b128 v[196:199], v5 offset:4096
  ds_read_b128 v[200:203], v5 offset:6144
  ds_read_b128 v[204:207], v4 offset:24576
  ds_read_b128 v[208:211], v4 offset:26624
  s_waitcnt lgkmcnt(4)
  v_mfma_f32_16x16x32_bf16 v[24:27], v[180:183], v[96:99], v[24:27]
  v_mfma_f32_16x16x32_bf16 v[28:31], v[180:183], v[100:103], v[28:31]
  v_mfma_f32_16x16x32_bf16 v[32:35], v[180:183], v[104:107], v[32:35]
  v_mfma_f32_16x16x32_bf16 v[36:39], v[184:187], v[96:99], v[36:39]
  v_mfma_f32_16x16x32_bf16 v[40:43], v[184:187], v[100:103], v[40:43]
  v_mfma_f32_16x16x32_bf16 v[44:47], v[184:187], v[104:107], v[44:47]
  v_mfma_f32_16x16x32_bf16 v[48:51], v[188:191], v[96:99], v[48:51]
  v_mfma_f32_16x16x32_bf16 v[52:55], v[188:191], v[100:103], v[52:55]
  v_mfma_f32_16x16x32_bf16 v[56:59], v[188:191], v[104:107], v[56:59]
  v_mfma_f32_16x16x32_bf16 v[60:63], v[192:195], v[96:99], v[60:63]
  v_mfma_f32_16x16x32_bf16 v[64:67], v[192:195], v[100:103], v[64:67]
  v_mfma_f32_16x16x32_bf16 v[68:71], v[192:195], v[104:107], v[68:71]
  ds_read_b128 v[180:183], v4 offset:8192
  ds_read_b128 v[184:187], v4 offset:10240
  ds_read_b128 v[188:191], v5 offset:24576
  ds_read_b128 v[192:195], v5 offset:26624
  s_waitcnt lgkmcnt(4)
  v_mfma_f32_16x16x32_bf16 v[24:27], v[196:199], v[108:111], v[24:27]
  v_mfma_f32_16x16x32_bf16 v[28:31], v[196:199], v[112:115], v[28:31]
  v_mfma_f32_16x16x32_bf16 v[32:35], v[196:199], v[116:119], v[32:35]
  v_mfma_f32_16x16x32_bf16 v[36:39], v[200:203], v[108:111], v[36:39]
  v_mfma_f32_16x16x32_bf16 v[40:43], v[200:203], v[112:115], v[40:43]
  v_mfma_f32_16x16x32_bf16 v[44:47], v[200:203], v[116:119], v[44:47]
  v_mfma_f32_16x16x32_bf16 v[48:51], v[204:207], v[108:111], v[48:51]
  v_mfma_f32_16x16x32_bf16 v[52:55], v[204:207], v[112:115], v[52:55]
  v_mfma_f32_16x16x32_bf16 v[56:59], v[204:207], v[116:119], v[56:59]
  v_mfma_f32_16x16x32_bf16 v[60:63], v[208:211], v[108:111], v[60:63]
  v_mfma_f32_16x16x32_bf16 v[64:67], v[208:211], v[112:115], v[64:67]
  v_mfma_f32_16x16x32_bf16 v[68:71], v[208:211], v[116:119], v[68:71]
  ds_read_b128 v[196:199], v5 offset:8192
  ds_read_b128 v[200:203], v5 offset:10240
  ds_read_b128 v[204:207], v4 offset:28672
  ds_read_b128 v[208:211], v4 offset:30720
  s_waitcnt lgkmcnt(4)
  v_mfma_f32_16x16x32_bf16 v[24:27], v[180:183], v[120:123], v[24:27]
  v_mfma_f32_16x16x32_bf16 v[28:31], v[180:183], v[124:127], v[28:31]
  v_mfma_f32_16x16x32_bf16 v[32:35], v[180:183], v[128:131], v[32:35]
  v_mfma_f32_16x16x32_bf16 v[36:39], v[184:187], v[120:123], v[36:39]
  v_mfma_f32_16x16x32_bf16 v[40:43], v[184:187], v[124:127], v[40:43]
  v_mfma_f32_16x16x32_bf16 v[44:47], v[184:187], v[128:131], v[44:47]
  v_mfma_f32_16x16x32_bf16 v[48:51], v[188:191], v[120:123], v[48:51]
  v_mfma_f32_16x16x32_bf16 v[52:55], v[188:191], v[124:127], v[52:55]
  v_mfma_f32_16x16x32_bf16 v[56:59], v[188:191], v[128:131], v[56:59]
  v_mfma_f32_16x16x32_bf16 v[60:63], v[192:195], v[120:123], v[60:63]
  v_mfma_f32_16x16x32_bf16 v[64:67], v[192:195], v[124:127], v[64:67]
  v_mfma_f32_16x16x32_bf16 v[68:71], v[192:195], v[128:131], v[68:71]
  ds_read_b128 v[180:183], v4 offset:12288
  ds_read_b128 v[184:187], v4 offset:14336
  ds_read_b128 v[188:191], v5 offset:28672
  ds_read_b128 v[192:195], v5 offset:30720
  s_waitcnt lgkmcnt(4)
  v_mfma_f32_16x16x32_bf16 v[24:27], v[196:199], v[132:135], v[24:27]
  v_mfma_f32_16x16x32_bf16 v[28:31], v[196:199], v[136:139], v[28:31]
  v_mfma_f32_16x16x32_bf16 v[32:35], v[196:199], v[140:143], v[32:35]
  v_mfma_f32_16x16x32_bf16 v[36:39], v[200:203], v[132:135], v[36:39]
  v_mfma_f32_16x16x32_bf16 v[40:43], v[200:203], v[136:139], v[40:43]
  v_mfma_f32_16x16x32_bf16 v[44:47], v[200:203], v[140:143], v[44:47]
  v_mfma_f32_16x16x32_bf16 v[48:51], v[204:207], v[132:135], v[48:51]
  v_mfma_f32_16x16x32_bf16 v[52:55], v[204:207], v[136:139], v[52:55]
  v_mfma_f32_16x16x32_bf16 v[56:59], v[204:207], v[140:143], v[56:59]
  v_mfma_f32_16x16x32_bf16 v[60:63], v[208:211], v[132:135], v[60:63]
  v_mfma_f32_16x16x32_bf16 v[64:67], v[208:211], v[136:139], v[64:67]
  v_mfma_f32_16x16x32_bf16 v[68:71], v[208:211], v[140:143], v[68:71]
  ds_read_b128 v[196:199], v5 offset:12288
  ds_read_b128 v[200:203], v5 offset:14336
  ds_read_b128 v[204:207], v4 offset:32768
  ds_read_b128 v[208:211], v4 offset:34816
  s_waitcnt lgkmcnt(4)
  v_mfma_f32_16x16x32_bf16 v[24:27], v[180:183], v[144:147], v[24:27]
  v_mfma_f32_16x16x32_bf16 v[28:31], v[180:183], v[148:151], v[28:31]
  v_mfma_f32_16x16x32_bf16 v[32:35], v[180:183], v[152:155], v[32:35]
  v_mfma_f32_16x16x32_bf16 v[36:39], v[184:187], v[144:147], v[36:39]
  v_mfma_f32_16x16x32_bf16 v[40:43], v[184:187], v[148:151], v[40:43]
  v_mfma_f32_16x16x32_bf16 v[44:47], v[184:187], v[152:155], v[44:47]
  v_mfma_f32_16x16x32_bf16 v[48:51], v[188:191], v[144:147], v[48:51]
  v_mfma_f32_16x16x32_bf16 v[52:55], v[188:191], v[148:151], v[52:55]
  v_mfma_f32_16x16x32_bf16 v[56:59], v[188:191], v[152:155], v[56:59]
  v_mfma_f32_16x16x32_bf16 v[60:63], v[192:195], v[144:147], v[60:63]
  v_mfma_f32_16x16x32_bf16 v[64:67], v[192:195], v[148:151], v[64:67]
  v_mfma_f32_16x16x32_bf16 v[68:71], v[192:195], v[152:155], v[68:71]
  ds_read_b128 v[180:183], v4 offset:16384
  ds_read_b128 v[184:187], v4 offset:18432
  ds_read_b128 v[188:191], v5 offset:32768
  ds_read_b128 v[192:195], v5 offset:34816
  s_waitcnt lgkmcnt(4)
  v_mfma_f32_16x16x32_bf16 v[24:27], v[196:199], v[156:159], v[24:27]
  v_mfma_f32_16x16x32_bf16 v[28:31], v[196:199], v[160:163], v[28:31]
  v_mfma_f32_16x16x32_bf16 v[32:35], v[196:199], v[164:167], v[32:35]
  v_mfma_f32_16x16x32_bf16 v[36:39], v[200:203], v[156:159], v[36:39]
  v_mfma_f32_16x16x32_bf16 v[40:43], v[200:203], v[160:163], v[40:43]
  v_mfma_f32_16x16x32_bf16 v[44:47], v[200:203], v[164:167], v[44:47]
  v_mfma_f32_16x16x32_bf16 v[48:51], v[204:207], v[156:159], v[48:51]
  v_mfma_f32_16x16x32_bf16 v[52:55], v[204:207], v[160:163], v[52:55]
  v_mfma_f32_16x16x32_bf16 v[56:59], v[204:207], v[164:167], v[56:59]
  v_mfma_f32_16x16x32_bf16 v[60:63], v[208:211], v[156:159], v[60:63]
  v_mfma_f32_16x16x32_bf16 v[64:67], v[208:211], v[160:163], v[64:67]
  v_mfma_f32_16x16x32_bf16 v[68:71], v[208:211], v[164:167], v[68:71]
  s_waitcnt lgkmcnt(0)
  v_mfma_f32_16x16x32_bf16 v[24:27], v[180:183], v[168:171], v[24:27]
  v_mfma_f32_16x16x32_bf16 v[28:31], v[180:183], v[172:175], v[28:31]
  v_mfma_f32_16x16x32_bf16 v[32:35], v[180:183], v[176:179], v[32:35]
  v_mfma_f32_16x16x32_bf16 v[36:39], v[184:187], v[168:171], v[36:39]
  v_mfma_f32_16x16x32_bf16 v[40:43], v[184:187], v[172:175], v[40:43]
  v_mfma_f32_16x16x32_bf16 v[44:47], v[184:187], v[176:179], v[44:47]
  v_mfma_f32_16x16x32_bf16 v[48:51], v[188:191], v[168:171], v[48:51]
  v_mfma_f32_16x16x32_bf16 v[52:55], v[188:191], v[172:175], v[52:55]
  v_mfma_f32_16x16x32_bf16 v[56:59], v[188:191], v[176:179], v[56:59]
  v_mfma_f32_16x16x32_bf16 v[60:63], v[192:195], v[168:171], v[60:63]
  v_mfma_f32_16x16x32_bf16 v[64:67], v[192:195], v[172:175], v[64:67]
  v_mfma_f32_16x16x32_bf16 v[68:71], v[192:195], v[176:179], v[68:71]
  s_barrier
  v_lshlrev_b32 v22, 4, v3
  v_add_u32 v22, 36864, v22
  ds_read_b128 v[180:183], v22
  ds_read_b128 v[184:187], v22 offset:64
  s_mov_b32 s25, 0x0
  s_nop 4
  s_waitcnt lgkmcnt(0)
  v_fma_f32 v24, v48, v7, v24
  v_fma_f32 v25, v49, v7, v25
  v_fma_f32 v26, v50, v7, v26
  v_fma_f32 v27, v51, v7, v27
  v_mul_f32 v24, v24, v180
  v_mul_f32 v25, v25, v181
  v_mul_f32 v26, v26, v182
  v_mul_f32 v27, v27, v183
  v_cvt_pk_bf16_f32 v48, v24, v25
  v_cvt_pk_bf16_f32 v49, v26, v27
  buffer_store_dwordx2 v[48:49], v19, s[8:11], s25 offen offset:0
  v_fma_f32 v28, v52, v8, v28
  v_fma_f32 v29, v53, v8, v29
  v_fma_f32 v30, v54, v8, v30
  v_fma_f32 v31, v55, v8, v31
  v_mul_f32 v28, v28, v180
  v_mul_f32 v29, v29, v181
  v_mul_f32 v30, v30, v182
  v_mul_f32 v31, v31, v183
  v_cvt_pk_bf16_f32 v52, v28, v29
  v_cvt_pk_bf16_f32 v53, v30, v31
  buffer_store_dwordx2 v[52:53], v20, s[8:11], s25 offen offset:0
  v_fma_f32 v32, v56, v9, v32
  v_fma_f32 v33, v57, v9, v33
  v_fma_f32 v34, v58, v9, v34
  v_fma_f32 v35, v59, v9, v35
  v_mul_f32 v32, v32, v180
  v_mul_f32 v33, v33, v181
  v_mul_f32 v34, v34, v182
  v_mul_f32 v35, v35, v183
  v_cvt_pk_bf16_f32 v56, v32, v33
  v_cvt_pk_bf16_f32 v57, v34, v35
  buffer_store_dwordx2 v[56:57], v21, s[8:11], s25 offen offset:0
  v_fma_f32 v36, v60, v7, v36
  v_fma_f32 v37, v61, v7, v37
  v_fma_f32 v38, v62, v7, v38
  v_fma_f32 v39, v63, v7, v39
  v_mul_f32 v36, v36, v184
  v_mul_f32 v37, v37, v185
  v_mul_f32 v38, v38, v186
  v_mul_f32 v39, v39, v187
  v_cvt_pk_bf16_f32 v60, v36, v37
  v_cvt_pk_bf16_f32 v61, v38, v39
  buffer_store_dwordx2 v[60:61], v19, s[8:11], s25 offen offset:32
  v_fma_f32 v40, v64, v8, v40
  v_fma_f32 v41, v65, v8, v41
  v_fma_f32 v42, v66, v8, v42
  v_fma_f32 v43, v67, v8, v43
  v_mul_f32 v40, v40, v184
  v_mul_f32 v41, v41, v185
  v_mul_f32 v42, v42, v186
  v_mul_f32 v43, v43, v187
  v_cvt_pk_bf16_f32 v64, v40, v41
  v_cvt_pk_bf16_f32 v65, v42, v43
  buffer_store_dwordx2 v[64:65], v20, s[8:11], s25 offen offset:32
  v_fma_f32 v44, v68, v9, v44
  v_fma_f32 v45, v69, v9, v45
  v_fma_f32 v46, v70, v9, v46
  v_fma_f32 v47, v71, v9, v47
  v_mul_f32 v44, v44, v184
  v_mul_f32 v45, v45, v185
  v_mul_f32 v46, v46, v186
  v_mul_f32 v47, v47, v187
  v_cvt_pk_bf16_f32 v68, v44, v45
  v_cvt_pk_bf16_f32 v69, v46, v47
  buffer_store_dwordx2 v[68:69], v21, s[8:11], s25 offen offset:32
  s_endpgm
k1_kernel_stats:
  s_getpc_b64 s[40:41]
k1_kernel_pc1:
  s_add_u32 s40, s40, k2_kernel - k1_kernel_pc1
  s_addc_u32 s41, s41, 0
  s_lshr_b32 s42, s2, 3
  s_and_b32 s42, s42, 7
  s_lshl_b32 s42, s42, 13
  v_lshlrev_b32 v213, 7, v1
  v_add_u32 v213, s42, v213
  v_min_u32 v213, text_end - k2_kernel - 4, v213
  global_load_dword v212, v213, s[40:41]
  s_cmp_lg_u32 s2, 0
  s_cbranch_scc1 k1_kernel_nz
  v_and_b32 v213, 31, v1
  v_lshlrev_b32 v213, 8, v213
  v_lshrrev_b32 v214, 5, v1
  v_lshl_add_u32 v213, v214, 6, v213
  v_mov_b32 v208, 0
  v_mov_b32 v209, 0
  v_mov_b32 v210, 0
  v_mov_b32 v211, 0
  s_mov_b32 s30, 0x6d0000
  buffer_store_dwordx4 v[208:211], v213, s[8:11], s30 offen offset:0
  buffer_store_dwordx4 v[208:211], v213, s[8:11], s30 offen offset:16
  buffer_store_dwordx4 v[208:211], v213, s[8:11], s30 offen offset:32
  buffer_store_dwordx4 v[208:211], v213, s[8:11], s30 offen offset:48
  s_waitcnt vmcnt(0)
k1_kernel_nz:
  v_mov_b32 v72, 0x3f803f80
  v_mov_b32 v73, 0x3f803f80
  v_mov_b32 v74, 0x3f803f80
  v_mov_b32 v75, 0x3f803f80
  s_waitcnt vmcnt(1)
  s_barrier
  ds_read_b128 v[80:83], v4 offset:0
  ds_read_b128 v[84:87], v5 offset:0
  ds_read_b128 v[88:91], v4 offset:4096
  ds_read_b128 v[92:95], v5 offset:4096
  ds_read_b128 v[96:99], v4 offset:8192
  ds_read_b128 v[100:103], v5 offset:8192
  ds_read_b128 v[104:107], v4 offset:12288
  ds_read_b128 v[108:111], v5 offset:12288
  ds_read_b128 v[112:115], v4 offset:16384
  ds_read_b128 v[116:119], v5 offset:16384
  ds_read_b128 v[120:123], v4 offset:20480
  ds_read_b128 v[124:127], v5 offset:20480
  s_waitcnt lgkmcnt(6)
  v_mfma_f32_16x16x32_bf16 v[24:27], v[80:83], v[80:83], 0
  v_mfma_f32_16x16x32_bf16 v[28:31], v[80:83], v[72:75], 0
  v_mfma_f32_16x16x32_bf16 v[24:27], v[84:87], v[84:87], v[24:27]
  v_mfma_f32_16x16x32_bf16 v[28:31], v[84:87], v[72:75], v[28:31]
  v_mfma_f32_16x16x32_bf16 v[24:27], v[88:91], v[88:91], v[24:27]
  v_mfma_f32_16x16x32_bf16 v[28:31], v[88:91], v[72:75], v[28:31]
  v_mfma_f32_16x16x32_bf16 v[24:27], v[92:95], v[92:95], v[24:27]
  v_mfma_f32_16x16x32_bf16 v[28:31], v[92:95], v[72:75], v[28:31]
  v_mfma_f32_16x16x32_bf16 v[24:27], v[96:99], v[96:99], v[24:27]
  v_mfma_f32_16x16x32_bf16 v[28:31], v[96:99], v[72:75], v[28:31]
  v_mfma_f32_16x16x32_bf16 v[24:27], v[100:103], v[100:103], v[24:27]
  v_mfma_f32_16x16x32_bf16 v[28:31], v[100:103], v[72:75], v[28:31]
  ds_read_b128 v[128:131], v4 offset:24576
  ds_read_b128 v[132:135], v5 offset:24576
  ds_read_b128 v[136:139], v4 offset:28672
  ds_read_b128 v[140:143], v5 offset:28672
  ds_read_b128 v[144:147], v4 offset:32768
  ds_read_b128 v[148:151], v5 offset:32768
  s_waitcnt lgkmcnt(6)
  v_mfma_f32_16x16x32_bf16 v[24:27], v[104:107], v[104:107], v[24:27]
  v_mfma_f32_16x16x32_bf16 v[28:31], v[104:107], v[72:75], v[28:31]
  v_mfma_f32_16x16x32_bf16 v[24:27], v[108:111], v[108:111], v[24:27]
  v_mfma_f32_16x16x32_bf16 v[28:31], v[108:111], v[72:75], v[28:31]
  v_mfma_f32_16x16x32_bf16 v[24:27], v[112:115], v[112:115], v[24:27]
  v_mfma_f32_16x16x32_bf16 v[28:31], v[112:115], v[72:75], v[28:31]
  v_mfma_f32_16x16x32_bf16 v[24:27], v[116:119], v[116:119], v[24:27]
  v_mfma_f32_16x16x32_bf16 v[28:31], v[116:119], v[72:75], v[28:31]
  v_mfma_f32_16x16x32_bf16 v[24:27], v[120:123], v[120:123], v[24:27]
  v_mfma_f32_16x16x32_bf16 v[28:31], v[120:123], v[72:75], v[28:31]
  v_mfma_f32_16x16x32_bf16 v[24:27], v[124:127], v[124:127], v[24:27]
  v_mfma_f32_16x16x32_bf16 v[28:31], v[124:127], v[72:75], v[28:31]
  ds_read_b128 v[80:83], v4 offset:2048
  ds_read_b128 v[84:87], v5 offset:2048
  ds_read_b128 v[88:91], v4 offset:6144
  ds_read_b128 v[92:95], v5 offset:6144
  ds_read_b128 v[96:99], v4 offset:10240
  ds_read_b128 v[100:103], v5 offset:10240
  s_waitcnt lgkmcnt(6)
  v_mfma_f32_16x16x32_bf16 v[24:27], v[128:131], v[128:131], v[24:27]
  v_mfma_f32_16x16x32_bf16 v[28:31], v[128:131], v[72:75], v[28:31]
  v_mfma_f32_16x16x32_bf16 v[24:27], v[132:135], v[132:135], v[24:27]
  v_mfma_f32_16x16x32_bf16 v[28:31], v[132:135], v[72:75], v[28:31]
  v_mfma_f32_16x16x32_bf16 v[24:27], v[136:139], v[136:139], v[24:27]
  v_mfma_f32_16x16x32_bf16 v[28:31], v[136:139], v[72:75], v[28:31]
  v_mfma_f32_16x16x32_bf16 v[24:27], v[140:143], v[140:143], v[24:27]
  v_mfma_f32_16x16x32_bf16 v[28:31], v[140:143], v[72:75], v[28:31]
  v_mfma_f32_16x16x32_bf16 v[24:27], v[144:147], v[144:147], v[24:27]
  v_mfma_f32_16x16x32_bf16 v[28:31], v[144:147], v[72:75], v[28:31]
  v_mfma_f32_16x16x32_bf16 v[24:27], v[148:151], v[148:151], v[24:27]
  v_mfma_f32_16x16x32_bf16 v[28:31], v[148:151], v[72:75], v[28:31]
  ds_read_b128 v[104:107], v4 offset:14336
  ds_read_b128 v[108:111], v5 offset:14336
  ds_read_b128 v[112:115], v4 offset:18432
  ds_read_b128 v[116:119], v5 offset:18432
  ds_read_b128 v[120:123], v4 offset:22528
  ds_read_b128 v[124:127], v5 offset:22528
  s_waitcnt lgkmcnt(6)
  v_mfma_f32_16x16x32_bf16 v[32:35], v[80:83], v[80:83], 0
  v_mfma_f32_16x16x32_bf16 v[36:39], v[80:83], v[72:75], 0
  v_mfma_f32_16x16x32_bf16 v[32:35], v[84:87], v[84:87], v[32:35]
  v_mfma_f32_16x16x32_bf16 v[36:39], v[84:87], v[72:75], v[36:39]
  v_mfma_f32_16x16x32_bf16 v[32:35], v[88:91], v[88:91], v[32:35]
  v_mfma_f32_16x16x32_bf16 v[36:39], v[88:91], v[72:75], v[36:39]
  v_mfma_f32_16x16x32_bf16 v[32:35], v[92:95], v[92:95], v[32:35]
  v_mfma_f32_16x16x32_bf16 v[36:39], v[92:95], v[72:75], v[36:39]
  v_mfma_f32_16x16x32_bf16 v[32:35], v[96:99], v[96:99], v[32:35]
  v_mfma_f32_16x16x32_bf16 v[36:39], v[96:99], v[72:75], v[36:39]
  v_mfma_f32_16x16x32_bf16 v[32:35], v[100:103], v[100:103], v[32:35]
  v_mfma_f32_16x16x32_bf16 v[36:39], v[100:103], v[72:75], v[36:39]
  ds_read_b128 v[128:131], v4 offset:26624
  ds_read_b128 v[132:135], v5 offset:26624
  ds_read_b128 v[136:139], v4 offset:30720
  ds_read_b128 v[140:143], v5 offset:30720
  ds_read_b128 v[144:147], v4 offset:34816
  ds_read_b128 v[148:151], v5 offset:34816
  s_waitcnt lgkmcnt(6)
  v_mfma_f32_16x16x32_bf16 v[32:35], v[104:107], v[104:107], v[32:35]
  v_mfma_f32_16x16x32_bf16 v[36:39], v[104:107], v[72:75], v[36:39]
  v_mfma_f32_16x16x32_bf16 v[32:35], v[108:111], v[108:111], v[32:35]
  v_mfma_f32_16x16x32_bf16 v[36:39], v[108:111], v[72:75], v[36:39]
  v_mfma_f32_16x16x32_bf16 v[32:35], v[112:115], v[112:115], v[32:35]
  v_mfma_f32_16x16x32_bf16 v[36:39], v[112:115], v[72:75], v[36:39]
  v_mfma_f32_16x16x32_bf16 v[32:35], v[116:119], v[116:119], v[32:35]
  v_mfma_f32_16x16x32_bf16 v[36:39], v[116:119], v[72:75], v[36:39]
  v_mfma_f32_16x16x32_bf16 v[32:35], v[120:123], v[120:123], v[32:35]
  v_mfma_f32_16x16x32_bf16 v[36:39], v[120:123], v[72:75], v[36:39]
  v_mfma_f32_16x16x32_bf16 v[32:35], v[124:127], v[124:127], v[32:35]
  v_mfma_f32_16x16x32_bf16 v[36:39], v[124:127], v[72:75], v[36:39]
  s_waitcnt lgkmcnt(0)
  v_mfma_f32_16x16x32_bf16 v[32:35], v[128:131], v[128:131], v[32:35]
  v_mfma_f32_16x16x32_bf16 v[36:39], v[128:131], v[72:75], v[36:39]
  v_mfma_f32_16x16x32_bf16 v[32:35], v[132:135], v[132:135], v[32:35]
  v_mfma_f32_16x16x32_bf16 v[36:39], v[132:135], v[72:75], v[36:39]
  v_mfma_f32_16x16x32_bf16 v[32:35], v[136:139], v[136:139], v[32:35]
  v_mfma_f32_16x16x32_bf16 v[36:39], v[136:139], v[72:75], v[36:39]
  v_mfma_f32_16x16x32_bf16 v[32:35], v[140:143], v[140:143], v[32:35]
  v_mfma_f32_16x16x32_bf16 v[36:39], v[140:143], v[72:75], v[36:39]
  v_mfma_f32_16x16x32_bf16 v[32:35], v[144:147], v[144:147], v[32:35]
  v_mfma_f32_16x16x32_bf16 v[36:39], v[144:147], v[72:75], v[36:39]
  v_mfma_f32_16x16x32_bf16 v[32:35], v[148:151], v[148:151], v[32:35]
  v_mfma_f32_16x16x32_bf16 v[36:39], v[148:151], v[72:75], v[36:39]
  s_nop 7
  s_nop 1
  v_and_b32 v22, 3, v1
  v_cmp_eq_u32 vcc, 1, v22
  s_nop 1
  v_cndmask_b32 v40, v24, v25, vcc
  v_cndmask_b32 v41, v28, v29, vcc
  v_cmp_eq_u32 vcc, 2, v22
  s_nop 1
  v_cndmask_b32 v40, v40, v26, vcc
  v_cndmask_b32 v41, v41, v30, vcc
  v_cmp_eq_u32 vcc, 3, v22
  s_nop 1
  v_cndmask_b32 v40, v40, v27, vcc
  v_cndmask_b32 v41, v41, v31, vcc
  v_mul_f32 v41, 0x3ae38e39, v41
  v_mul_f32 v40, 0x3ae38e39, v40
  v_fma_f32 v40, -v41, v41, v40
  v_max_f32 v40, 0, v40
  v_add_f32 v40, 0x3727c5ac, v40
  v_rsq_f32 v40, v40
  v_cmp_eq_u32 vcc, 1, v22
  s_nop 1
  v_cndmask_b32 v44, v32, v33, vcc
  v_cndmask_b32 v45, v36, v37, vcc
  v_cmp_eq_u32 vcc, 2, v22
  s_nop 1
  v_cndmask_b32 v44, v44, v34, vcc
  v_cndmask_b32 v45, v45, v38, vcc
  v_cmp_eq_u32 vcc, 3, v22
  s_nop 1
  v_cndmask_b32 v44, v44, v35, vcc
  v_cndmask_b32 v45, v45, v39, vcc
  v_mul_f32 v45, 0x3ae38e39, v45
  v_mul_f32 v44, 0x3ae38e39, v44
  v_fma_f32 v44, -v45, v45, v44
  v_max_f32 v44, 0, v44
  v_add_f32 v44, 0x3727c5ac, v44
  v_rsq_f32 v44, v44
  v_lshrrev_b32 v23, 2, v2
  v_lshlrev_b32 v50, 2, v2
  v_add_u32 v51, 36864, v50
  s_lshl_b32 s21, s17, 7
  s_add_u32 s21, s21, 0x6c0000
  v_cmp_eq_u32 vcc, v23, v3
  s_and_saveexec_b64 s[28:29], vcc
  ds_write_b32 v51, v40
  ds_write_b32 v51, v44 offset:64
  s_cmp_lg_u32 s19, 0
  s_cbranch_scc1 k1_kernel_nomean
  buffer_store_dword v41, v50, s[8:11], s21 offen
  buffer_store_dword v45, v50, s[8:11], s21 offen offset:64
k1_kernel_nomean:
  s_mov_b64 exec, s[28:29]
  s_waitcnt lgkmcnt(0)
  s_barrier
  s_endpgm
k1_kernel_wt:
  s_cmp_ge_u32 s2, 320
  s_cbranch_scc1 k1_kernel_swz
  s_sub_u32 s16, s2, 256
  s_waitcnt lgkmcnt(0)
  s_mov_b32 s8, s4
  s_mov_b32 s9, s5
  s_mov_b32 s10, 0x10000000
  s_mov_b32 s11, 0x20000
  s_mov_b32 s12, s36
  s_mov_b32 s13, s37
  s_mov_b32 s14, 1183744
  s_mov_b32 s15, 0x20000
  s_mov_b32 s24, s38
  s_mov_b32 s25, s39
  s_lshr_b32 s20, s16, 1
  s_and_b32 s21, s16, 1
  s_cmp_eq_u32 s21, 1
  s_cselect_b32 s12, s24, s12
  s_cselect_b32 s13, s25, s13
  v_lshlrev_b32 v11, 4, v1
  s_mul_i32 s23, s20, 36992
  s_lshl_b32 s22, s18, 10
  s_add_u32 s23, s23, s22
  s_add_u32 m0, s22, 0
  s_nop 0
  buffer_load_dwordx4 v11, s[12:15], s23 offen lds
  s_add_u32 m0, s22, 4096
  s_add_u32 s23, s23, 4096
  buffer_load_dwordx4 v11, s[12:15], s23 offen lds
  s_add_u32 m0, s22, 8192
  s_add_u32 s23, s23, 4096
  buffer_load_dwordx4 v11, s[12:15], s23 offen lds
  s_add_u32 m0, s22, 12288
  s_add_u32 s23, s23, 4096
  buffer_load_dwordx4 v11, s[12:15], s23 offen lds
  s_add_u32 m0, s22, 16384
  s_add_u32 s23, s23, 4096
  buffer_load_dwordx4 v11, s[12:15], s23 offen lds
  s_add_u32 m0, s22, 20480
  s_add_u32 s23, s23, 4096
  buffer_load_dwordx4 v11, s[12:15], s23 offen lds
  s_add_u32 m0, s22, 24576
  s_add_u32 s23, s23, 4096
  buffer_load_dwordx4 v11, s[12:15], s23 offen lds
  s_add_u32 m0, s22, 28672
  s_add_u32 s23, s23, 4096
  buffer_load_dwordx4 v11, s[12:15], s23 offen lds
  s_add_u32 m0, s22, 32768
  s_add_u32 s23, s23, 4096
  buffer_load_dwordx4 v11, s[12:15], s23 offen lds
  s_cmp_lg_u32 s18, 0
  s_cbranch_scc1 WT2_skip
  s_add_u32 m0, s22, 36864
  s_add_u32 s23, s23, 4096
  buffer_load_dwordx4 v11, s[12:15], s23 offen lds
WT2_skip:
  v_and_b32 v2, 15, v1
  v_lshrrev_b32 v3, 4, v1
  s_movk_i32 s26, 578
  v_mul_lo_u32 v4, v2, s26
  s_mul_i32 s26, s18, 72
  v_add_u32 v5, s26, v3
  v_lshl_add_u32 v6, v5, 1, v4
  v_cmp_eq_u32 vcc, 0, v5
  v_add_u32 v7, 576, v4
  s_nop 0
  v_cndmask_b32 v7, v6, v7, vcc
  v_lshlrev_b32 v8, 13, v5
  v_lshl_add_u32 v8, v2, 3, v8
  s_lshr_b32 s26, s20, 3
  s_lshl_b32 s26, s26, 11
  s_lshl_b32 s27, s21, 10
  s_add_u32 s26, s26, s27
  s_and_b32 s27, s20, 1
  s_lshl_b32 s27, s27, 9
  s_add_u32 s26, s26, s27
  s_bfe_u32 s27, s20, 0x20001
  s_lshl_b32 s27, s27, 7
  s_add_u32 s26, s26, s27
  s_add_u32 s26, s26, 0x700000
  s_waitcnt vmcnt(0)
  s_barrier
  ds_read_u16 v16, v7 offset:0
  ds_read_u16 v17, v7 offset:18496
  ds_read_u16 v18, v7 offset:9248
  ds_read_u16 v19, v7 offset:27744
  ds_read_u16 v20, v6 offset:8
  ds_read_u16 v21, v6 offset:18504
  ds_read_u16 v22, v6 offset:9256
  ds_read_u16 v23, v6 offset:27752
  ds_read_u16 v24, v6 offset:16
  ds_read_u16 v25, v6 offset:18512
  ds_read_u16 v26, v6 offset:9264
  ds_read_u16 v27, v6 offset:27760
  s_waitcnt lgkmcnt(8)
  v_lshl_or_b32 v32, v17, 16, v16
  v_lshl_or_b32 v33, v19, 16, v18
  buffer_store_dwordx2 v[32:33], v8, s[8:11], s26 offen
  s_add_u32 s26, s26, 32768
  ds_read_u16 v16, v6 offset:24
  ds_read_u16 v17, v6 offset:18520
  ds_read_u16 v18, v6 offset:9272
  ds_read_u16 v19, v6 offset:27768
  s_waitcnt lgkmcnt(8)
  v_lshl_or_b32 v34, v21, 16, v20
  v_lshl_or_b32 v35, v23, 16, v22
  buffer_store_dwordx2 v[34:35], v8, s[8:11], s26 offen
  s_add_u32 s26, s26, 32768
  ds_read_u16 v20, v6 offset:32
  ds_read_u16 v21, v6 offset:18528
  ds_read_u16 v22, v6 offset:9280
  ds_read_u16 v23, v6 offset:27776
  s_waitcnt lgkmcnt(8)
  v_lshl_or_b32 v32, v25, 16, v24
  v_lshl_or_b32 v33, v27, 16, v26
  buffer_store_dwordx2 v[32:33], v8, s[8:11], s26 offen
  s_add_u32 s26, s26, 32768
  ds_read_u16 v24, v6 offset:40
  ds_read_u16 v25, v6 offset:18536
  ds_read_u16 v26, v6 offset:9288
  ds_read_u16 v27, v6 offset:27784
  s_waitcnt lgkmcnt(8)
  v_lshl_or_b32 v34, v17, 16, v16
  v_lshl_or_b32 v35, v19, 16, v18
  buffer_store_dwordx2 v[34:35], v8, s[8:11], s26 offen
  s_add_u32 s26, s26, 32768
  ds_read_u16 v16, v6 offset:48
  ds_read_u16 v17, v6 offset:18544
  ds_read_u16 v18, v6 offset:9296
  ds_read_u16 v19, v6 offset:27792
  s_waitcnt lgkmcnt(8)
  v_lshl_or_b32 v32, v21, 16, v20
  v_lshl_or_b32 v33, v23, 16, v22
  buffer_store_dwordx2 v[32:33], v8, s[8:11], s26 offen
  s_add_u32 s26, s26, 32768
  ds_read_u16 v20, v6 offset:56
  ds_read_u16 v21, v6 offset:18552
  ds_read_u16 v22, v6 offset:9304
  ds_read_u16 v23, v6 offset:27800
  s_waitcnt lgkmcnt(8)
  v_lshl_or_b32 v34, v25, 16, v24
  v_lshl_or_b32 v35, v27, 16, v26
  buffer_store_dwordx2 v[34:35], v8, s[8:11], s26 offen
  s_add_u32 s26, s26, 32768
  ds_read_u16 v24, v6 offset:64
  ds_read_u16 v25, v6 offset:18560
  ds_read_u16 v26, v6 offset:9312
  ds_read_u16 v27, v6 offset:27808
  s_waitcnt lgkmcnt(8)
  v_lshl_or_b32 v32, v17, 16, v16
  v_lshl_or_b32 v33, v19, 16, v18
  buffer_store_dwordx2 v[32:33], v8, s[8:11], s26 offen
  s_add_u32 s26, s26, 32768
  ds_read_u16 v16, v6 offset:72
  ds_read_u16 v17, v6 offset:18568
  ds_read_u16 v18, v6 offset:9320
  ds_read_u16 v19, v6 offset:27816
  s_waitcnt lgkmcnt(8)
  v_lshl_or_b32 v34, v21, 16, v20
  v_lshl_or_b32 v35, v23, 16, v22
  buffer_store_dwordx2 v[34:35], v8, s[8:11], s26 offen
  s_add_u32 s26, s26, 32768
  ds_read_u16 v20, v6 offset:80
  ds_read_u16 v21, v6 offset:18576
  ds_read_u16 v22, v6 offset:9328
  ds_read_u16 v23, v6 offset:27824
  s_waitcnt lgkmcnt(8)
  v_lshl_or_b32 v32, v25, 16, v24
  v_lshl_or_b32 v33, v27, 16, v26
  buffer_store_dwordx2 v[32:33], v8, s[8:11], s26 offen
  s_add_u32 s26, s26, 32768
  ds_read_u16 v24, v6 offset:88
  ds_read_u16 v25, v6 offset:18584
  ds_read_u16 v26, v6 offset:9336
  ds_read_u16 v27, v6 offset:27832
  s_waitcnt lgkmcnt(8)
  v_lshl_or_b32 v34, v17, 16, v16
  v_lshl_or_b32 v35, v19, 16, v18
  buffer_store_dwordx2 v[34:35], v8, s[8:11], s26 offen
  s_add_u32 s26, s26, 32768
  ds_read_u16 v16, v6 offset:96
  ds_read_u16 v17, v6 offset:18592
  ds_read_u16 v18, v6 offset:9344
  ds_read_u16 v19, v6 offset:27840
  s_waitcnt lgkmcnt(8)
  v_lshl_or_b32 v32, v21, 16, v20
  v_lshl_or_b32 v33, v23, 16, v22
  buffer_store_dwordx2 v[32:33], v8, s[8:11], s26 offen
  s_add_u32 s26, s26, 32768
  ds_read_u16 v20, v6 offset:104
  ds_read_u16 v21, v6 offset:18600
  ds_read_u16 v22, v6 offset:9352
  ds_read_u16 v23, v6 offset:27848
  s_waitcnt lgkmcnt(8)
  v_lshl_or_b32 v34, v25, 16, v24
  v_lshl_or_b32 v35, v27, 16, v26
  buffer_store_dwordx2 v[34:35], v8, s[8:11], s26 offen
  s_add_u32 s26, s26, 32768
  ds_read_u16 v24, v6 offset:112
  ds_read_u16 v25, v6 offset:18608
  ds_read_u16 v26, v6 offset:9360
  ds_read_u16 v27, v6 offset:27856
  s_waitcnt lgkmcnt(8)
  v_lshl_or_b32 v32, v17, 16, v16
  v_lshl_or_b32 v33, v19, 16, v18
  buffer_store_dwordx2 v[32:33], v8, s[8:11], s26 offen
  s_add_u32 s26, s26, 32768
  ds_read_u16 v16, v6 offset:120
  ds_read_u16 v17, v6 offset:18616
  ds_read_u16 v18, v6 offset:9368
  ds_read_u16 v19, v6 offset:27864
  s_waitcnt lgkmcnt(8)
  v_lshl_or_b32 v34, v21, 16, v20
  v_lshl_or_b32 v35, v23, 16, v22
  buffer_store_dwordx2 v[34:35], v8, s[8:11], s26 offen
  s_add_u32 s26, s26, 32768
  ds_read_u16 v20, v6 offset:128
  ds_read_u16 v21, v6 offset:18624
  ds_read_u16 v22, v6 offset:9376
  ds_read_u16 v23, v6 offset:27872
  s_waitcnt lgkmcnt(8)
  v_lshl_or_b32 v32, v25, 16, v24
  v_lshl_or_b32 v33, v27, 16, v26
  buffer_store_dwordx2 v[32:33], v8, s[8:11], s26 offen
  s_add_u32 s26, s26, 32768
  ds_read_u16 v24, v6 offset:136
  ds_read_u16 v25, v6 offset:18632
  ds_read_u16 v26, v6 offset:9384
  ds_read_u16 v27, v6 offset:27880
  s_waitcnt lgkmcnt(8)
  v_lshl_or_b32 v34, v17, 16, v16
  v_lshl_or_b32 v35, v19, 16, v18
  buffer_store_dwordx2 v[34:35], v8, s[8:11], s26 offen
  s_add_u32 s26, s26, 32768
  s_waitcnt lgkmcnt(4)
  v_lshl_or_b32 v32, v21, 16, v20
  v_lshl_or_b32 v33, v23, 16, v22
  buffer_store_dwordx2 v[32:33], v8, s[8:11], s26 offen
  s_add_u32 s26, s26, 32768
  s_waitcnt lgkmcnt(0)
  v_lshl_or_b32 v34, v25, 16, v24
  v_lshl_or_b32 v35, v27, 16, v26
  buffer_store_dwordx2 v[34:35], v8, s[8:11], s26 offen
  s_add_u32 s26, s26, 32768
  s_endpgm
k1_kernel_swz:
  s_sub_u32 s16, s2, 320
  s_waitcnt lgkmcnt(0)
  s_mov_b32 s8, s4
  s_mov_b32 s9, s5
  s_mov_b32 s10, 0x10000000
  s_mov_b32 s11, 0x20000
  s_mov_b32 s12, s44
  s_mov_b32 s13, s45
  s_mov_b32 s14, 5308416
  s_mov_b32 s15, 0x20000
  s_mul_hi_u32 s20, s16, 0x1c71c71d
  s_mul_i32 s21, s20, 9
  s_sub_u32 s21, s16, s21
  s_and_b32 s22, s18, 1
  s_lshl_b32 s22, s22, 3
  v_xor_b32 v2, s22, v1
  v_xor_b32 v3, 0, v2
  v_lshlrev_b32 v3, 4, v3
  v_xor_b32 v4, 2, v2
  v_lshlrev_b32 v4, 4, v4
  v_xor_b32 v5, 4, v2
  v_lshlrev_b32 v5, 4, v5
  v_xor_b32 v6, 6, v2
  v_lshlrev_b32 v6, 4, v6
  s_lshl_b32 s23, s20, 5
  s_lshl_b32 s24, s18, 3
  s_add_u32 s23, s23, s24
  s_mul_i32 s23, s23, 9216
  s_lshl_b32 s24, s21, 10
  s_add_u32 s23, s23, s24
  s_lshl_b32 s19, s18, 13
  s_add_u32 m0, s19, 0
  s_nop 0
  buffer_load_dwordx4 v3, s[12:15], s23 offen lds
  s_add_u32 m0, s19, 1024
  s_add_u32 s23, s23, 9216
  buffer_load_dwordx4 v4, s[12:15], s23 offen lds
  s_add_u32 m0, s19, 2048
  s_add_u32 s23, s23, 9216
  buffer_load_dwordx4 v5, s[12:15], s23 offen lds
  s_add_u32 m0, s19, 3072
  s_add_u32 s23, s23, 9216
  buffer_load_dwordx4 v6, s[12:15], s23 offen lds
  s_add_u32 m0, s19, 4096
  s_add_u32 s23, s23, 9216
  buffer_load_dwordx4 v3, s[12:15], s23 offen lds
  s_add_u32 m0, s19, 5120
  s_add_u32 s23, s23, 9216
  buffer_load_dwordx4 v4, s[12:15], s23 offen lds
  s_add_u32 m0, s19, 6144
  s_add_u32 s23, s23, 9216
  buffer_load_dwordx4 v5, s[12:15], s23 offen lds
  s_add_u32 m0, s19, 7168
  s_add_u32 s23, s23, 9216
  buffer_load_dwordx4 v6, s[12:15], s23 offen lds
  v_lshrrev_b32 v8, 4, v1
  v_bfe_u32 v9, v1, 2, 2
  v_lshl_add_u32 v10, v8, 3, v9
  v_lshlrev_b32 v10, 10, v10
  v_and_b32 v8, 1, v8
  v_lshl_add_u32 v8, v8, 2, v9
  v_lshl_add_u32 v10, v8, 5, v10
  v_and_b32 v8, 3, v1
  v_lshl_add_u32 v10, v8, 3, v10
  v_lshlrev_b32 v11, 4, v1
  s_lshl_b32 s24, s18, 8
  v_xor_b32 v10, s24, v10
  v_xor_b32 v12, 0, v10
  v_xor_b32 v13, 32, v10
  v_xor_b32 v14, 64, v10
  v_xor_b32 v15, 96, v10
  v_xor_b32 v16, 128, v10
  v_xor_b32 v17, 160, v10
  v_xor_b32 v18, 192, v10
  v_xor_b32 v19, 224, v10
  s_mov_b32 s34, s20
  s_add_u32 s35, s20, 36
  s_lshl_b32 s26, s21, 5
  s_lshl_b32 s27, s18, 3
  s_add_u32 s26, s26, s27
  s_add_u32 s26, s26, 0
  s_mul_hi_u32 s27, s26, 0x55555556
  s_mul_i32 s28, s27, 3
  s_sub_u32 s28, s26, s28
  s_mul_hi_u32 s26, s27, 0x55555556
  s_mul_i32 s29, s26, 3
  s_sub_u32 s29, s27, s29
  s_mul_i32 s27, s29, 18
  s_add_u32 s27, s27, s34
  s_cmp_eq_u32 s29, 2
  s_cselect_b32 s27, s35, s27
  s_mul_i32 s27, s27, 3
  s_add_u32 s27, s27, s28
  s_lshl_b32 s27, s27, 10
  s_mul_i32 s26, s26, 165888
  s_add_u32 s27, s27, s26
  s_add_u32 s46, s27, 0x940000
  s_lshl_b32 s26, s21, 5
  s_lshl_b32 s27, s18, 3
  s_add_u32 s26, s26, s27
  s_add_u32 s26, s26, 1
  s_mul_hi_u32 s27, s26, 0x55555556
  s_mul_i32 s28, s27, 3
  s_sub_u32 s28, s26, s28
  s_mul_hi_u32 s26, s27, 0x55555556
  s_mul_i32 s29, s26, 3
  s_sub_u32 s29, s27, s29
  s_mul_i32 s27, s29, 18
  s_add_u32 s27, s27, s34
  s_cmp_eq_u32 s29, 2
  s_cselect_b32 s27, s35, s27
  s_mul_i32 s27, s27, 3
  s_add_u32 s27, s27, s28
  s_lshl_b32 s27, s27, 10
  s_mul_i32 s26, s26, 165888
  s_add_u32 s27, s27, s26
  s_add_u32 s47, s27, 0x940000
  s_lshl_b32 s26, s21, 5
  s_lshl_b32 s27, s18, 3
  s_add_u32 s26, s26, s27
  s_add_u32 s26, s26, 2
  s_mul_hi_u32 s27, s26, 0x55555556
  s_mul_i32 s28, s27, 3
  s_sub_u32 s28, s26, s28
  s_mul_hi_u32 s26, s27, 0x55555556
  s_mul_i32 s29, s26, 3
  s_sub_u32 s29, s27, s29
  s_mul_i32 s27, s29, 18
  s_add_u32 s27, s27, s34
  s_cmp_eq_u32 s29, 2
  s_cselect_b32 s27, s35, s27
  s_mul_i32 s27, s27, 3
  s_add_u32 s27, s27, s28
  s_lshl_b32 s27, s27, 10
  s_mul_i32 s26, s26, 165888
  s_add_u32 s27, s27, s26
  s_add_u32 s48, s27, 0x940000
  s_lshl_b32 s26, s21, 5
  s_lshl_b32 s27, s18, 3
  s_add_u32 s26, s26, s27
  s_add_u32 s26, s26, 3
  s_mul_hi_u32 s27, s26, 0x55555556
  s_mul_i32 s28, s27, 3
  s_sub_u32 s28, s26, s28
  s_mul_hi_u32 s26, s27, 0x55555556
  s_mul_i32 s29, s26, 3
  s_sub_u32 s29, s27, s29
  s_mul_i32 s27, s29, 18
  s_add_u32 s27, s27, s34
  s_cmp_eq_u32 s29, 2
  s_cselect_b32 s27, s35, s27
  s_mul_i32 s27, s27, 3
  s_add_u32 s27, s27, s28
  s_lshl_b32 s27, s27, 10
  s_mul_i32 s26, s26, 165888
  s_add_u32 s27, s27, s26
  s_add_u32 s49, s27, 0x940000
  s_lshl_b32 s26, s21, 5
  s_lshl_b32 s27, s18, 3
  s_add_u32 s26, s26, s27
  s_add_u32 s26, s26, 4
  s_mul_hi_u32 s27, s26, 0x55555556
  s_mul_i32 s28, s27, 3
  s_sub_u32 s28, s26, s28
  s_mul_hi_u32 s26, s27, 0x55555556
  s_mul_i32 s29, s26, 3
  s_sub_u32 s29, s27, s29
  s_mul_i32 s27, s29, 18
  s_add_u32 s27, s27, s34
  s_cmp_eq_u32 s29, 2
  s_cselect_b32 s27, s35, s27
  s_mul_i32 s27, s27, 3
  s_add_u32 s27, s27, s28
  s_lshl_b32 s27, s27, 10
  s_mul_i32 s26, s26, 165888
  s_add_u32 s27, s27, s26
  s_add_u32 s50, s27, 0x940000
  s_lshl_b32 s26, s21, 5
  s_lshl_b32 s27, s18, 3
  s_add_u32 s26, s26, s27
  s_add_u32 s26, s26, 5
  s_mul_hi_u32 s27, s26, 0x55555556
  s_mul_i32 s28, s27, 3
  s_sub_u32 s28, s26, s28
  s_mul_hi_u32 s26, s27, 0x55555556
  s_mul_i32 s29, s26, 3
  s_sub_u32 s29, s27, s29
  s_mul_i32 s27, s29, 18
  s_add_u32 s27, s27, s34
  s_cmp_eq_u32 s29, 2
  s_cselect_b32 s27, s35, s27
  s_mul_i32 s27, s27, 3
  s_add_u32 s27, s27, s28
  s_lshl_b32 s27, s27, 10
  s_mul_i32 s26, s26, 165888
  s_add_u32 s27, s27, s26
  s_add_u32 s51, s27, 0x940000
  s_lshl_b32 s26, s21, 5
  s_lshl_b32 s27, s18, 3
  s_add_u32 s26, s26, s27
  s_add_u32 s26, s26, 6
  s_mul_hi_u32 s27, s26, 0x55555556
  s_mul_i32 s28, s27, 3
  s_sub_u32 s28, s26, s28
  s_mul_hi_u32 s26, s27, 0x55555556
  s_mul_i32 s29, s26, 3
  s_sub_u32 s29, s27, s29
  s_mul_i32 s27, s29, 18
  s_add_u32 s27, s27, s34
  s_cmp_eq_u32 s29, 2
  s_cselect_b32 s27, s35, s27
  s_mul_i32 s27, s27, 3
  s_add_u32 s27, s27, s28
  s_lshl_b32 s27, s27, 10
  s_mul_i32 s26, s26, 165888
  s_add_u32 s27, s27, s26
  s_add_u32 s52, s27, 0x940000
  s_lshl_b32 s26, s21, 5
  s_lshl_b32 s27, s18, 3
  s_add_u32 s26, s26, s27
  s_add_u32 s26, s26, 7
  s_mul_hi_u32 s27, s26, 0x55555556
  s_mul_i32 s28, s27, 3
  s_sub_u32 s28, s26, s28
  s_mul_hi_u32 s26, s27, 0x55555556
  s_mul_i32 s29, s26, 3
  s_sub_u32 s29, s27, s29
  s_mul_i32 s27, s29, 18
  s_add_u32 s27, s27, s34
  s_cmp_eq_u32 s29, 2
  s_cselect_b32 s27, s35, s27
  s_mul_i32 s27, s27, 3
  s_add_u32 s27, s27, s28
  s_lshl_b32 s27, s27, 10
  s_mul_i32 s26, s26, 165888
  s_add_u32 s27, s27, s26
  s_add_u32 s53, s27, 0x940000
  s_waitcnt vmcnt(0)
  s_barrier
  ds_read_b64_tr_b16 v[24:25], v12
  ds_read_b64_tr_b16 v[26:27], v12 offset:4096
  ds_read_b64_tr_b16 v[28:29], v13
  ds_read_b64_tr_b16 v[30:31], v13 offset:4096
  ds_read_b64_tr_b16 v[32:33], v14
  ds_read_b64_tr_b16 v[34:35], v14 offset:4096
  ds_read_b64_tr_b16 v[36:37], v15
  ds_read_b64_tr_b16 v[38:39], v15 offset:4096
  ds_read_b64_tr_b16 v[40:41], v16
  ds_read_b64_tr_b16 v[42:43], v16 offset:4096
  ds_read_b64_tr_b16 v[44:45], v17
  ds_read_b64_tr_b16 v[46:47], v17 offset:4096
  ds_read_b64_tr_b16 v[48:49], v18
  ds_read_b64_tr_b16 v[50:51], v18 offset:4096
  s_waitcnt lgkmcnt(12)
  buffer_store_dwordx4 v[24:27], v11, s[8:11], s46 offen sc1
  ds_read_b64_tr_b16 v[52:53], v19
  ds_read_b64_tr_b16 v[54:55], v19 offset:4096
  s_waitcnt lgkmcnt(12)
  buffer_store_dwordx4 v[28:31], v11, s[8:11], s47 offen sc1
  s_waitcnt lgkmcnt(10)
  buffer_store_dwordx4 v[32:35], v11, s[8:11], s48 offen sc1
  s_waitcnt lgkmcnt(8)
  buffer_store_dwordx4 v[36:39], v11, s[8:11], s49 offen sc1
  s_waitcnt lgkmcnt(6)
  buffer_store_dwordx4 v[40:43], v11, s[8:11], s50 offen sc1
  s_waitcnt lgkmcnt(4)
  buffer_store_dwordx4 v[44:47], v11, s[8:11], s51 offen sc1
  s_waitcnt lgkmcnt(2)
  buffer_store_dwordx4 v[48:51], v11, s[8:11], s52 offen sc1
  s_waitcnt lgkmcnt(0)
  buffer_store_dwordx4 v[52:55], v11, s[8:11], s53 offen sc1
k1_kernel_end:
  s_endpgm
.globl k2_kernel
.p2align 8
.type k2_kernel,@function
k2_kernel:
  s_cmp_ge_u32 s2, 432
  s_cbranch_scc1 k2_kernel_end
  s_add_u32 s58, s2, 288
  s_sub_u32 s59, s2, 144
  s_cmp_lt_u32 s2, 144
  s_cselect_b32 s2, s58, s59
  s_load_dwordx2 s[4:5], s[0:1], 80
  s_load_dwordx2 s[6:7], s[0:1], 32
  s_load_dwordx2 s[36:37], s[0:1], 48
  v_and_b32 v1, 63, v0
  v_lshrrev_b32 v2, 6, v0
  s_nop 0
  v_readfirstlane_b32 s18, v2
  s_cmp_ge_u32 s2, 288
  s_cbranch_scc1 k2_kernel_swz
  s_setprio 3
  v_and_b32 v2, 15, v1
  v_lshrrev_b32 v3, 4, v1
  v_lshlrev_b32 v4, 4, v1
  v_cvt_f32_u32 v6, v2
  v_lshlrev_b32 v7, 2, v3
  v_cvt_f32_u32 v7, v7
  s_lshl_b32 s25, s18, 4
  v_cvt_f32_u32 v15, s25
  v_add_f32 v160, 0x00000000, v6
  v_mul_f32 v160, 0x3d000000, v160
  v_add_f32 v9, 0x00000000, v7
  v_mul_f32 v8, v160, v9
  v_mov_b32 v10, v8
  v_fmamk_f32 v11, v160, 0x3f800000, v8
  v_fmamk_f32 v12, v160, 0x40000000, v8
  v_fmamk_f32 v13, v160, 0x40400000, v8
  v_cos_f32 v152, v10
  v_cos_f32 v153, v11
  v_cos_f32 v154, v12
  v_cos_f32 v155, v13
  v_sin_f32 v156, v10
  v_sin_f32 v157, v11
  v_sin_f32 v158, v12
  v_sin_f32 v159, v13
  v_cvt_pk_bf16_f32 v18, v152, v153
  v_cvt_pk_bf16_f32 v19, v154, v155
  v_cvt_pk_bf16_f32 v20, v156, v157
  v_cvt_pk_bf16_f32 v21, v158, v159
  v_xor_b32 v16, 0x80008000, v20
  v_xor_b32 v17, 0x80008000, v21
  v_add_f32 v9, 0x41800000, v7
  v_mul_f32 v8, v160, v9
  v_mov_b32 v10, v8
  v_fmamk_f32 v11, v160, 0x3f800000, v8
  v_fmamk_f32 v12, v160, 0x40000000, v8
  v_fmamk_f32 v13, v160, 0x40400000, v8
  v_cos_f32 v152, v10
  v_cos_f32 v153, v11
  v_cos_f32 v154, v12
  v_cos_f32 v155, v13
  v_sin_f32 v156, v10
  v_sin_f32 v157, v11
  v_sin_f32 v158, v12
  v_sin_f32 v159, v13
  v_cvt_pk_bf16_f32 v24, v152, v153
  v_cvt_pk_bf16_f32 v25, v154, v155
  v_cvt_pk_bf16_f32 v26, v156, v157
  v_cvt_pk_bf16_f32 v27, v158, v159
  v_xor_b32 v22, 0x80008000, v26
  v_xor_b32 v23, 0x80008000, v27
  v_add_f32 v160, 0x41800000, v6
  v_mul_f32 v160, 0x3d000000, v160
  v_add_f32 v9, 0x00000000, v7
  v_mul_f32 v8, v160, v9
  v_mov_b32 v10, v8
  v_fmamk_f32 v11, v160, 0x3f800000, v8
  v_fmamk_f32 v12, v160, 0x40000000, v8
  v_fmamk_f32 v13, v160, 0x40400000, v8
  v_cos_f32 v152, v10
  v_cos_f32 v153, v11
  v_cos_f32 v154, v12
  v_cos_f32 v155, v13
  v_sin_f32 v156, v10
  v_sin_f32 v157, v11
  v_sin_f32 v158, v12
  v_sin_f32 v159, v13
  v_cvt_pk_bf16_f32 v30, v152, v153
  s_waitcnt lgkmcnt(0)
  s_mov_b32 s8, s4
  s_mov_b32 s9, s5
  s_mov_b32 s10, 0x10000000
  s_mov_b32 s11, 0x20000
  s_lshl_b32 s20, s2, 13
  s_lshl_b32 s21, s18, 11
  s_add_u32 s22, s20, s21
  s_add_u32 s23, s22, 0x0
  s_mov_b32 m0, s21
  s_nop 0
  buffer_load_dwordx4 v4, s[8:11], s23 offen lds
  s_add_u32 m0, s21, 1024
  s_add_u32 s23, s23, 1024
  buffer_load_dwordx4 v4, s[8:11], s23 offen lds
  v_lshlrev_b32 v5, 3, v1
  s_add_u32 s24, s22, 0x700000
  buffer_load_dwordx2 v[96:97], v5, s[8:11], s24 offen offset:0
  buffer_load_dwordx2 v[98:99], v5, s[8:11], s24 offen offset:512
  buffer_load_dwordx2 v[100:101], v5, s[8:11], s24 offen offset:1024
  buffer_load_dwordx2 v[102:103], v5, s[8:11], s24 offen offset:1536
  v_cvt_pk_bf16_f32 v31, v154, v155
  v_cvt_pk_bf16_f32 v32, v156, v157
  v_cvt_pk_bf16_f32 v33, v158, v159
  v_xor_b32 v28, 0x80008000, v32
  v_xor_b32 v29, 0x80008000, v33
  v_add_f32 v9, 0x41800000, v7
  v_mul_f32 v8, v160, v9
  v_mov_b32 v10, v8
  v_fmamk_f32 v11, v160, 0x3f800000, v8
  v_fmamk_f32 v12, v160, 0x40000000, v8
  v_fmamk_f32 v13, v160, 0x40400000, v8
  v_cos_f32 v152, v10
  v_cos_f32 v153, v11
  v_cos_f32 v154, v12
  v_cos_f32 v155, v13
  v_sin_f32 v156, v10
  v_sin_f32 v157, v11
  v_sin_f32 v158, v12
  v_sin_f32 v159, v13
  v_cvt_pk_bf16_f32 v36, v152, v153
  v_cvt_pk_bf16_f32 v37, v154, v155
  v_cvt_pk_bf16_f32 v38, v156, v157
  v_cvt_pk_bf16_f32 v39, v158, v159
  v_xor_b32 v34, 0x80008000, v38
  v_xor_b32 v35, 0x80008000, v39
  v_add_f32 v160, v15, v6
  v_mul_f32 v160, 0x3c800000, v160
  v_add_f32 v9, 0x00000000, v7
  v_mul_f32 v8, v160, v9
  v_mov_b32 v10, v8
  v_fmamk_f32 v11, v160, 0x3f800000, v8
  v_fmamk_f32 v12, v160, 0x40000000, v8
  v_fmamk_f32 v13, v160, 0x40400000, v8
  v_cos_f32 v152, v10
  v_cos_f32 v153, v11
  v_cos_f32 v154, v12
  v_cos_f32 v155, v13
  v_sin_f32 v156, v10
  v_sin_f32 v157, v11
  v_sin_f32 v158, v12
  v_sin_f32 v159, v13
  v_cvt_pk_bf16_f32 v42, v152, v153
  v_cvt_pk_bf16_f32 v43, v154, v155
  v_cvt_pk_bf16_f32 v44, v156, v157
  v_cvt_pk_bf16_f32 v45, v158, v159
  v_xor_b32 v40, 0x80008000, v44
  v_xor_b32 v41, 0x80008000, v45
  v_add_f32 v9, 0x41800000, v7
  v_mul_f32 v8, v160, v9
  v_mov_b32 v10, v8
  v_fmamk_f32 v11, v160, 0x3f800000, v8
  v_fmamk_f32 v12, v160, 0x40000000, v8
  v_fmamk_f32 v13, v160, 0x40400000, v8
  v_cos_f32 v152, v10
  v_cos_f32 v153, v11
  v_cos_f32 v154, v12
  v_cos_f32 v155, v13
  v_sin_f32 v156, v10
  v_sin_f32 v157, v11
  v_sin_f32 v158, v12
  v_sin_f32 v159, v13
  v_cvt_pk_bf16_f32 v48, v152, v153
  v_cvt_pk_bf16_f32 v49, v154, v155
  v_cvt_pk_bf16_f32 v50, v156, v157
  v_cvt_pk_bf16_f32 v51, v158, v159
  v_xor_b32 v46, 0x80008000, v50
  v_xor_b32 v47, 0x80008000, v51
  v_add_f32 v9, 0x42000000, v7
  v_mul_f32 v8, v160, v9
  v_mov_b32 v10, v8
  v_fmamk_f32 v11, v160, 0x3f800000, v8
  v_fmamk_f32 v12, v160, 0x40000000, v8
  v_fmamk_f32 v13, v160, 0x40400000, v8
  v_cos_f32 v152, v10
  v_cos_f32 v153, v11
  v_cos_f32 v154, v12
  v_cos_f32 v155, v13
  v_sin_f32 v156, v10
  v_sin_f32 v157, v11
  v_sin_f32 v158, v12
  v_sin_f32 v159, v13
  v_cvt_pk_bf16_f32 v54, v152, v153
  v_cvt_pk_bf16_f32 v55, v154, v155
  v_cvt_pk_bf16_f32 v56, v156, v157
  v_cvt_pk_bf16_f32 v57, v158, v159
  v_xor_b32 v52, 0x80008000, v56
  v_xor_b32 v53, 0x80008000, v57
  v_add_f32 v9, 0x42400000, v7
  v_mul_f32 v8, v160, v9
  v_mov_b32 v10, v8
  v_fmamk_f32 v11, v160, 0x3f800000, v8
  v_fmamk_f32 v12, v160, 0x40000000, v8
  v_fmamk_f32 v13, v160, 0x40400000, v8
  v_cos_f32 v152, v10
  v_cos_f32 v153, v11
  v_cos_f32 v154, v12
  v_cos_f32 v155, v13
  v_sin_f32 v156, v10
  v_sin_f32 v157, v11
  v_sin_f32 v158, v12
  v_sin_f32 v159, v13
  v_cvt_pk_bf16_f32 v60, v152, v153
  v_cvt_pk_bf16_f32 v61, v154, v155
  v_cvt_pk_bf16_f32 v62, v156, v157
  v_cvt_pk_bf16_f32 v63, v158, v159
  v_xor_b32 v58, 0x80008000, v62
  v_xor_b32 v59, 0x80008000, v63
  v_add_f32 v9, v15, v7
  v_add_f32 v160, 0x00000000, v6
  v_mul_f32 v160, 0x3a000000, v160
  v_mul_f32 v8, v160, v9
  v_mov_b32 v10, v8
  v_fmamk_f32 v11, v160, 0x3f800000, v8
  v_fmamk_f32 v12, v160, 0x40000000, v8
  v_fmamk_f32 v13, v160, 0x40400000, v8
  v_cos_f32 v64, v10
  v_cos_f32 v65, v11
  v_cos_f32 v66, v12
  v_cos_f32 v67, v13
  v_sin_f32 v68, v10
  v_sin_f32 v69, v11
  v_sin_f32 v70, v12
  v_sin_f32 v71, v13
  v_add_f32 v160, 0x41800000, v6
  v_mul_f32 v160, 0x3a000000, v160
  v_mul_f32 v8, v160, v9
  v_mov_b32 v10, v8
  v_fmamk_f32 v11, v160, 0x3f800000, v8
  v_fmamk_f32 v12, v160, 0x40000000, v8
  v_fmamk_f32 v13, v160, 0x40400000, v8
  v_cos_f32 v72, v10
  v_cos_f32 v73, v11
  v_cos_f32 v74, v12
  v_cos_f32 v75, v13
  v_sin_f32 v76, v10
  v_sin_f32 v77, v11
  v_sin_f32 v78, v12
  v_sin_f32 v79, v13
  v_add_f32 v160, v15, v6
  v_mul_f32 v160, 0x3a000000, v160
  v_add_f32 v9, 0x00000000, v7
  v_mul_f32 v8, v160, v9
  v_mov_b32 v10, v8
  v_fmamk_f32 v11, v160, 0x3f800000, v8
  v_fmamk_f32 v12, v160, 0x40000000, v8
  v_fmamk_f32 v13, v160, 0x40400000, v8
  v_cos_f32 v80, v10
  v_cos_f32 v81, v11
  v_cos_f32 v82, v12
  v_cos_f32 v83, v13
  v_sin_f32 v84, v10
  v_sin_f32 v85, v11
  v_sin_f32 v86, v12
  v_sin_f32 v87, v13
  v_add_f32 v9, 0x41800000, v7
  v_mul_f32 v8, v160, v9
  v_mov_b32 v10, v8
  v_fmamk_f32 v11, v160, 0x3f800000, v8
  v_fmamk_f32 v12, v160, 0x40000000, v8
  v_fmamk_f32 v13, v160, 0x40400000, v8
  v_cos_f32 v88, v10
  v_cos_f32 v89, v11
  v_cos_f32 v90, v12
  v_cos_f32 v91, v13
  v_sin_f32 v92, v10
  v_sin_f32 v93, v11
  v_sin_f32 v94, v12
  v_sin_f32 v95, v13
  v_lshrrev_b32 v10, 2, v2
  v_lshl_add_u32 v10, v3, 2, v10
  v_lshlrev_b32 v10, 7, v10
  v_and_b32 v11, 3, v2
  v_lshl_add_u32 v10, v11, 3, v10
  s_lshl_b32 s25, s18, 5
  v_add_u32 v5, s25, v10
  v_add_u32 v6, s21, v4
  s_waitcnt vmcnt(4)
  s_barrier
  ds_read_b64_tr_b16 v[104:105], v5 offset:0
  ds_read_b64_tr_b16 v[106:107], v5 offset:4096
  ds_read_b64_tr_b16 v[108:109], v5 offset:2048
  ds_read_b64_tr_b16 v[110:111], v5 offset:6144
  s_waitcnt lgkmcnt(0)
  v_mfma_f32_16x16x32_bf16 v[136:139], v[104:107], v[18:21], 0
  v_mfma_f32_16x16x32_bf16 v[144:147], v[104:107], v[16:19], 0
  v_mfma_f32_16x16x32_bf16 v[140:143], v[104:107], v[30:33], 0
  v_mfma_f32_16x16x32_bf16 v[148:151], v[104:107], v[28:31], 0
  v_mfma_f32_16x16x32_bf16 v[136:139], v[108:111], v[24:27], v[136:139]
  v_mfma_f32_16x16x32_bf16 v[144:147], v[108:111], v[22:25], v[144:147]
  v_mfma_f32_16x16x32_bf16 v[140:143], v[108:111], v[36:39], v[140:143]
  v_mfma_f32_16x16x32_bf16 v[148:151], v[108:111], v[34:37], v[148:151]
  s_nop 7
  v_mul_f32 v152, v136, v64
  v_mul_f32 v156, v144, v64
  v_mul_f32 v153, v137, v65
  v_mul_f32 v157, v145, v65
  v_mul_f32 v154, v138, v66
  v_mul_f32 v158, v146, v66
  v_mul_f32 v155, v139, v67
  v_mul_f32 v159, v147, v67
  v_fma_f32 v152, v144, v68, v152
  v_fma_f32 v156, -v136, v68, v156
  v_fma_f32 v153, v145, v69, v153
  v_fma_f32 v157, -v137, v69, v157
  v_fma_f32 v154, v146, v70, v154
  v_fma_f32 v158, -v138, v70, v158
  v_fma_f32 v155, v147, v71, v155
  v_fma_f32 v159, -v139, v71, v159
  v_cvt_pk_bf16_f32 v160, v152, v153
  v_cvt_pk_bf16_f32 v161, v154, v155
  v_cvt_pk_bf16_f32 v162, v156, v157
  v_cvt_pk_bf16_f32 v163, v158, v159
  v_mul_f32 v152, v140, v72
  v_mul_f32 v156, v148, v72
  v_mul_f32 v153, v141, v73
  v_mul_f32 v157, v149, v73
  v_mul_f32 v154, v142, v74
  v_mul_f32 v158, v150, v74
  v_mul_f32 v155, v143, v75
  v_mul_f32 v159, v151, v75
  v_fma_f32 v152, v148, v76, v152
  v_fma_f32 v156, -v140, v76, v156
  v_fma_f32 v153, v149, v77, v153
  v_fma_f32 v157, -v141, v77, v157
  v_fma_f32 v154, v150, v78, v154
  v_fma_f32 v158, -v142, v78, v158
  v_fma_f32 v155, v151, v79, v155
  v_fma_f32 v159, -v143, v79, v159
  v_cvt_pk_bf16_f32 v164, v152, v153
  v_cvt_pk_bf16_f32 v165, v154, v155
  v_cvt_pk_bf16_f32 v166, v156, v157
  v_cvt_pk_bf16_f32 v167, v158, v159
  ds_write_b128 v6, v[160:163] offset:8192
  ds_write_b128 v6, v[164:167] offset:9216
  s_waitcnt vmcnt(0)
  v_lshlrev_b32 v64, 16, v96
  v_and_b32 v65, 0xffff0000, v96
  v_lshlrev_b32 v66, 16, v98
  v_and_b32 v67, 0xffff0000, v98
  v_lshlrev_b32 v68, 16, v100
  v_and_b32 v69, 0xffff0000, v100
  v_lshlrev_b32 v70, 16, v102
  v_and_b32 v71, 0xffff0000, v102
  v_lshlrev_b32 v72, 16, v97
  v_and_b32 v73, 0xffff0000, v97
  v_lshlrev_b32 v74, 16, v99
  v_and_b32 v75, 0xffff0000, v99
  v_lshlrev_b32 v76, 16, v101
  v_and_b32 v77, 0xffff0000, v101
  v_lshlrev_b32 v78, 16, v103
  v_and_b32 v79, 0xffff0000, v103
  s_waitcnt lgkmcnt(0)
  s_barrier
  ds_read_b128 v[104:107], v4 offset:8192
  ds_read_b128 v[108:111], v4 offset:9216
  ds_read_b128 v[112:115], v4 offset:10240
  ds_read_b128 v[116:119], v4 offset:11264
  ds_read_b128 v[120:123], v4 offset:12288
  ds_read_b128 v[124:127], v4 offset:13312
  ds_read_b128 v[128:131], v4 offset:14336
  ds_read_b128 v[132:135], v4 offset:15360
  s_waitcnt lgkmcnt(6)
  v_mfma_f32_16x16x32_bf16 v[136:139], v[42:45], v[104:107], 0
  v_mfma_f32_16x16x32_bf16 v[144:147], v[40:43], v[104:107], 0
  v_mfma_f32_16x16x32_bf16 v[140:143], v[42:45], v[108:111], 0
  v_mfma_f32_16x16x32_bf16 v[148:151], v[40:43], v[108:111], 0
  s_waitcnt lgkmcnt(4)
  v_mfma_f32_16x16x32_bf16 v[136:139], v[48:51], v[112:115], v[136:139]
  v_mfma_f32_16x16x32_bf16 v[144:147], v[46:49], v[112:115], v[144:147]
  v_mfma_f32_16x16x32_bf16 v[140:143], v[48:51], v[116:119], v[140:143]
  v_mfma_f32_16x16x32_bf16 v[148:151], v[46:49], v[116:119], v[148:151]
  s_waitcnt lgkmcnt(2)
  v_mfma_f32_16x16x32_bf16 v[136:139], v[54:57], v[120:123], v[136:139]
  v_mfma_f32_16x16x32_bf16 v[144:147], v[52:55], v[120:123], v[144:147]
  v_mfma_f32_16x16x32_bf16 v[140:143], v[54:57], v[124:127], v[140:143]
  v_mfma_f32_16x16x32_bf16 v[148:151], v[52:55], v[124:127], v[148:151]
  s_waitcnt lgkmcnt(0)
  v_mfma_f32_16x16x32_bf16 v[136:139], v[60:63], v[128:131], v[136:139]
  v_mfma_f32_16x16x32_bf16 v[144:147], v[58:61], v[128:131], v[144:147]
  v_mfma_f32_16x16x32_bf16 v[140:143], v[60:63], v[132:135], v[140:143]
  v_mfma_f32_16x16x32_bf16 v[148:151], v[58:61], v[132:135], v[148:151]
  s_nop 7
  v_mul_f32 v152, v136, v64
  v_mul_f32_e64 v156, -v136, v68
  v_mul_f32 v153, v137, v65
  v_mul_f32_e64 v157, -v137, v69
  v_mul_f32 v154, v138, v66
  v_mul_f32_e64 v158, -v138, v70
  v_mul_f32 v155, v139, v67
  v_mul_f32_e64 v159, -v139, v71
  v_fma_f32 v152, -v144, v68, v152
  v_fma_f32 v156, -v144, v64, v156
  v_fma_f32 v153, -v145, v69, v153
  v_fma_f32 v157, -v145, v65, v157
  v_fma_f32 v154, -v146, v70, v154
  v_fma_f32 v158, -v146, v66, v158
  v_fma_f32 v155, -v147, v71, v155
  v_fma_f32 v159, -v147, v67, v159
  v_cvt_pk_bf16_f32 v160, v152, v153
  v_cvt_pk_bf16_f32 v161, v154, v155
  v_cvt_pk_bf16_f32 v162, v156, v157
  v_cvt_pk_bf16_f32 v163, v158, v159
  v_mul_f32 v152, v140, v72
  v_mul_f32_e64 v156, -v140, v76
  v_mul_f32 v153, v141, v73
  v_mul_f32_e64 v157, -v141, v77
  v_mul_f32 v154, v142, v74
  v_mul_f32_e64 v158, -v142, v78
  v_mul_f32 v155, v143, v75
  v_mul_f32_e64 v159, -v143, v79
  v_fma_f32 v152, -v148, v76, v152
  v_fma_f32 v156, -v148, v72, v156
  v_fma_f32 v153, -v149, v77, v153
  v_fma_f32 v157, -v149, v73, v157
  v_fma_f32 v154, -v150, v78, v154
  v_fma_f32 v158, -v150, v74, v158
  v_fma_f32 v155, -v151, v79, v155
  v_fma_f32 v159, -v151, v75, v159
  v_cvt_pk_bf16_f32 v164, v152, v153
  v_cvt_pk_bf16_f32 v165, v154, v155
  v_cvt_pk_bf16_f32 v166, v156, v157
  v_cvt_pk_bf16_f32 v167, v158, v159
  ds_write_b128 v6, v[160:163] offset:16384
  ds_write_b128 v6, v[164:167] offset:17408
  s_waitcnt lgkmcnt(0)
  s_barrier
  ds_read_b128 v[104:107], v4 offset:16384
  ds_read_b128 v[108:111], v4 offset:17408
  ds_read_b128 v[112:115], v4 offset:18432
  ds_read_b128 v[116:119], v4 offset:19456
  ds_read_b128 v[120:123], v4 offset:20480
  ds_read_b128 v[124:127], v4 offset:21504
  ds_read_b128 v[128:131], v4 offset:22528
  ds_read_b128 v[132:135], v4 offset:23552
  s_waitcnt lgkmcnt(6)
  v_mfma_f32_16x16x32_bf16 v[136:139], v[104:107], v[42:45], 0
  v_mfma_f32_16x16x32_bf16 v[144:147], v[104:107], v[40:43], 0
  v_mfma_f32_16x16x32_bf16 v[140:143], v[108:111], v[42:45], 0
  v_mfma_f32_16x16x32_bf16 v[148:151], v[108:111], v[40:43], 0
  s_waitcnt lgkmcnt(4)
  v_mfma_f32_16x16x32_bf16 v[136:139], v[112:115], v[48:51], v[136:139]
  v_mfma_f32_16x16x32_bf16 v[144:147], v[112:115], v[46:49], v[144:147]
  v_mfma_f32_16x16x32_bf16 v[140:143], v[116:119], v[48:51], v[140:143]
  v_mfma_f32_16x16x32_bf16 v[148:151], v[116:119], v[46:49], v[148:151]
  s_waitcnt lgkmcnt(2)
  v_mfma_f32_16x16x32_bf16 v[136:139], v[120:123], v[54:57], v[136:139]
  v_mfma_f32_16x16x32_bf16 v[144:147], v[120:123], v[52:55], v[144:147]
  v_mfma_f32_16x16x32_bf16 v[140:143], v[124:127], v[54:57], v[140:143]
  v_mfma_f32_16x16x32_bf16 v[148:151], v[124:127], v[52:55], v[148:151]
  s_waitcnt lgkmcnt(0)
  v_mfma_f32_16x16x32_bf16 v[136:139], v[128:131], v[60:63], v[136:139]
  v_mfma_f32_16x16x32_bf16 v[144:147], v[128:131], v[58:61], v[144:147]
  v_mfma_f32_16x16x32_bf16 v[140:143], v[132:135], v[60:63], v[140:143]
  v_mfma_f32_16x16x32_bf16 v[148:151], v[132:135], v[58:61], v[148:151]
  s_nop 7
  v_mul_f32 v152, v136, v80
  v_mul_f32 v156, v144, v80
  v_mul_f32 v153, v137, v81
  v_mul_f32 v157, v145, v81
  v_mul_f32 v154, v138, v82
  v_mul_f32 v158, v146, v82
  v_mul_f32 v155, v139, v83
  v_mul_f32 v159, v147, v83
  v_fma_f32 v152, v144, v84, v152
  v_fma_f32 v156, -v136, v84, v156
  v_fma_f32 v153, v145, v85, v153
  v_fma_f32 v157, -v137, v85, v157
  v_fma_f32 v154, v146, v86, v154
  v_fma_f32 v158, -v138, v86, v158
  v_fma_f32 v155, v147, v87, v155
  v_fma_f32 v159, -v139, v87, v159
  v_cvt_pk_bf16_f32 v160, v152, v153
  v_cvt_pk_bf16_f32 v161, v154, v155
  v_cvt_pk_bf16_f32 v162, v156, v157
  v_cvt_pk_bf16_f32 v163, v158, v159
  v_mul_f32 v152, v140, v88
  v_mul_f32 v156, v148, v88
  v_mul_f32 v153, v141, v89
  v_mul_f32 v157, v149, v89
  v_mul_f32 v154, v142, v90
  v_mul_f32 v158, v150, v90
  v_mul_f32 v155, v143, v91
  v_mul_f32 v159, v151, v91
  v_fma_f32 v152, v148, v92, v152
  v_fma_f32 v156, -v140, v92, v156
  v_fma_f32 v153, v149, v93, v153
  v_fma_f32 v157, -v141, v93, v157
  v_fma_f32 v154, v150, v94, v154
  v_fma_f32 v158, -v142, v94, v158
  v_fma_f32 v155, v151, v95, v155
  v_fma_f32 v159, -v143, v95, v159
  v_cvt_pk_bf16_f32 v164, v152, v153
  v_cvt_pk_bf16_f32 v165, v154, v155
  v_cvt_pk_bf16_f32 v166, v156, v157
  v_cvt_pk_bf16_f32 v167, v158, v159
  s_nop 1
  v_mfma_f32_16x16x32_bf16 v[136:139], v[160:163], v[18:21], 0
  v_mfma_f32_16x16x32_bf16 v[144:147], v[160:163], v[16:19], 0
  v_mfma_f32_16x16x32_bf16 v[140:143], v[160:163], v[30:33], 0
  v_mfma_f32_16x16x32_bf16 v[148:151], v[160:163], v[28:31], 0
  v_mfma_f32_16x16x32_bf16 v[136:139], v[164:167], v[24:27], v[136:139]
  v_mfma_f32_16x16x32_bf16 v[144:147], v[164:167], v[22:25], v[144:147]
  v_mfma_f32_16x16x32_bf16 v[140:143], v[164:167], v[36:39], v[140:143]
  v_mfma_f32_16x16x32_bf16 v[148:151], v[164:167], v[34:37], v[148:151]
  v_lshlrev_b32 v10, 7, v2
  v_lshl_add_u32 v10, v3, 3, v10
  s_lshl_b32 s25, s18, 5
  s_add_u32 s25, s25, s20
  s_add_u32 s25, s25, 0x240000
  s_add_u32 s26, s25, 4096
  s_nop 4
  v_cvt_pk_bf16_f32 v152, v136, v137
  v_cvt_pk_bf16_f32 v153, v138, v139
  buffer_store_dwordx2 v[152:153], v10, s[8:11], s25 offen offset:0
  v_cvt_pk_bf16_f32 v154, v140, v141
  v_cvt_pk_bf16_f32 v155, v142, v143
  buffer_store_dwordx2 v[154:155], v10, s[8:11], s25 offen offset:2048
  v_cvt_pk_bf16_f32 v156, v144, v145
  v_cvt_pk_bf16_f32 v157, v146, v147
  buffer_store_dwordx2 v[156:157], v10, s[8:11], s26 offen offset:0
  v_cvt_pk_bf16_f32 v158, v148, v149
  v_cvt_pk_bf16_f32 v159, v150, v151
  buffer_store_dwordx2 v[158:159], v10, s[8:11], s26 offen offset:2048
  s_endpgm
k2_kernel_swz:
  s_sub_u32 s16, s2, 288
  s_waitcnt lgkmcnt(0)
  s_mov_b32 s8, s4
  s_mov_b32 s9, s5
  s_mov_b32 s10, 0x10000000
  s_mov_b32 s11, 0x20000
  s_mov_b32 s14, 5308416
  s_mov_b32 s15, 0x20000
  s_mov_b32 s12, s36
  s_mov_b32 s13, s37
  s_mul_hi_u32 s20, s16, 0xe38e38f
  s_mul_i32 s21, s20, 18
  s_sub_u32 s21, s16, s21
  s_lshl_b32 s26, s21, 5
  s_add_u32 s26, s26, 0
  s_mul_hi_u32 s27, s26, 0x1555556
  s_mul_i32 s28, s27, 192
  s_sub_u32 s28, s26, s28
  s_mul_hi_u32 s29, s28, 0x5555556
  s_mul_i32 s34, s29, 48
  s_sub_u32 s28, s28, s34
  s_mul_i32 s29, s29, 144
  s_mul_i32 s27, s27, 48
  s_add_u32 s28, s28, s29
  s_add_u32 s28, s28, s27
  s_mul_i32 s27, s20, 576
  s_add_u32 s28, s28, s27
  s_mul_i32 s24, s28, 1152
  s_lshl_b32 s26, s21, 5
  s_add_u32 s26, s26, 16
  s_mul_hi_u32 s27, s26, 0x1555556
  s_mul_i32 s28, s27, 192
  s_sub_u32 s28, s26, s28
  s_mul_hi_u32 s29, s28, 0x5555556
  s_mul_i32 s34, s29, 48
  s_sub_u32 s28, s28, s34
  s_mul_i32 s29, s29, 144
  s_mul_i32 s27, s27, 48
  s_add_u32 s28, s28, s29
  s_add_u32 s28, s28, s27
  s_mul_i32 s27, s20, 576
  s_add_u32 s28, s28, s27
  s_mul_i32 s25, s28, 1152
  v_lshlrev_b32 v11, 4, v1
  s_mul_i32 s22, s18, 9
  s_cmp_ge_u32 s18, 2
  s_cselect_b32 s23, s25, s24
  s_cselect_b32 s26, 18, 0
  s_sub_u32 s26, s22, s26
  s_lshl_b32 s26, s26, 10
  s_add_u32 s23, s23, s26
  s_lshl_b32 s19, s22, 10
  s_add_u32 m0, s19, 0
  s_nop 0
  buffer_load_dwordx4 v11, s[12:15], s23 offen lds
  s_add_u32 m0, s19, 1024
  s_add_u32 s23, s23, 1024
  buffer_load_dwordx4 v11, s[12:15], s23 offen lds
  s_add_u32 m0, s19, 2048
  s_add_u32 s23, s23, 1024
  buffer_load_dwordx4 v11, s[12:15], s23 offen lds
  s_add_u32 m0, s19, 3072
  s_add_u32 s23, s23, 1024
  buffer_load_dwordx4 v11, s[12:15], s23 offen lds
  s_add_u32 m0, s19, 4096
  s_add_u32 s23, s23, 1024
  buffer_load_dwordx4 v11, s[12:15], s23 offen lds
  s_add_u32 m0, s19, 5120
  s_add_u32 s23, s23, 1024
  buffer_load_dwordx4 v11, s[12:15], s23 offen lds
  s_add_u32 m0, s19, 6144
  s_add_u32 s23, s23, 1024
  buffer_load_dwordx4 v11, s[12:15], s23 offen lds
  s_add_u32 m0, s19, 7168
  s_add_u32 s23, s23, 1024
  buffer_load_dwordx4 v11, s[12:15], s23 offen lds
  s_add_u32 m0, s19, 8192
  s_add_u32 s23, s23, 1024
  buffer_load_dwordx4 v11, s[12:15], s23 offen lds
  v_lshrrev_b32 v8, 4, v1
  v_bfe_u32 v9, v1, 2, 2
  v_lshl_add_u32 v10, v8, 3, v9
  s_movk_i32 s26, 1152
  v_mul_lo_u32 v10, v10, s26
  v_and_b32 v8, 3, v1
  v_lshl_add_u32 v10, v8, 3, v10
  s_mul_i32 s26, s18, 288
  v_add_u32 v10, s26, v10
  s_mul_hi_u32 s27, s21, 0x2aaaaaab
  s_mul_i32 s28, s27, 6
  s_sub_u32 s28, s21, s28
  s_cmp_eq_u32 s27, 2
  s_cselect_b32 s29, 3, 9
  s_cselect_b32 s34, 18, 3
  s_lshl_b32 s34, s34, 10
  s_mul_i32 s27, s27, 54
  s_mul_i32 s28, s28, s29
  s_add_u32 s27, s27, s28
  s_lshl_b32 s28, s20, 2
  s_add_u32 s28, s28, s18
  s_mul_i32 s28, s28, 162
  s_add_u32 s27, s27, s28
  s_lshl_b32 s27, s27, 10
  s_add_u32 s27, s27, 0xe50000
  s_waitcnt vmcnt(0)
  s_barrier
  ds_read_b64_tr_b16 v[24:25], v10 offset:0
  ds_read_b64_tr_b16 v[26:27], v10 offset:4608
  ds_read_b64_tr_b16 v[28:29], v10 offset:32
  ds_read_b64_tr_b16 v[30:31], v10 offset:4640
  ds_read_b64_tr_b16 v[32:33], v10 offset:64
  ds_read_b64_tr_b16 v[34:35], v10 offset:4672
  ds_read_b64_tr_b16 v[36:37], v10 offset:96
  ds_read_b64_tr_b16 v[38:39], v10 offset:4704
  ds_read_b64_tr_b16 v[40:41], v10 offset:128
  ds_read_b64_tr_b16 v[42:43], v10 offset:4736
  ds_read_b64_tr_b16 v[44:45], v10 offset:160
  ds_read_b64_tr_b16 v[46:47], v10 offset:4768
  ds_read_b64_tr_b16 v[48:49], v10 offset:192
  ds_read_b64_tr_b16 v[50:51], v10 offset:4800
  s_waitcnt lgkmcnt(8)
  ds_read_b64_tr_b16 v[52:53], v10 offset:224
  ds_read_b64_tr_b16 v[54:55], v10 offset:4832
  ds_read_b64_tr_b16 v[56:57], v10 offset:256
  ds_read_b64_tr_b16 v[58:59], v10 offset:4864
  s_waitcnt lgkmcnt(14)
  s_add_u32 s28, s27, 0
  buffer_store_dwordx4 v[24:27], v11, s[8:11], s28 offen sc1
  s_waitcnt lgkmcnt(14)
  s_add_u32 s28, s27, 1024
  buffer_store_dwordx4 v[28:31], v11, s[8:11], s28 offen sc1
  s_waitcnt lgkmcnt(12)
  s_add_u32 s28, s27, 2048
  buffer_store_dwordx4 v[32:35], v11, s[8:11], s28 offen sc1
  s_waitcnt lgkmcnt(10)
  s_add_u32 s27, s27, s34
  s_add_u32 s28, s27, 0
  buffer_store_dwordx4 v[36:39], v11, s[8:11], s28 offen sc1
  s_waitcnt lgkmcnt(8)
  s_add_u32 s28, s27, 1024
  buffer_store_dwordx4 v[40:43], v11, s[8:11], s28 offen sc1
  s_waitcnt lgkmcnt(6)
  s_add_u32 s28, s27, 2048
  buffer_store_dwordx4 v[44:47], v11, s[8:11], s28 offen sc1
  s_waitcnt lgkmcnt(4)
  s_add_u32 s27, s27, s34
  s_add_u32 s28, s27, 0
  buffer_store_dwordx4 v[48:51], v11, s[8:11], s28 offen sc1
  s_waitcnt lgkmcnt(2)
  s_add_u32 s28, s27, 1024
  buffer_store_dwordx4 v[52:55], v11, s[8:11], s28 offen sc1
  s_waitcnt lgkmcnt(0)
  s_add_u32 s28, s27, 2048
  buffer_store_dwordx4 v[56:59], v11, s[8:11], s28 offen sc1
k2_kernel_end:
  s_endpgm
.globl k3_kernel
.p2align 8
.type k3_kernel,@function
k3_kernel:
  s_cmp_ge_u32 s2, 192
  s_cbranch_scc1 k3_kernel_end
  s_load_dwordx2 s[4:5], s[0:1], 80
  s_load_dwordx2 s[6:7], s[0:1], 0
  s_load_dwordx2 s[36:37], s[0:1], 48
  v_and_b32 v1, 63, v0
  v_lshrrev_b32 v2, 6, v0
  s_nop 0
  v_readfirstlane_b32 s18, v2
  s_and_b32 s16, s2, 7
  s_lshr_b32 s17, s2, 3
  s_mul_hi_u32 s19, s17, 0x2aaaaaab
  s_mul_i32 s20, s19, 6
  s_sub_u32 s20, s17, s20
  s_lshl_b32 s19, s19, 3
  s_add_u32 s19, s19, s16
  v_and_b32 v2, 15, v1
  v_lshrrev_b32 v3, 4, v1
  v_bfe_u32 v19, v1, 3, 1
  v_lshl_add_u32 v19, v3, 2, v19
  v_lshlrev_b32 v19, 12, v19
  v_and_b32 v20, 1, v3
  v_lshlrev_b32 v20, 1, v20
  v_and_b32 v21, 7, v1
  v_xor_b32 v21, v21, v20
  v_lshl_add_u32 v4, v21, 4, v19
  v_xor_b32 v5, 64, v4
  s_waitcnt lgkmcnt(0)
  s_mov_b32 s8, s4
  s_mov_b32 s9, s5
  s_mov_b32 s10, 0x10000000
  s_mov_b32 s11, 0x20000
  s_mov_b32 s12, s6
  s_mov_b32 s13, s7
  s_mov_b32 s14, 2359296
  s_mov_b32 s15, 0x20000
  s_mul_i32 s21, s18, 18
  s_cmp_ge_u32 s18, 2
  s_cselect_b32 s22, 36, 0
  s_cselect_b32 s23, 2, 0
  s_sub_u32 s22, s21, s22
  s_lshl_b32 s22, s22, 4
  s_add_u32 s22, s22, s23
  s_lshl_b32 s22, s22, 12
  s_lshl_b32 s23, s19, 7
  s_add_u32 s22, s22, s23
  s_add_u32 s22, s22, 0x240000
  s_lshl_b32 s23, s21, 10
  s_cmp_eq_u32 s18, 3
  s_cbranch_scc1 k3_kernel_w3
  s_add_u32 m0, s23, 0
  s_nop 0
  buffer_load_dwordx4 v4, s[8:11], s22 offen lds
  s_mul_i32 s24, s20, 48
  s_lshl_b32 s25, s18, 4
  s_add_u32 s24, s24, s25
  v_lshrrev_b32 v19, 2, v2
  v_lshl_add_u32 v20, v3, 3, v19
  v_lshlrev_b32 v20, 7, v20
  v_lshrrev_b32 v19, 1, v19
  v_and_b32 v21, 1, v3
  v_lshl_add_u32 v19, v21, 1, v19
  v_lshl_add_u32 v20, v19, 5, v20
  v_and_b32 v19, 3, v2
  v_lshl_add_u32 v20, v19, 3, v20
  v_xor_b32 v6, 0, v20
  v_add_u32 v10, 0x10000, v6
  v_xor_b32 v7, 32, v20
  s_add_u32 m0, s23, 1024
  s_add_u32 s22, s22, 65536
  buffer_load_dwordx4 v5, s[8:11], s22 offen lds
  v_add_u32 v11, 0x10000, v7
  v_xor_b32 v8, 64, v20
  v_add_u32 v12, 0x10000, v8
  v_xor_b32 v9, 96, v20
  v_add_u32 v13, 0x10000, v9
  v_add_u32 v19, s24, v2
  v_and_b32 v22, 1, v19
  v_cvt_f32_u32 v19, v19
  v_mul_f32 v14, 0x3ae38e39, v19
  v_lshlrev_b32 v22, 31, v22
  v_or_b32 v22, 0.5, v22
  v_mul_f32 v19, 0x42000000, v14
  v_fract_f32 v19, v19
  v_cos_f32 v19, v19
  v_lshlrev_b32 v20, 3, v3
  v_cvt_f32_u32 v20, v20
  s_add_u32 m0, s23, 2048
  s_add_u32 s22, s22, 65536
  buffer_load_dwordx4 v4, s[8:11], s22 offen lds
  v_add_f32 v15, v19, v19
  v_mul_f32 v16, v14, v20
  v_add_f32 v21, 0xbe800000, v16
  v_cos_f32 v24, v16
  v_cos_f32 v25, v21
  v_fmamk_f32 v26, v14, 0x40000000, v16
  v_fmamk_f32 v27, v14, 0x40000000, v21
  v_fmamk_f32 v28, v14, 0x40800000, v16
  v_fmamk_f32 v29, v14, 0x40800000, v21
  v_fmamk_f32 v30, v14, 0x40c00000, v16
  v_fmamk_f32 v31, v14, 0x40c00000, v21
  v_cos_f32 v26, v26
  v_cos_f32 v27, v27
  v_cos_f32 v28, v28
  v_cos_f32 v29, v29
  v_cos_f32 v30, v30
  s_add_u32 m0, s23, 3072
  s_add_u32 s22, s22, 65536
  buffer_load_dwordx4 v5, s[8:11], s22 offen lds
  v_cos_f32 v31, v31
  s_nop 0
  v_cmp_eq_u32 vcc, 0, v3
  s_nop 1
  v_cndmask_b32 v40, v24, v22, vcc
  v_cvt_pk_bf16_f32 v44, v40, v25
  v_cvt_pk_bf16_f32 v45, v26, v27
  v_cvt_pk_bf16_f32 v46, v28, v29
  v_cvt_pk_bf16_f32 v47, v30, v31
  v_fmamk_f32 v32, v14, 0x42000000, v16
  v_fmamk_f32 v33, v14, 0x42000000, v21
  v_fmamk_f32 v34, v14, 0x42080000, v16
  v_fmamk_f32 v35, v14, 0x42080000, v21
  v_fmamk_f32 v36, v14, 0x42100000, v16
  v_fmamk_f32 v37, v14, 0x42100000, v21
  v_fmamk_f32 v38, v14, 0x42180000, v16
  v_fmamk_f32 v39, v14, 0x42180000, v21
  v_cos_f32 v32, v32
  s_add_u32 m0, s23, 4096
  s_add_u32 s22, s22, 65536
  buffer_load_dwordx4 v4, s[8:11], s22 offen lds
  v_cos_f32 v33, v33
  v_cos_f32 v34, v34
  v_cos_f32 v35, v35
  v_cos_f32 v36, v36
  v_cos_f32 v37, v37
  v_cos_f32 v38, v38
  v_cos_f32 v39, v39
  s_nop 0
  v_cvt_pk_bf16_f32 v48, v32, v33
  v_cvt_pk_bf16_f32 v49, v34, v35
  v_cvt_pk_bf16_f32 v50, v36, v37
  v_cvt_pk_bf16_f32 v51, v38, v39
  v_fma_f32 v24, v15, v32, -v24
  v_fma_f32 v25, v15, v33, -v25
  v_fma_f32 v26, v15, v34, -v26
  v_fma_f32 v27, v15, v35, -v27
  s_add_u32 m0, s23, 5120
  s_add_u32 s22, s22, 65536
  buffer_load_dwordx4 v5, s[8:11], s22 offen lds
  v_fma_f32 v28, v15, v36, -v28
  v_fma_f32 v29, v15, v37, -v29
  v_fma_f32 v30, v15, v38, -v30
  v_fma_f32 v31, v15, v39, -v31
  v_cvt_pk_bf16_f32 v52, v24, v25
  v_cvt_pk_bf16_f32 v53, v26, v27
  v_cvt_pk_bf16_f32 v54, v28, v29
  v_cvt_pk_bf16_f32 v55, v30, v31
  v_fma_f32 v32, v15, v24, -v32
  v_fma_f32 v33, v15, v25, -v33
  v_fma_f32 v34, v15, v26, -v34
  v_fma_f32 v35, v15, v27, -v35
  v_fma_f32 v36, v15, v28, -v36
  v_fma_f32 v37, v15, v29, -v37
  v_fma_f32 v38, v15, v30, -v38
  v_fma_f32 v39, v15, v31, -v39
  s_add_u32 m0, s23, 6144
  s_add_u32 s22, s22, 65536
  buffer_load_dwordx4 v4, s[8:11], s22 offen lds
  v_cvt_pk_bf16_f32 v56, v32, v33
  v_cvt_pk_bf16_f32 v57, v34, v35
  v_cvt_pk_bf16_f32 v58, v36, v37
  v_cvt_pk_bf16_f32 v59, v38, v39
  v_fma_f32 v24, v15, v32, -v24
  v_fma_f32 v25, v15, v33, -v25
  v_fma_f32 v26, v15, v34, -v26
  v_fma_f32 v27, v15, v35, -v27
  v_fma_f32 v28, v15, v36, -v28
  v_fma_f32 v29, v15, v37, -v29
  v_fma_f32 v30, v15, v38, -v30
  v_fma_f32 v31, v15, v39, -v31
  v_cvt_pk_bf16_f32 v60, v24, v25
  v_cvt_pk_bf16_f32 v61, v26, v27
  v_cvt_pk_bf16_f32 v62, v28, v29
  s_add_u32 m0, s23, 7168
  s_add_u32 s22, s22, 65536
  buffer_load_dwordx4 v5, s[8:11], s22 offen lds
  v_cvt_pk_bf16_f32 v63, v30, v31
  v_fma_f32 v32, v15, v24, -v32
  v_fma_f32 v33, v15, v25, -v33
  v_fma_f32 v34, v15, v26, -v34
  v_fma_f32 v35, v15, v27, -v35
  v_fma_f32 v36, v15, v28, -v36
  v_fma_f32 v37, v15, v29, -v37
  v_fma_f32 v38, v15, v30, -v38
  v_fma_f32 v39, v15, v31, -v39
  v_cvt_pk_bf16_f32 v64, v32, v33
  v_cvt_pk_bf16_f32 v65, v34, v35
  v_cvt_pk_bf16_f32 v66, v36, v37
  v_cvt_pk_bf16_f32 v67, v38, v39
  v_fma_f32 v24, v15, v32, -v24
  v_fma_f32 v25, v15, v33, -v25
  v_fma_f32 v26, v15, v34, -v26
  s_add_u32 m0, s23, 8192
  s_add_u32 s22, s22, 65536
  buffer_load_dwordx4 v4, s[8:11], s22 offen lds
  v_fma_f32 v27, v15, v35, -v27
  v_fma_f32 v28, v15, v36, -v28
  v_fma_f32 v29, v15, v37, -v29
  v_fma_f32 v30, v15, v38, -v30
  v_fma_f32 v31, v15, v39, -v31
  v_cvt_pk_bf16_f32 v68, v24, v25
  v_cvt_pk_bf16_f32 v69, v26, v27
  v_cvt_pk_bf16_f32 v70, v28, v29
  v_cvt_pk_bf16_f32 v71, v30, v31
  v_fma_f32 v32, v15, v24, -v32
  v_fma_f32 v33, v15, v25, -v33
  v_fma_f32 v34, v15, v26, -v34
  v_fma_f32 v35, v15, v27, -v35
  v_fma_f32 v36, v15, v28, -v36
  v_fma_f32 v37, v15, v29, -v37
  v_fma_f32 v38, v15, v30, -v38
  s_add_u32 m0, s23, 9216
  s_add_u32 s22, s22, 65536
  buffer_load_dwordx4 v5, s[8:11], s22 offen lds
  v_fma_f32 v39, v15, v31, -v39
  v_cvt_pk_bf16_f32 v72, v32, v33
  v_cvt_pk_bf16_f32 v73, v34, v35
  v_cvt_pk_bf16_f32 v74, v36, v37
  v_cvt_pk_bf16_f32 v75, v38, v39
  v_fma_f32 v24, v15, v32, -v24
  v_fma_f32 v25, v15, v33, -v25
  v_fma_f32 v26, v15, v34, -v26
  v_fma_f32 v27, v15, v35, -v27
  v_fma_f32 v28, v15, v36, -v28
  v_fma_f32 v29, v15, v37, -v29
  v_fma_f32 v30, v15, v38, -v30
  v_fma_f32 v31, v15, v39, -v31
  v_cvt_pk_bf16_f32 v76, v24, v25
  v_cvt_pk_bf16_f32 v77, v26, v27
  v_cvt_pk_bf16_f32 v78, v28, v29
  s_add_u32 m0, s23, 10240
  s_add_u32 s22, s22, 65536
  buffer_load_dwordx4 v4, s[8:11], s22 offen lds
  v_cvt_pk_bf16_f32 v79, v30, v31
  v_fmamk_f32 v24, v14, 0x3f800000, v16
  v_fmamk_f32 v25, v14, 0x3f800000, v21
  v_fmamk_f32 v26, v14, 0x40400000, v16
  v_fmamk_f32 v27, v14, 0x40400000, v21
  v_fmamk_f32 v28, v14, 0x40a00000, v16
  v_fmamk_f32 v29, v14, 0x40a00000, v21
  v_fmamk_f32 v30, v14, 0x40e00000, v16
  v_fmamk_f32 v31, v14, 0x40e00000, v21
  v_cos_f32 v24, v24
  v_cos_f32 v25, v25
  v_cos_f32 v26, v26
  v_cos_f32 v27, v27
  v_cos_f32 v28, v28
  v_cos_f32 v29, v29
  v_cos_f32 v30, v30
  s_add_u32 m0, s23, 11264
  s_add_u32 s22, s22, 65536
  buffer_load_dwordx4 v5, s[8:11], s22 offen lds
  v_cos_f32 v31, v31
  s_nop 0
  v_cvt_pk_bf16_f32 v80, v24, v25
  v_cvt_pk_bf16_f32 v81, v26, v27
  v_cvt_pk_bf16_f32 v82, v28, v29
  v_cvt_pk_bf16_f32 v83, v30, v31
  v_fmamk_f32 v32, v14, 0x42040000, v16
  v_fmamk_f32 v33, v14, 0x42040000, v21
  v_fmamk_f32 v34, v14, 0x420c0000, v16
  v_fmamk_f32 v35, v14, 0x420c0000, v21
  v_fmamk_f32 v36, v14, 0x42140000, v16
  v_fmamk_f32 v37, v14, 0x42140000, v21
  v_fmamk_f32 v38, v14, 0x421c0000, v16
  v_fmamk_f32 v39, v14, 0x421c0000, v21
  v_cos_f32 v32, v32
  v_cos_f32 v33, v33
  s_add_u32 m0, s23, 12288
  s_add_u32 s22, s22, 65536
  buffer_load_dwordx4 v4, s[8:11], s22 offen lds
  v_cos_f32 v34, v34
  v_cos_f32 v35, v35
  v_cos_f32 v36, v36
  v_cos_f32 v37, v37
  v_cos_f32 v38, v38
  v_cos_f32 v39, v39
  s_nop 0
  v_cvt_pk_bf16_f32 v84, v32, v33
  v_cvt_pk_bf16_f32 v85, v34, v35
  v_cvt_pk_bf16_f32 v86, v36, v37
  v_cvt_pk_bf16_f32 v87, v38, v39
  v_fma_f32 v24, v15, v32, -v24
  v_fma_f32 v25, v15, v33, -v25
  v_fma_f32 v26, v15, v34, -v26
  v_fma_f32 v27, v15, v35, -v27
  s_add_u32 m0, s23, 13312
  s_add_u32 s22, s22, 65536
  buffer_load_dwordx4 v5, s[8:11], s22 offen lds
  v_fma_f32 v28, v15, v36, -v28
  v_fma_f32 v29, v15, v37, -v29
  v_fma_f32 v30, v15, v38, -v30
  v_fma_f32 v31, v15, v39, -v31
  v_cvt_pk_bf16_f32 v88, v24, v25
  v_cvt_pk_bf16_f32 v89, v26, v27
  v_cvt_pk_bf16_f32 v90, v28, v29
  v_cvt_pk_bf16_f32 v91, v30, v31
  v_fma_f32 v32, v15, v24, -v32
  v_fma_f32 v33, v15, v25, -v33
  v_fma_f32 v34, v15, v26, -v34
  v_fma_f32 v35, v15, v27, -v35
  v_fma_f32 v36, v15, v28, -v36
  v_fma_f32 v37, v15, v29, -v37
  v_fma_f32 v38, v15, v30, -v38
  v_fma_f32 v39, v15, v31, -v39
  s_add_u32 m0, s23, 14336
  s_add_u32 s22, s22, 65536
  buffer_load_dwordx4 v4, s[8:11], s22 offen lds
  v_cvt_pk_bf16_f32 v92, v32, v33
  v_cvt_pk_bf16_f32 v93, v34, v35
  v_cvt_pk_bf16_f32 v94, v36, v37
  v_cvt_pk_bf16_f32 v95, v38, v39
  v_fma_f32 v24, v15, v32, -v24
  v_fma_f32 v25, v15, v33, -v25
  v_fma_f32 v26, v15, v34, -v26
  v_fma_f32 v27, v15, v35, -v27
  v_fma_f32 v28, v15, v36, -v28
  v_fma_f32 v29, v15, v37, -v29
  v_fma_f32 v30, v15, v38, -v30
  v_fma_f32 v31, v15, v39, -v31
  v_cvt_pk_bf16_f32 v96, v24, v25
  v_cvt_pk_bf16_f32 v97, v26, v27
  v_cvt_pk_bf16_f32 v98, v28, v29
  v_cvt_pk_bf16_f32 v99, v30, v31
  s_add_u32 m0, s23, 15360
  s_add_u32 s22, s22, 65536
  buffer_load_dwordx4 v5, s[8:11], s22 offen lds
  v_fma_f32 v32, v15, v24, -v32
  v_fma_f32 v33, v15, v25, -v33
  v_fma_f32 v34, v15, v26, -v34
  v_fma_f32 v35, v15, v27, -v35
  v_fma_f32 v36, v15, v28, -v36
  v_fma_f32 v37, v15, v29, -v37
  v_fma_f32 v38, v15, v30, -v38
  v_fma_f32 v39, v15, v31, -v39
  v_cvt_pk_bf16_f32 v100, v32, v33
  v_cvt_pk_bf16_f32 v101, v34, v35
  v_cvt_pk_bf16_f32 v102, v36, v37
  v_cvt_pk_bf16_f32 v103, v38, v39
  v_fma_f32 v24, v15, v32, -v24
  v_fma_f32 v25, v15, v33, -v25
  v_fma_f32 v26, v15, v34, -v26
  v_fma_f32 v27, v15, v35, -v27
  s_add_u32 m0, s23, 16384
  s_add_u32 s22, s22, 65536
  buffer_load_dwordx4 v4, s[8:11], s22 offen lds
  v_fma_f32 v28, v15, v36, -v28
  v_fma_f32 v29, v15, v37, -v29
  v_fma_f32 v30, v15, v38, -v30
  v_fma_f32 v31, v15, v39, -v31
  v_cvt_pk_bf16_f32 v104, v24, v25
  v_cvt_pk_bf16_f32 v105, v26, v27
  v_cvt_pk_bf16_f32 v106, v28, v29
  v_cvt_pk_bf16_f32 v107, v30, v31
  v_fma_f32 v32, v15, v24, -v32
  v_fma_f32 v33, v15, v25, -v33
  v_fma_f32 v34, v15, v26, -v34
  v_fma_f32 v35, v15, v27, -v35
  v_fma_f32 v36, v15, v28, -v36
  v_fma_f32 v37, v15, v29, -v37
  v_fma_f32 v38, v15, v30, -v38
  v_fma_f32 v39, v15, v31, -v39
  s_add_u32 m0, s23, 17408
  s_add_u32 s22, s22, 65536
  buffer_load_dwordx4 v5, s[8:11], s22 offen lds
  v_cvt_pk_bf16_f32 v108, v32, v33
  v_cvt_pk_bf16_f32 v109, v34, v35
  v_cvt_pk_bf16_f32 v110, v36, v37
  v_cvt_pk_bf16_f32 v111, v38, v39
  v_fma_f32 v24, v15, v32, -v24
  v_fma_f32 v25, v15, v33, -v25
  v_fma_f32 v26, v15, v34, -v26
  v_fma_f32 v27, v15, v35, -v27
  v_fma_f32 v28, v15, v36, -v28
  v_fma_f32 v29, v15, v37, -v29
  v_fma_f32 v30, v15, v38, -v30
  v_fma_f32 v31, v15, v39, -v31
  v_cvt_pk_bf16_f32 v112, v24, v25
  v_cvt_pk_bf16_f32 v113, v26, v27
  v_cvt_pk_bf16_f32 v114, v28, v29
  v_cvt_pk_bf16_f32 v115, v30, v31
  s_movk_i32 s25, 1152
  v_mul_lo_u32 v17, v2, s25
  v_lshl_add_u32 v17, v3, 3, v17
  s_mul_i32 s26, s19, 73728
  s_lshl_b32 s27, s24, 1
  s_add_u32 s26, s26, s27
  s_add_u32 s27, s26, 0
  buffer_load_dwordx2 v[180:181], v17, s[12:15], s27 offen
  buffer_load_dwordx2 v[182:183], v17, s[12:15], s27 offen offset:576
  s_add_u32 s27, s26, 18432
  buffer_load_dwordx2 v[184:185], v17, s[12:15], s27 offen
  buffer_load_dwordx2 v[186:187], v17, s[12:15], s27 offen offset:576
  s_add_u32 s27, s26, 36864
  buffer_load_dwordx2 v[188:189], v17, s[12:15], s27 offen
  buffer_load_dwordx2 v[190:191], v17, s[12:15], s27 offen offset:576
  s_add_u32 s27, s26, 55296
  buffer_load_dwordx2 v[192:193], v17, s[12:15], s27 offen
  buffer_load_dwordx2 v[194:195], v17, s[12:15], s27 offen offset:576
  v_lshlrev_b32 v18, 2, v2
  s_lshl_b32 s27, s19, 8
  s_add_u32 s27, s27, 0x6c0000
  buffer_load_dword v196, v18, s[8:11], s27 offen offset:0
  buffer_load_dword v197, v18, s[8:11], s27 offen offset:64
  buffer_load_dword v198, v18, s[8:11], s27 offen offset:128
  buffer_load_dword v199, v18, s[8:11], s27 offen offset:192
  s_waitcnt vmcnt(12)
  s_barrier
  ds_read_b64_tr_b16 v[116:117], v6 offset:0
  ds_read_b64_tr_b16 v[118:119], v6 offset:512
  ds_read_b64_tr_b16 v[120:121], v7 offset:0
  ds_read_b64_tr_b16 v[122:123], v7 offset:512
  ds_read_b64_tr_b16 v[124:125], v8 offset:0
  ds_read_b64_tr_b16 v[126:127], v8 offset:512
  ds_read_b64_tr_b16 v[128:129], v9 offset:0
  ds_read_b64_tr_b16 v[130:131], v9 offset:512
  ds_read_b64_tr_b16 v[132:133], v6 offset:4096
  ds_read_b64_tr_b16 v[134:135], v6 offset:4608
  ds_read_b64_tr_b16 v[136:137], v7 offset:4096
  ds_read_b64_tr_b16 v[138:139], v7 offset:4608
  s_waitcnt lgkmcnt(8)
  v_mfma_f32_16x16x32_bf16 v[148:151], v[44:47], v[116:119], 0
  v_mfma_f32_16x16x32_bf16 v[152:155], v[44:47], v[120:123], 0
  ds_read_b64_tr_b16 v[140:141], v8 offset:4096
  ds_read_b64_tr_b16 v[142:143], v8 offset:4608
  ds_read_b64_tr_b16 v[144:145], v9 offset:4096
  ds_read_b64_tr_b16 v[146:147], v9 offset:4608
  s_waitcnt lgkmcnt(8)
  v_mfma_f32_16x16x32_bf16 v[156:159], v[44:47], v[124:127], 0
  v_mfma_f32_16x16x32_bf16 v[160:163], v[44:47], v[128:131], 0
  ds_read_b64_tr_b16 v[116:117], v6 offset:8192
  ds_read_b64_tr_b16 v[118:119], v6 offset:8704
  ds_read_b64_tr_b16 v[120:121], v7 offset:8192
  ds_read_b64_tr_b16 v[122:123], v7 offset:8704
  s_waitcnt lgkmcnt(8)
  v_mfma_f32_16x16x32_bf16 v[148:151], v[48:51], v[132:135], v[148:151]
  v_mfma_f32_16x16x32_bf16 v[152:155], v[48:51], v[136:139], v[152:155]
  ds_read_b64_tr_b16 v[124:125], v8 offset:8192
  ds_read_b64_tr_b16 v[126:127], v8 offset:8704
  ds_read_b64_tr_b16 v[128:129], v9 offset:8192
  ds_read_b64_tr_b16 v[130:131], v9 offset:8704
  s_waitcnt lgkmcnt(8)
  v_mfma_f32_16x16x32_bf16 v[156:159], v[48:51], v[140:143], v[156:159]
  v_mfma_f32_16x16x32_bf16 v[160:163], v[48:51], v[144:147], v[160:163]
  ds_read_b64_tr_b16 v[132:133], v6 offset:12288
  ds_read_b64_tr_b16 v[134:135], v6 offset:12800
  ds_read_b64_tr_b16 v[136:137], v7 offset:12288
  ds_read_b64_tr_b16 v[138:139], v7 offset:12800
  s_waitcnt lgkmcnt(8)
  v_mfma_f32_16x16x32_bf16 v[148:151], v[52:55], v[116:119], v[148:151]
  v_mfma_f32_16x16x32_bf16 v[152:155], v[52:55], v[120:123], v[152:155]
  ds_read_b64_tr_b16 v[140:141], v8 offset:12288
  ds_read_b64_tr_b16 v[142:143], v8 offset:12800
  ds_read_b64_tr_b16 v[144:145], v9 offset:12288
  ds_read_b64_tr_b16 v[146:147], v9 offset:12800
  s_waitcnt lgkmcnt(8)
  v_mfma_f32_16x16x32_bf16 v[156:159], v[52:55], v[124:127], v[156:159]
  v_mfma_f32_16x16x32_bf16 v[160:163], v[52:55], v[128:131], v[160:163]
  ds_read_b64_tr_b16 v[116:117], v6 offset:16384
  ds_read_b64_tr_b16 v[118:119], v6 offset:16896
  ds_read_b64_tr_b16 v[120:121], v7 offset:16384
  ds_read_b64_tr_b16 v[122:123], v7 offset:16896
  s_waitcnt lgkmcnt(8)
  v_mfma_f32_16x16x32_bf16 v[148:151], v[56:59], v[132:135], v[148:151]
  v_mfma_f32_16x16x32_bf16 v[152:155], v[56:59], v[136:139], v[152:155]
  ds_read_b64_tr_b16 v[124:125], v8 offset:16384
  ds_read_b64_tr_b16 v[126:127], v8 offset:16896
  ds_read_b64_tr_b16 v[128:129], v9 offset:16384
  ds_read_b64_tr_b16 v[130:131], v9 offset:16896
  s_waitcnt lgkmcnt(8)
  v_mfma_f32_16x16x32_bf16 v[156:159], v[56:59], v[140:143], v[156:159]
  v_mfma_f32_16x16x32_bf16 v[160:163], v[56:59], v[144:147], v[160:163]
  ds_read_b64_tr_b16 v[132:133], v6 offset:20480
  ds_read_b64_tr_b16 v[134:135], v6 offset:20992
  ds_read_b64_tr_b16 v[136:137], v7 offset:20480
  ds_read_b64_tr_b16 v[138:139], v7 offset:20992
  s_waitcnt lgkmcnt(8)
  v_mfma_f32_16x16x32_bf16 v[148:151], v[60:63], v[116:119], v[148:151]
  v_mfma_f32_16x16x32_bf16 v[152:155], v[60:63], v[120:123], v[152:155]
  ds_read_b64_tr_b16 v[140:141], v8 offset:20480
  ds_read_b64_tr_b16 v[142:143], v8 offset:20992
  ds_read_b64_tr_b16 v[144:145], v9 offset:20480
  ds_read_b64_tr_b16 v[146:147], v9 offset:20992
  s_waitcnt lgkmcnt(8)
  v_mfma_f32_16x16x32_bf16 v[156:159], v[60:63], v[124:127], v[156:159]
  v_mfma_f32_16x16x32_bf16 v[160:163], v[60:63], v[128:131], v[160:163]
  ds_read_b64_tr_b16 v[116:117], v6 offset:24576
  ds_read_b64_tr_b16 v[118:119], v6 offset:25088
  ds_read_b64_tr_b16 v[120:121], v7 offset:24576
  ds_read_b64_tr_b16 v[122:123], v7 offset:25088
  s_waitcnt lgkmcnt(8)
  v_mfma_f32_16x16x32_bf16 v[148:151], v[64:67], v[132:135], v[148:151]
  v_mfma_f32_16x16x32_bf16 v[152:155], v[64:67], v[136:139], v[152:155]
  ds_read_b64_tr_b16 v[124:125], v8 offset:24576
  ds_read_b64_tr_b16 v[126:127], v8 offset:25088
  ds_read_b64_tr_b16 v[128:129], v9 offset:24576
  ds_read_b64_tr_b16 v[130:131], v9 offset:25088
  s_waitcnt lgkmcnt(8)
  v_mfma_f32_16x16x32_bf16 v[156:159], v[64:67], v[140:143], v[156:159]
  v_mfma_f32_16x16x32_bf16 v[160:163], v[64:67], v[144:147], v[160:163]
  ds_read_b64_tr_b16 v[132:133], v6 offset:28672
  ds_read_b64_tr_b16 v[134:135], v6 offset:29184
  ds_read_b64_tr_b16 v[136:137], v7 offset:28672
  ds_read_b64_tr_b16 v[138:139], v7 offset:29184
  s_waitcnt lgkmcnt(8)
  v_mfma_f32_16x16x32_bf16 v[148:151], v[68:71], v[116:119], v[148:151]
  v_mfma_f32_16x16x32_bf16 v[152:155], v[68:71], v[120:123], v[152:155]
  ds_read_b64_tr_b16 v[140:141], v8 offset:28672
  ds_read_b64_tr_b16 v[142:143], v8 offset:29184
  ds_read_b64_tr_b16 v[144:145], v9 offset:28672
  ds_read_b64_tr_b16 v[146:147], v9 offset:29184
  s_waitcnt lgkmcnt(8)
  v_mfma_f32_16x16x32_bf16 v[156:159], v[68:71], v[124:127], v[156:159]
  v_mfma_f32_16x16x32_bf16 v[160:163], v[68:71], v[128:131], v[160:163]
  ds_read_b64_tr_b16 v[116:117], v6 offset:32768
  ds_read_b64_tr_b16 v[118:119], v6 offset:33280
  ds_read_b64_tr_b16 v[120:121], v7 offset:32768
  ds_read_b64_tr_b16 v[122:123], v7 offset:33280
  s_waitcnt lgkmcnt(8)
  v_mfma_f32_16x16x32_bf16 v[148:151], v[72:75], v[132:135], v[148:151]
  v_mfma_f32_16x16x32_bf16 v[152:155], v[72:75], v[136:139], v[152:155]
  ds_read_b64_tr_b16 v[124:125], v8 offset:32768
  ds_read_b64_tr_b16 v[126:127], v8 offset:33280
  ds_read_b64_tr_b16 v[128:129], v9 offset:32768
  ds_read_b64_tr_b16 v[130:131], v9 offset:33280
  s_waitcnt lgkmcnt(8)
  v_mfma_f32_16x16x32_bf16 v[156:159], v[72:75], v[140:143], v[156:159]
  v_mfma_f32_16x16x32_bf16 v[160:163], v[72:75], v[144:147], v[160:163]
  ds_read_b64_tr_b16 v[132:133], v6 offset:36864
  ds_read_b64_tr_b16 v[134:135], v6 offset:37376
  ds_read_b64_tr_b16 v[136:137], v7 offset:36864
  ds_read_b64_tr_b16 v[138:139], v7 offset:37376
  s_waitcnt lgkmcnt(8)
  v_mfma_f32_16x16x32_bf16 v[148:151], v[76:79], v[116:119], v[148:151]
  v_mfma_f32_16x16x32_bf16 v[152:155], v[76:79], v[120:123], v[152:155]
  ds_read_b64_tr_b16 v[140:141], v8 offset:36864
  ds_read_b64_tr_b16 v[142:143], v8 offset:37376
  ds_read_b64_tr_b16 v[144:145], v9 offset:36864
  ds_read_b64_tr_b16 v[146:147], v9 offset:37376
  s_waitcnt lgkmcnt(8)
  v_mfma_f32_16x16x32_bf16 v[156:159], v[76:79], v[124:127], v[156:159]
  v_mfma_f32_16x16x32_bf16 v[160:163], v[76:79], v[128:131], v[160:163]
  ds_read_b64_tr_b16 v[116:117], v6 offset:40960
  ds_read_b64_tr_b16 v[118:119], v6 offset:41472
  ds_read_b64_tr_b16 v[120:121], v7 offset:40960
  ds_read_b64_tr_b16 v[122:123], v7 offset:41472
  s_waitcnt lgkmcnt(8)
  v_mfma_f32_16x16x32_bf16 v[164:167], v[80:83], v[132:135], 0
  v_mfma_f32_16x16x32_bf16 v[168:171], v[80:83], v[136:139], 0
  ds_read_b64_tr_b16 v[124:125], v8 offset:40960
  ds_read_b64_tr_b16 v[126:127], v8 offset:41472
  ds_read_b64_tr_b16 v[128:129], v9 offset:40960
  ds_read_b64_tr_b16 v[130:131], v9 offset:41472
  s_waitcnt lgkmcnt(8)
  v_mfma_f32_16x16x32_bf16 v[172:175], v[80:83], v[140:143], 0
  v_mfma_f32_16x16x32_bf16 v[176:179], v[80:83], v[144:147], 0
  ds_read_b64_tr_b16 v[132:133], v6 offset:45056
  ds_read_b64_tr_b16 v[134:135], v6 offset:45568
  ds_read_b64_tr_b16 v[136:137], v7 offset:45056
  ds_read_b64_tr_b16 v[138:139], v7 offset:45568
  s_waitcnt lgkmcnt(8)
  v_mfma_f32_16x16x32_bf16 v[164:167], v[84:87], v[116:119], v[164:167]
  v_mfma_f32_16x16x32_bf16 v[168:171], v[84:87], v[120:123], v[168:171]
  ds_read_b64_tr_b16 v[140:141], v8 offset:45056
  ds_read_b64_tr_b16 v[142:143], v8 offset:45568
  ds_read_b64_tr_b16 v[144:145], v9 offset:45056
  ds_read_b64_tr_b16 v[146:147], v9 offset:45568
  s_waitcnt lgkmcnt(8)
  v_mfma_f32_16x16x32_bf16 v[172:175], v[84:87], v[124:127], v[172:175]
  v_mfma_f32_16x16x32_bf16 v[176:179], v[84:87], v[128:131], v[176:179]
  ds_read_b64_tr_b16 v[116:117], v6 offset:49152
  ds_read_b64_tr_b16 v[118:119], v6 offset:49664
  ds_read_b64_tr_b16 v[120:121], v7 offset:49152
  ds_read_b64_tr_b16 v[122:123], v7 offset:49664
  s_waitcnt lgkmcnt(8)
  v_mfma_f32_16x16x32_bf16 v[164:167], v[88:91], v[132:135], v[164:167]
  v_mfma_f32_16x16x32_bf16 v[168:171], v[88:91], v[136:139], v[168:171]
  ds_read_b64_tr_b16 v[124:125], v8 offset:49152
  ds_read_b64_tr_b16 v[126:127], v8 offset:49664
  ds_read_b64_tr_b16 v[128:129], v9 offset:49152
  ds_read_b64_tr_b16 v[130:131], v9 offset:49664
  s_waitcnt lgkmcnt(8)
  v_mfma_f32_16x16x32_bf16 v[172:175], v[88:91], v[140:143], v[172:175]
  v_mfma_f32_16x16x32_bf16 v[176:179], v[88:91], v[144:147], v[176:179]
  ds_read_b64_tr_b16 v[132:133], v6 offset:53248
  ds_read_b64_tr_b16 v[134:135], v6 offset:53760
  ds_read_b64_tr_b16 v[136:137], v7 offset:53248
  ds_read_b64_tr_b16 v[138:139], v7 offset:53760
  s_waitcnt lgkmcnt(8)
  v_mfma_f32_16x16x32_bf16 v[164:167], v[92:95], v[116:119], v[164:167]
  v_mfma_f32_16x16x32_bf16 v[168:171], v[92:95], v[120:123], v[168:171]
  ds_read_b64_tr_b16 v[140:141], v8 offset:53248
  ds_read_b64_tr_b16 v[142:143], v8 offset:53760
  ds_read_b64_tr_b16 v[144:145], v9 offset:53248
  ds_read_b64_tr_b16 v[146:147], v9 offset:53760
  s_waitcnt lgkmcnt(8)
  v_mfma_f32_16x16x32_bf16 v[172:175], v[92:95], v[124:127], v[172:175]
  v_mfma_f32_16x16x32_bf16 v[176:179], v[92:95], v[128:131], v[176:179]
  ds_read_b64_tr_b16 v[116:117], v6 offset:57344
  ds_read_b64_tr_b16 v[118:119], v6 offset:57856
  ds_read_b64_tr_b16 v[120:121], v7 offset:57344
  ds_read_b64_tr_b16 v[122:123], v7 offset:57856
  s_waitcnt lgkmcnt(8)
  v_mfma_f32_16x16x32_bf16 v[164:167], v[96:99], v[132:135], v[164:167]
  v_mfma_f32_16x16x32_bf16 v[168:171], v[96:99], v[136:139], v[168:171]
  ds_read_b64_tr_b16 v[124:125], v8 offset:57344
  ds_read_b64_tr_b16 v[126:127], v8 offset:57856
  ds_read_b64_tr_b16 v[128:129], v9 offset:57344
  ds_read_b64_tr_b16 v[130:131], v9 offset:57856
  s_waitcnt lgkmcnt(8)
  v_mfma_f32_16x16x32_bf16 v[172:175], v[96:99], v[140:143], v[172:175]
  v_mfma_f32_16x16x32_bf16 v[176:179], v[96:99], v[144:147], v[176:179]
  ds_read_b64_tr_b16 v[132:133], v6 offset:61440
  ds_read_b64_tr_b16 v[134:135], v6 offset:61952
  ds_read_b64_tr_b16 v[136:137], v7 offset:61440
  ds_read_b64_tr_b16 v[138:139], v7 offset:61952
  s_waitcnt lgkmcnt(8)
  v_mfma_f32_16x16x32_bf16 v[164:167], v[100:103], v[116:119], v[164:167]
  v_mfma_f32_16x16x32_bf16 v[168:171], v[100:103], v[120:123], v[168:171]
  ds_read_b64_tr_b16 v[140:141], v8 offset:61440
  ds_read_b64_tr_b16 v[142:143], v8 offset:61952
  ds_read_b64_tr_b16 v[144:145], v9 offset:61440
  ds_read_b64_tr_b16 v[146:147], v9 offset:61952
  s_waitcnt lgkmcnt(8)
  v_mfma_f32_16x16x32_bf16 v[172:175], v[100:103], v[124:127], v[172:175]
  v_mfma_f32_16x16x32_bf16 v[176:179], v[100:103], v[128:131], v[176:179]
  ds_read_b64_tr_b16 v[116:117], v10 offset:0
  ds_read_b64_tr_b16 v[118:119], v10 offset:512
  ds_read_b64_tr_b16 v[120:121], v11 offset:0
  ds_read_b64_tr_b16 v[122:123], v11 offset:512
  s_waitcnt lgkmcnt(8)
  v_mfma_f32_16x16x32_bf16 v[164:167], v[104:107], v[132:135], v[164:167]
  v_mfma_f32_16x16x32_bf16 v[168:171], v[104:107], v[136:139], v[168:171]
  ds_read_b64_tr_b16 v[124:125], v12 offset:0
  ds_read_b64_tr_b16 v[126:127], v12 offset:512
  ds_read_b64_tr_b16 v[128:129], v13 offset:0
  ds_read_b64_tr_b16 v[130:131], v13 offset:512
  s_waitcnt lgkmcnt(8)
  v_mfma_f32_16x16x32_bf16 v[172:175], v[104:107], v[140:143], v[172:175]
  v_mfma_f32_16x16x32_bf16 v[176:179], v[104:107], v[144:147], v[176:179]
  ds_read_b64_tr_b16 v[132:133], v10 offset:4096
  ds_read_b64_tr_b16 v[134:135], v10 offset:4608
  ds_read_b64_tr_b16 v[136:137], v11 offset:4096
  ds_read_b64_tr_b16 v[138:139], v11 offset:4608
  s_waitcnt lgkmcnt(8)
  v_mfma_f32_16x16x32_bf16 v[164:167], v[108:111], v[116:119], v[164:167]
  v_mfma_f32_16x16x32_bf16 v[168:171], v[108:111], v[120:123], v[168:171]
  ds_read_b64_tr_b16 v[140:141], v12 offset:4096
  ds_read_b64_tr_b16 v[142:143], v12 offset:4608
  ds_read_b64_tr_b16 v[144:145], v13 offset:4096
  ds_read_b64_tr_b16 v[146:147], v13 offset:4608
  s_waitcnt lgkmcnt(8)
  v_mfma_f32_16x16x32_bf16 v[172:175], v[108:111], v[124:127], v[172:175]
  v_mfma_f32_16x16x32_bf16 v[176:179], v[108:111], v[128:131], v[176:179]
  s_waitcnt lgkmcnt(4)
  v_mfma_f32_16x16x32_bf16 v[164:167], v[112:115], v[132:135], v[164:167]
  v_mfma_f32_16x16x32_bf16 v[168:171], v[112:115], v[136:139], v[168:171]
  s_waitcnt lgkmcnt(0)
  v_mfma_f32_16x16x32_bf16 v[172:175], v[112:115], v[140:143], v[172:175]
  v_mfma_f32_16x16x32_bf16 v[176:179], v[112:115], v[144:147], v[176:179]
  s_mov_b32 s28, 0x35e38e39
  s_add_u32 s26, s26, 0x480000
  s_waitcnt vmcnt(0)
  s_nop 4
  v_lshlrev_b32 v24, 16, v180
  v_and_b32 v25, 0xffff0000, v180
  v_lshlrev_b32 v26, 16, v181
  v_and_b32 v27, 0xffff0000, v181
  v_sub_f32 v24, v24, v196
  v_sub_f32 v25, v25, v196
  v_sub_f32 v26, v26, v196
  v_sub_f32 v27, v27, v196
  v_add_f32 v28, v148, v164
  v_add_f32 v29, v149, v165
  v_add_f32 v30, v150, v166
  v_add_f32 v31, v151, v167
  v_fma_f32 v24, v28, s28, v24
  v_fma_f32 v25, v29, s28, v25
  v_fma_f32 v26, v30, s28, v26
  v_fma_f32 v27, v31, s28, v27
  v_cvt_pk_bf16_f32 v32, v24, v25
  v_cvt_pk_bf16_f32 v33, v26, v27
  s_add_u32 s27, s26, 0
  buffer_store_dwordx2 v[32:33], v17, s[8:11], s27 offen offset:0
  v_lshlrev_b32 v24, 16, v182
  v_and_b32 v25, 0xffff0000, v182
  v_lshlrev_b32 v26, 16, v183
  v_and_b32 v27, 0xffff0000, v183
  v_sub_f32 v24, v24, v196
  v_sub_f32 v25, v25, v196
  v_sub_f32 v26, v26, v196
  v_sub_f32 v27, v27, v196
  v_sub_f32 v28, v148, v164
  v_sub_f32 v29, v149, v165
  v_sub_f32 v30, v150, v166
  v_sub_f32 v31, v151, v167
  v_fma_f32 v24, v28, s28, v24
  v_fma_f32 v25, v29, s28, v25
  v_fma_f32 v26, v30, s28, v26
  v_fma_f32 v27, v31, s28, v27
  v_cvt_pk_bf16_f32 v34, v24, v25
  v_cvt_pk_bf16_f32 v35, v26, v27
  s_add_u32 s27, s26, 0
  buffer_store_dwordx2 v[34:35], v17, s[8:11], s27 offen offset:576
  v_lshlrev_b32 v24, 16, v184
  v_and_b32 v25, 0xffff0000, v184
  v_lshlrev_b32 v26, 16, v185
  v_and_b32 v27, 0xffff0000, v185
  v_sub_f32 v24, v24, v197
  v_sub_f32 v25, v25, v197
  v_sub_f32 v26, v26, v197
  v_sub_f32 v27, v27, v197
  v_add_f32 v28, v152, v168
  v_add_f32 v29, v153, v169
  v_add_f32 v30, v154, v170
  v_add_f32 v31, v155, v171
  v_fma_f32 v24, v28, s28, v24
  v_fma_f32 v25, v29, s28, v25
  v_fma_f32 v26, v30, s28, v26
  v_fma_f32 v27, v31, s28, v27
  v_cvt_pk_bf16_f32 v32, v24, v25
  v_cvt_pk_bf16_f32 v33, v26, v27
  s_add_u32 s27, s26, 18432
  buffer_store_dwordx2 v[32:33], v17, s[8:11], s27 offen offset:0
  v_lshlrev_b32 v24, 16, v186
  v_and_b32 v25, 0xffff0000, v186
  v_lshlrev_b32 v26, 16, v187
  v_and_b32 v27, 0xffff0000, v187
  v_sub_f32 v24, v24, v197
  v_sub_f32 v25, v25, v197
  v_sub_f32 v26, v26, v197
  v_sub_f32 v27, v27, v197
  v_sub_f32 v28, v152, v168
  v_sub_f32 v29, v153, v169
  v_sub_f32 v30, v154, v170
  v_sub_f32 v31, v155, v171
  v_fma_f32 v24, v28, s28, v24
  v_fma_f32 v25, v29, s28, v25
  v_fma_f32 v26, v30, s28, v26
  v_fma_f32 v27, v31, s28, v27
  v_cvt_pk_bf16_f32 v34, v24, v25
  v_cvt_pk_bf16_f32 v35, v26, v27
  s_add_u32 s27, s26, 18432
  buffer_store_dwordx2 v[34:35], v17, s[8:11], s27 offen offset:576
  v_lshlrev_b32 v24, 16, v188
  v_and_b32 v25, 0xffff0000, v188
  v_lshlrev_b32 v26, 16, v189
  v_and_b32 v27, 0xffff0000, v189
  v_sub_f32 v24, v24, v198
  v_sub_f32 v25, v25, v198
  v_sub_f32 v26, v26, v198
  v_sub_f32 v27, v27, v198
  v_add_f32 v28, v156, v172
  v_add_f32 v29, v157, v173
  v_add_f32 v30, v158, v174
  v_add_f32 v31, v159, v175
  v_fma_f32 v24, v28, s28, v24
  v_fma_f32 v25, v29, s28, v25
  v_fma_f32 v26, v30, s28, v26
  v_fma_f32 v27, v31, s28, v27
  v_cvt_pk_bf16_f32 v32, v24, v25
  v_cvt_pk_bf16_f32 v33, v26, v27
  s_add_u32 s27, s26, 36864
  buffer_store_dwordx2 v[32:33], v17, s[8:11], s27 offen offset:0
  v_lshlrev_b32 v24, 16, v190
  v_and_b32 v25, 0xffff0000, v190
  v_lshlrev_b32 v26, 16, v191
  v_and_b32 v27, 0xffff0000, v191
  v_sub_f32 v24, v24, v198
  v_sub_f32 v25, v25, v198
  v_sub_f32 v26, v26, v198
  v_sub_f32 v27, v27, v198
  v_sub_f32 v28, v156, v172
  v_sub_f32 v29, v157, v173
  v_sub_f32 v30, v158, v174
  v_sub_f32 v31, v159, v175
  v_fma_f32 v24, v28, s28, v24
  v_fma_f32 v25, v29, s28, v25
  v_fma_f32 v26, v30, s28, v26
  v_fma_f32 v27, v31, s28, v27
  v_cvt_pk_bf16_f32 v34, v24, v25
  v_cvt_pk_bf16_f32 v35, v26, v27
  s_add_u32 s27, s26, 36864
  buffer_store_dwordx2 v[34:35], v17, s[8:11], s27 offen offset:576
  v_lshlrev_b32 v24, 16, v192
  v_and_b32 v25, 0xffff0000, v192
  v_lshlrev_b32 v26, 16, v193
  v_and_b32 v27, 0xffff0000, v193
  v_sub_f32 v24, v24, v199
  v_sub_f32 v25, v25, v199
  v_sub_f32 v26, v26, v199
  v_sub_f32 v27, v27, v199
  v_add_f32 v28, v160, v176
  v_add_f32 v29, v161, v177
  v_add_f32 v30, v162, v178
  v_add_f32 v31, v163, v179
  v_fma_f32 v24, v28, s28, v24
  v_fma_f32 v25, v29, s28, v25
  v_fma_f32 v26, v30, s28, v26
  v_fma_f32 v27, v31, s28, v27
  v_cvt_pk_bf16_f32 v32, v24, v25
  v_cvt_pk_bf16_f32 v33, v26, v27
  s_add_u32 s27, s26, 55296
  buffer_store_dwordx2 v[32:33], v17, s[8:11], s27 offen offset:0
  v_lshlrev_b32 v24, 16, v194
  v_and_b32 v25, 0xffff0000, v194
  v_lshlrev_b32 v26, 16, v195
  v_and_b32 v27, 0xffff0000, v195
  v_sub_f32 v24, v24, v199
  v_sub_f32 v25, v25, v199
  v_sub_f32 v26, v26, v199
  v_sub_f32 v27, v27, v199
  v_sub_f32 v28, v160, v176
  v_sub_f32 v29, v161, v177
  v_sub_f32 v30, v162, v178
  v_sub_f32 v31, v163, v179
  v_fma_f32 v24, v28, s28, v24
  v_fma_f32 v25, v29, s28, v25
  v_fma_f32 v26, v30, s28, v26
  v_fma_f32 v27, v31, s28, v27
  v_cvt_pk_bf16_f32 v34, v24, v25
  v_cvt_pk_bf16_f32 v35, v26, v27
  s_add_u32 s27, s26, 55296
  buffer_store_dwordx2 v[34:35], v17, s[8:11], s27 offen offset:576
  s_endpgm
k3_kernel_w3:
  s_add_u32 m0, s23, 0
  s_nop 0
  buffer_load_dwordx4 v4, s[8:11], s22 offen lds
  s_add_u32 m0, s23, 1024
  s_add_u32 s22, s22, 65536
  buffer_load_dwordx4 v5, s[8:11], s22 offen lds
  s_add_u32 m0, s23, 2048
  s_add_u32 s22, s22, 65536
  buffer_load_dwordx4 v4, s[8:11], s22 offen lds
  s_add_u32 m0, s23, 3072
  s_add_u32 s22, s22, 65536
  buffer_load_dwordx4 v5, s[8:11], s22 offen lds
  s_add_u32 m0, s23, 4096
  s_add_u32 s22, s22, 65536
  buffer_load_dwordx4 v4, s[8:11], s22 offen lds
  s_add_u32 m0, s23, 5120
  s_add_u32 s22, s22, 65536
  buffer_load_dwordx4 v5, s[8:11], s22 offen lds
  s_add_u32 m0, s23, 6144
  s_add_u32 s22, s22, 65536
  buffer_load_dwordx4 v4, s[8:11], s22 offen lds
  s_add_u32 m0, s23, 7168
  s_add_u32 s22, s22, 65536
  buffer_load_dwordx4 v5, s[8:11], s22 offen lds
  s_add_u32 m0, s23, 8192
  s_add_u32 s22, s22, 65536
  buffer_load_dwordx4 v4, s[8:11], s22 offen lds
  s_add_u32 m0, s23, 9216
  s_add_u32 s22, s22, 65536
  buffer_load_dwordx4 v5, s[8:11], s22 offen lds
  s_add_u32 m0, s23, 10240
  s_add_u32 s22, s22, 65536
  buffer_load_dwordx4 v4, s[8:11], s22 offen lds
  s_add_u32 m0, s23, 11264
  s_add_u32 s22, s22, 65536
  buffer_load_dwordx4 v5, s[8:11], s22 offen lds
  s_add_u32 m0, s23, 12288
  s_add_u32 s22, s22, 65536
  buffer_load_dwordx4 v4, s[8:11], s22 offen lds
  s_add_u32 m0, s23, 13312
  s_add_u32 s22, s22, 65536
  buffer_load_dwordx4 v5, s[8:11], s22 offen lds
  s_add_u32 m0, s23, 14336
  s_add_u32 s22, s22, 65536
  buffer_load_dwordx4 v4, s[8:11], s22 offen lds
  s_add_u32 m0, s23, 15360
  s_add_u32 s22, s22, 65536
  buffer_load_dwordx4 v5, s[8:11], s22 offen lds
  s_add_u32 m0, s23, 16384
  s_add_u32 s22, s22, 65536
  buffer_load_dwordx4 v4, s[8:11], s22 offen lds
  s_add_u32 m0, s23, 17408
  s_add_u32 s22, s22, 65536
  buffer_load_dwordx4 v5, s[8:11], s22 offen lds
  s_getpc_b64 s[40:41]
k3_kernel_pc1:
  s_add_u32 s40, s40, k4_kernel - k3_kernel_pc1
  s_addc_u32 s41, s41, 0
  s_and_b32 s42, s17, 3
  s_lshl_b32 s42, s42, 13
  v_lshlrev_b32 v30, 7, v1
  v_add_u32 v30, s42, v30
  v_min_u32 v30, text_end - k4_kernel - 4, v30
  global_load_dword v31, v30, s[40:41]
  s_waitcnt vmcnt(1)
  s_barrier
k3_kernel_end:
  s_endpgm
.globl k4_kernel
.p2align 8
.type k4_kernel,@function
k4_kernel:
  s_cmp_ge_u32 s2, 256
  s_cbranch_scc1 k4_kernel_end
  s_load_dwordx2 s[4:5], s[0:1], 80
  s_load_dwordx2 s[6:7], s[0:1], 40
  s_load_dwordx4 s[32:35], s[0:1], 56
  v_and_b32 v1, 63, v0
  v_lshrrev_b32 v224, 6, v0
  s_lshr_b32 s31, s2, 3
  s_and_b32 s16, s31, 7
  s_and_b32 s17, s2, 7
  s_lshl_b32 s17, s17, 2
  s_lshr_b32 s19, s2, 6
  s_add_u32 s17, s17, s19
  v_readfirstlane_b32 s18, v224
  v_lshlrev_b32 v2, 4, v1
  v_lshrrev_b32 v226, 4, v1
  v_lshrrev_b32 v233, 3, v1
  s_lshl_b32 s19, s18, 4
  v_add_u32 v233, s19, v233
  s_movk_i32 s23, 1152
  v_mul_lo_u32 v233, v233, s23
  v_and_b32 v234, 7, v1
  v_xor_b32 v235, v234, v226
  v_xor_b32 v236, 4, v235
  v_lshl_add_u32 v235, v235, 4, v233
  v_lshl_add_u32 v236, v236, 4, v233
  v_add_u32 v236, 9216, v236
  s_mul_i32 s23, s17, 73728
  s_add_u32 s23, s23, 0x480000
  s_lshl_b32 s24, s18, 11
  s_lshl_b32 s25, s16, 2
  s_add_u32 s25, s25, s18
  s_mul_i32 s25, s25, 165888
  s_add_u32 s20, s25, 0x940000
  s_add_u32 s21, s25, 0xe50000
  s_waitcnt lgkmcnt(0)
  s_mov_b32 s8, s4
  s_mov_b32 s9, s5
  s_mov_b32 s10, 0x10000000
  s_mov_b32 s11, 0x20000
  s_add_u32 m0, s24, 0
  s_nop 0
  buffer_load_dwordx4 v235, s[8:11], s23 offen lds
  s_add_u32 m0, s24, 1024
  s_nop 0
  buffer_load_dwordx4 v236, s[8:11], s23 offen lds
  s_add_u32 m0, s24, 8192
  s_add_u32 s23, s23, 128
  buffer_load_dwordx4 v235, s[8:11], s23 offen lds
  s_add_u32 m0, s24, 9216
  s_nop 0
  buffer_load_dwordx4 v236, s[8:11], s23 offen lds
  s_add_u32 m0, s24, 16384
  s_add_u32 s23, s23, 128
  buffer_load_dwordx4 v235, s[8:11], s23 offen lds
  s_add_u32 m0, s24, 17408
  s_nop 0
  buffer_load_dwordx4 v236, s[8:11], s23 offen lds
  buffer_load_dwordx4 a[104:107], v2, s[8:11], s20 offen offset:0
  buffer_load_dwordx4 a[108:111], v2, s[8:11], s20 offen offset:1024
  buffer_load_dwordx4 a[112:115], v2, s[8:11], s20 offen offset:2048
  s_add_u32 s20, s20, 3072
  buffer_load_dwordx4 a[116:119], v2, s[8:11], s20 offen offset:0
  buffer_load_dwordx4 a[120:123], v2, s[8:11], s20 offen offset:1024
  buffer_load_dwordx4 a[124:127], v2, s[8:11], s20 offen offset:2048
  s_add_u32 s20, s20, 3072
  buffer_load_dwordx4 a[128:131], v2, s[8:11], s20 offen offset:0
  buffer_load_dwordx4 a[132:135], v2, s[8:11], s20 offen offset:1024
  buffer_load_dwordx4 a[136:139], v2, s[8:11], s20 offen offset:2048
  s_add_u32 s20, s20, 3072
  buffer_load_dwordx4 a[140:143], v2, s[8:11], s20 offen offset:0
  buffer_load_dwordx4 a[144:147], v2, s[8:11], s20 offen offset:1024
  buffer_load_dwordx4 a[148:151], v2, s[8:11], s20 offen offset:2048
  s_add_u32 s20, s20, 3072
  s_mov_b32 s12, s6
  s_mov_b32 s13, s7
  s_mov_b32 s14, 9216
  s_mov_b32 s15, 0x20000
  v_and_b32 v225, 15, v1
  v_lshrrev_b32 v227, 1, v225
  v_xor_b32 v228, v226, v227
  v_lshlrev_b32 v228, 4, v228
  v_lshl_add_u32 v3, v225, 7, v228
  v_xor_b32 v4, 64, v3
  v_add_u32 v5, 0x10000, v3
  v_add_u32 v6, 0x10000, v4
  v_add_u32 v7, 73728, v3
  v_add_u32 v8, 73728, v4
  v_add_u32 v9, 139264, v3
  v_add_u32 v10, 139264, v4
  v_add_u32 v14, s24, v3
  v_add_u32 v15, s24, v4
  v_add_u32 v16, s24, v5
  v_add_u32 v17, s24, v6
  s_mul_i32 s19, s18, 6
  v_lshrrev_b32 v229, 1, v226
  v_add_u32 v229, s19, v229
  v_and_b32 v230, 1, v226
  v_lshlrev_b32 v230, 3, v230
  v_lshl_add_u32 v230, v225, 7, v230
  v_add_u32 v230, 73728, v230
  v_add_u32 v231, 0, v229
  v_lshrrev_b32 v232, 3, v231
  v_and_b32 v231, 7, v231
  v_xor_b32 v231, v231, v227
  v_lshlrev_b32 v231, 4, v231
  v_lshl_add_u32 v231, v232, 13, v231
  v_add_u32 v11, v231, v230
  v_add_u32 v231, 2, v229
  v_lshrrev_b32 v232, 3, v231
  v_and_b32 v231, 7, v231
  v_xor_b32 v231, v231, v227
  v_lshlrev_b32 v231, 4, v231
  v_lshl_add_u32 v231, v232, 13, v231
  v_add_u32 v12, v231, v230
  v_add_u32 v231, 4, v229
  v_lshrrev_b32 v232, 3, v231
  v_and_b32 v231, 7, v231
  v_xor_b32 v231, v231, v227
  v_lshlrev_b32 v231, 4, v231
  v_lshl_add_u32 v231, v232, 13, v231
  v_add_u32 v13, v231, v230
  v_mov_b32 v52, 0x409d30fc
  v_mov_b32 v53, 0x3eeff558
  s_lshl_b32 s25, s17, 2
  s_add_u32 s25, s25, s18
  s_mul_i32 s25, s25, 18432
  s_mul_i32 s26, s16, 2359296
  s_add_u32 s25, s25, s26
  s_add_u32 s22, s25, 0x1360000
  v_lshlrev_b32 v237, 3, v226
  s_mul_i32 s25, s16, 1152
  s_mul_i32 s26, s18, 288
  s_add_u32 s30, s25, s26
  s_waitcnt vmcnt(12)
  s_barrier
  ds_read_b128 a[60:63], v3 offset:0
  ds_read_b128 a[64:67], v3 offset:2048
  ds_read_b128 a[68:71], v3 offset:4096
  ds_read_b128 a[72:75], v3 offset:6144
  ds_read_b128 a[92:95], v14 offset:0
  s_waitcnt vmcnt(9) lgkmcnt(0)
  v_mfma_f32_16x16x32_bf16 v[80:83], a[104:107], a[60:63], 0
  ds_read_b128 a[76:79], v4 offset:0
  buffer_load_dwordx4 a[152:155], v2, s[8:11], s20 offen offset:0
  v_mfma_f32_16x16x32_bf16 v[84:87], a[104:107], a[64:67], 0
  ds_read_b128 a[80:83], v4 offset:2048
  v_mfma_f32_16x16x32_bf16 v[88:91], a[104:107], a[68:71], 0
  buffer_load_dwordx4 a[156:159], v2, s[8:11], s20 offen offset:1024
  v_mfma_f32_16x16x32_bf16 v[92:95], a[104:107], a[72:75], 0
  ds_read_b128 a[84:87], v4 offset:4096
  buffer_load_dwordx4 a[160:163], v2, s[8:11], s20 offen offset:2048
  v_mfma_f32_16x16x32_bf16 v[96:99], a[108:111], a[60:63], 0
  v_mfma_f32_16x16x32_bf16 v[68:71], a[92:95], a[92:95], 0
  ds_read_b128 a[88:91], v4 offset:6144
  v_mfma_f32_16x16x32_bf16 v[100:103], a[108:111], a[64:67], 0
  s_add_u32 s20, s20, 3072
  v_mfma_f32_16x16x32_bf16 v[104:107], a[108:111], a[68:71], 0
  ds_read_b128 a[96:99], v15 offset:0
  buffer_load_dwordx4 a[164:167], v2, s[8:11], s20 offen offset:0
  v_mfma_f32_16x16x32_bf16 v[108:111], a[108:111], a[72:75], 0
  buffer_load_dwordx4 a[168:171], v2, s[8:11], s20 offen offset:1024
  v_mfma_f32_16x16x32_bf16 v[112:115], a[112:115], a[60:63], 0
  buffer_load_dwordx4 a[172:175], v2, s[8:11], s20 offen offset:2048
  v_mfma_f32_16x16x32_bf16 v[116:119], a[112:115], a[64:67], 0
  s_add_u32 s20, s20, 3072
  s_add_u32 m0, s24, 24576
  s_add_u32 s23, s23, 128
  buffer_load_dwordx4 v235, s[8:11], s23 offen lds
  v_mfma_f32_16x16x32_bf16 v[120:123], a[112:115], a[68:71], 0
  v_mfma_f32_16x16x32_bf16 v[124:127], a[112:115], a[72:75], 0
  s_add_u32 m0, s24, 25600
  s_nop 0
  buffer_load_dwordx4 v236, s[8:11], s23 offen lds
  s_waitcnt vmcnt(14) lgkmcnt(0)
  v_mfma_f32_16x16x32_bf16 v[80:83], a[116:119], a[76:79], v[80:83]
  ds_read_b128 a[60:63], v3 offset:8192
  buffer_load_dwordx4 a[104:107], v2, s[8:11], s20 offen offset:0
  v_mfma_f32_16x16x32_bf16 v[84:87], a[116:119], a[80:83], v[84:87]
  ds_read_b128 a[64:67], v3 offset:10240
  v_mfma_f32_16x16x32_bf16 v[88:91], a[116:119], a[84:87], v[88:91]
  buffer_load_dwordx4 a[108:111], v2, s[8:11], s20 offen offset:1024
  v_mfma_f32_16x16x32_bf16 v[92:95], a[116:119], a[88:91], v[92:95]
  ds_read_b128 a[68:71], v3 offset:12288
  buffer_load_dwordx4 a[112:115], v2, s[8:11], s20 offen offset:2048
  v_mfma_f32_16x16x32_bf16 v[96:99], a[120:123], a[76:79], v[96:99]
  v_mfma_f32_16x16x32_bf16 v[68:71], a[96:99], a[96:99], v[68:71]
  ds_read_b128 a[72:75], v3 offset:14336
  v_mfma_f32_16x16x32_bf16 v[100:103], a[120:123], a[80:83], v[100:103]
  s_add_u32 s20, s20, 3072
  v_mfma_f32_16x16x32_bf16 v[104:107], a[120:123], a[84:87], v[104:107]
  ds_read_b128 a[92:95], v14 offset:8192
  buffer_load_dwordx4 a[176:179], v2, s[8:11], s20 offen offset:0
  v_mfma_f32_16x16x32_bf16 v[108:111], a[120:123], a[88:91], v[108:111]
  buffer_load_dwordx4 a[180:183], v2, s[8:11], s20 offen offset:1024
  v_mfma_f32_16x16x32_bf16 v[112:115], a[124:127], a[76:79], v[112:115]
  buffer_load_dwordx4 a[184:187], v2, s[8:11], s20 offen offset:2048
  v_mfma_f32_16x16x32_bf16 v[116:119], a[124:127], a[80:83], v[116:119]
  s_add_u32 s20, s20, 3072
  s_add_u32 m0, s24, 32768
  s_add_u32 s23, s23, 128
  buffer_load_dwordx4 v235, s[8:11], s23 offen lds
  v_mfma_f32_16x16x32_bf16 v[120:123], a[124:127], a[84:87], v[120:123]
  v_mfma_f32_16x16x32_bf16 v[124:127], a[124:127], a[88:91], v[124:127]
  s_add_u32 m0, s24, 33792
  s_nop 0
  buffer_load_dwordx4 v236, s[8:11], s23 offen lds
  s_waitcnt vmcnt(19) lgkmcnt(0)
  v_mfma_f32_16x16x32_bf16 v[80:83], a[128:131], a[60:63], v[80:83]
  ds_read_b128 a[76:79], v4 offset:8192
  buffer_load_dwordx4 a[116:119], v2, s[8:11], s20 offen offset:0
  v_mfma_f32_16x16x32_bf16 v[84:87], a[128:131], a[64:67], v[84:87]
  ds_read_b128 a[80:83], v4 offset:10240
  v_mfma_f32_16x16x32_bf16 v[88:91], a[128:131], a[68:71], v[88:91]
  buffer_load_dwordx4 a[120:123], v2, s[8:11], s20 offen offset:1024
  v_mfma_f32_16x16x32_bf16 v[92:95], a[128:131], a[72:75], v[92:95]
  ds_read_b128 a[84:87], v4 offset:12288
  buffer_load_dwordx4 a[124:127], v2, s[8:11], s20 offen offset:2048
  v_mfma_f32_16x16x32_bf16 v[96:99], a[132:135], a[60:63], v[96:99]
  v_mfma_f32_16x16x32_bf16 v[68:71], a[92:95], a[92:95], v[68:71]
  ds_read_b128 a[88:91], v4 offset:14336
  v_mfma_f32_16x16x32_bf16 v[100:103], a[132:135], a[64:67], v[100:103]
  s_add_u32 s20, s20, 3072
  v_mfma_f32_16x16x32_bf16 v[104:107], a[132:135], a[68:71], v[104:107]
  ds_read_b128 a[96:99], v15 offset:8192
  buffer_load_dwordx4 a[188:191], v2, s[8:11], s20 offen offset:0
  v_mfma_f32_16x16x32_bf16 v[108:111], a[132:135], a[72:75], v[108:111]
  buffer_load_dwordx4 a[192:195], v2, s[8:11], s20 offen offset:1024
  v_mfma_f32_16x16x32_bf16 v[112:115], a[136:139], a[60:63], v[112:115]
  buffer_load_dwordx4 a[196:199], v2, s[8:11], s20 offen offset:2048
  v_mfma_f32_16x16x32_bf16 v[116:119], a[136:139], a[64:67], v[116:119]
  s_add_u32 s20, s20, 3072
  s_add_u32 m0, s24, 40960
  s_add_u32 s23, s23, 128
  buffer_load_dwordx4 v235, s[8:11], s23 offen lds
  v_mfma_f32_16x16x32_bf16 v[120:123], a[136:139], a[68:71], v[120:123]
  v_mfma_f32_16x16x32_bf16 v[124:127], a[136:139], a[72:75], v[124:127]
  s_add_u32 m0, s24, 41984
  s_nop 0
  buffer_load_dwordx4 v236, s[8:11], s23 offen lds
  s_waitcnt vmcnt(24) lgkmcnt(0)
  v_mfma_f32_16x16x32_bf16 v[80:83], a[140:143], a[76:79], v[80:83]
  ds_read_b128 a[60:63], v3 offset:16384
  buffer_load_dwordx4 a[128:131], v2, s[8:11], s20 offen offset:0
  v_mfma_f32_16x16x32_bf16 v[84:87], a[140:143], a[80:83], v[84:87]
  ds_read_b128 a[64:67], v3 offset:18432
  v_mfma_f32_16x16x32_bf16 v[88:91], a[140:143], a[84:87], v[88:91]
  buffer_load_dwordx4 a[132:135], v2, s[8:11], s20 offen offset:1024
  v_mfma_f32_16x16x32_bf16 v[92:95], a[140:143], a[88:91], v[92:95]
  ds_read_b128 a[68:71], v3 offset:20480
  buffer_load_dwordx4 a[136:139], v2, s[8:11], s20 offen offset:2048
  v_mfma_f32_16x16x32_bf16 v[96:99], a[144:147], a[76:79], v[96:99]
  v_mfma_f32_16x16x32_bf16 v[68:71], a[96:99], a[96:99], v[68:71]
  ds_read_b128 a[72:75], v3 offset:22528
  v_mfma_f32_16x16x32_bf16 v[100:103], a[144:147], a[80:83], v[100:103]
  s_add_u32 s20, s20, 3072
  v_mfma_f32_16x16x32_bf16 v[104:107], a[144:147], a[84:87], v[104:107]
  ds_read_b128 a[92:95], v14 offset:16384
  buffer_load_dwordx4 a[200:203], v2, s[8:11], s20 offen offset:0
  v_mfma_f32_16x16x32_bf16 v[108:111], a[144:147], a[88:91], v[108:111]
  buffer_load_dwordx4 a[204:207], v2, s[8:11], s20 offen offset:1024
  v_mfma_f32_16x16x32_bf16 v[112:115], a[148:151], a[76:79], v[112:115]
  buffer_load_dwordx4 a[208:211], v2, s[8:11], s20 offen offset:2048
  v_mfma_f32_16x16x32_bf16 v[116:119], a[148:151], a[80:83], v[116:119]
  s_add_u32 s20, s20, 3072
  s_add_u32 m0, s24, 49152
  s_add_u32 s23, s23, 128
  buffer_load_dwordx4 v235, s[8:11], s23 offen lds
  v_mfma_f32_16x16x32_bf16 v[120:123], a[148:151], a[84:87], v[120:123]
  v_mfma_f32_16x16x32_bf16 v[124:127], a[148:151], a[88:91], v[124:127]
  s_add_u32 m0, s24, 50176
  s_nop 0
  buffer_load_dwordx4 v236, s[8:11], s23 offen lds
  s_waitcnt vmcnt(29) lgkmcnt(0)
  v_mfma_f32_16x16x32_bf16 v[80:83], a[152:155], a[60:63], v[80:83]
  ds_read_b128 a[76:79], v4 offset:16384
  v_mfma_f32_16x16x32_bf16 v[84:87], a[152:155], a[64:67], v[84:87]
  buffer_load_dwordx4 a[140:143], v2, s[8:11], s20 offen offset:0
  v_mfma_f32_16x16x32_bf16 v[88:91], a[152:155], a[68:71], v[88:91]
  ds_read_b128 a[80:83], v4 offset:18432
  v_mfma_f32_16x16x32_bf16 v[92:95], a[152:155], a[72:75], v[92:95]
  buffer_load_dwordx4 a[144:147], v2, s[8:11], s20 offen offset:1024
  v_mfma_f32_16x16x32_bf16 v[96:99], a[156:159], a[60:63], v[96:99]
  v_mfma_f32_16x16x32_bf16 v[68:71], a[92:95], a[92:95], v[68:71]
  ds_read_b128 a[84:87], v4 offset:20480
  v_mfma_f32_16x16x32_bf16 v[100:103], a[156:159], a[64:67], v[100:103]
  buffer_load_dwordx4 a[148:151], v2, s[8:11], s20 offen offset:2048
  v_mfma_f32_16x16x32_bf16 v[104:107], a[156:159], a[68:71], v[104:107]
  ds_read_b128 a[88:91], v4 offset:22528
  v_mfma_f32_16x16x32_bf16 v[108:111], a[156:159], a[72:75], v[108:111]
  s_add_u32 s20, s20, 3072
  v_mfma_f32_16x16x32_bf16 v[112:115], a[160:163], a[60:63], v[112:115]
  ds_read_b128 a[96:99], v15 offset:16384
  s_add_u32 m0, s24, 57344
  s_add_u32 s23, s23, 128
  buffer_load_dwordx4 v235, s[8:11], s23 offen lds
  v_mfma_f32_16x16x32_bf16 v[116:119], a[160:163], a[64:67], v[116:119]
  v_mfma_f32_16x16x32_bf16 v[120:123], a[160:163], a[68:71], v[120:123]
  s_add_u32 m0, s24, 58368
  s_nop 0
  buffer_load_dwordx4 v236, s[8:11], s23 offen lds
  v_mfma_f32_16x16x32_bf16 v[124:127], a[160:163], a[72:75], v[124:127]
  s_waitcnt vmcnt(13) lgkmcnt(0)
  s_barrier
  v_mfma_f32_16x16x32_bf16 v[80:83], a[164:167], a[76:79], v[80:83]
  ds_read_b128 a[60:63], v3 offset:24576
  v_mfma_f32_16x16x32_bf16 v[84:87], a[164:167], a[80:83], v[84:87]
  buffer_load_dwordx4 a[152:155], v2, s[8:11], s20 offen offset:0
  v_mfma_f32_16x16x32_bf16 v[88:91], a[164:167], a[84:87], v[88:91]
  ds_read_b128 a[64:67], v3 offset:26624
  v_mfma_f32_16x16x32_bf16 v[92:95], a[164:167], a[88:91], v[92:95]
  buffer_load_dwordx4 a[156:159], v2, s[8:11], s20 offen offset:1024
  v_mfma_f32_16x16x32_bf16 v[96:99], a[168:171], a[76:79], v[96:99]
  v_mfma_f32_16x16x32_bf16 v[68:71], a[96:99], a[96:99], v[68:71]
  ds_read_b128 a[68:71], v3 offset:28672
  v_mfma_f32_16x16x32_bf16 v[100:103], a[168:171], a[80:83], v[100:103]
  buffer_load_dwordx4 a[160:163], v2, s[8:11], s20 offen offset:2048
  v_mfma_f32_16x16x32_bf16 v[104:107], a[168:171], a[84:87], v[104:107]
  ds_read_b128 a[72:75], v3 offset:30720
  v_mfma_f32_16x16x32_bf16 v[108:111], a[168:171], a[88:91], v[108:111]
  s_add_u32 s20, s20, 3072
  v_mfma_f32_16x16x32_bf16 v[112:115], a[172:175], a[76:79], v[112:115]
  ds_read_b128 a[92:95], v14 offset:24576
  s_add_u32 m0, s24, 65536
  s_add_u32 s23, s23, 128
  buffer_load_dwordx4 v235, s[8:11], s23 offen lds
  v_mfma_f32_16x16x32_bf16 v[116:119], a[172:175], a[80:83], v[116:119]
  v_mfma_f32_16x16x32_bf16 v[120:123], a[172:175], a[84:87], v[120:123]
  s_add_u32 m0, s24, 66560
  s_nop 0
  buffer_load_dwordx4 v236, s[8:11], s23 offen lds
  v_mfma_f32_16x16x32_bf16 v[124:127], a[172:175], a[88:91], v[124:127]
  s_waitcnt lgkmcnt(0)
  v_mfma_f32_16x16x32_bf16 v[80:83], a[104:107], a[60:63], v[80:83]
  ds_read_b128 a[76:79], v4 offset:24576
  v_mfma_f32_16x16x32_bf16 v[84:87], a[104:107], a[64:67], v[84:87]
  buffer_load_dwordx4 a[164:167], v2, s[8:11], s20 offen offset:0
  v_mfma_f32_16x16x32_bf16 v[88:91], a[104:107], a[68:71], v[88:91]
  ds_read_b128 a[80:83], v4 offset:26624
  v_mfma_f32_16x16x32_bf16 v[92:95], a[104:107], a[72:75], v[92:95]
  buffer_load_dwordx4 a[168:171], v2, s[8:11], s20 offen offset:1024
  v_mfma_f32_16x16x32_bf16 v[96:99], a[108:111], a[60:63], v[96:99]
  v_mfma_f32_16x16x32_bf16 v[68:71], a[92:95], a[92:95], v[68:71]
  ds_read_b128 a[84:87], v4 offset:28672
  v_mfma_f32_16x16x32_bf16 v[100:103], a[108:111], a[64:67], v[100:103]
  buffer_load_dwordx4 a[172:175], v2, s[8:11], s20 offen offset:2048
  v_mfma_f32_16x16x32_bf16 v[104:107], a[108:111], a[68:71], v[104:107]
  ds_read_b128 a[88:91], v4 offset:30720
  v_mfma_f32_16x16x32_bf16 v[108:111], a[108:111], a[72:75], v[108:111]
  s_add_u32 s20, s20, 3072
  v_mfma_f32_16x16x32_bf16 v[112:115], a[112:115], a[60:63], v[112:115]
  ds_read_b128 a[96:99], v15 offset:24576
  v_mfma_f32_16x16x32_bf16 v[116:119], a[112:115], a[64:67], v[116:119]
  v_mfma_f32_16x16x32_bf16 v[120:123], a[112:115], a[68:71], v[120:123]
  v_mfma_f32_16x16x32_bf16 v[124:127], a[112:115], a[72:75], v[124:127]
  s_waitcnt lgkmcnt(0)
  v_mfma_f32_16x16x32_bf16 v[80:83], a[176:179], a[76:79], v[80:83]
  ds_read_b128 a[60:63], v3 offset:32768
  v_mfma_f32_16x16x32_bf16 v[84:87], a[176:179], a[80:83], v[84:87]
  buffer_load_dwordx4 a[104:107], v2, s[8:11], s20 offen offset:0
  v_mfma_f32_16x16x32_bf16 v[88:91], a[176:179], a[84:87], v[88:91]
  ds_read_b128 a[64:67], v3 offset:34816
  buffer_load_dwordx2 v[34:35], v237, s[12:15], s30 offen offset:0
  v_mfma_f32_16x16x32_bf16 v[92:95], a[176:179], a[88:91], v[92:95]
  buffer_load_dwordx4 a[108:111], v2, s[8:11], s20 offen offset:1024
  v_mfma_f32_16x16x32_bf16 v[96:99], a[180:183], a[76:79], v[96:99]
  v_mfma_f32_16x16x32_bf16 v[68:71], a[96:99], a[96:99], v[68:71]
  ds_read_b128 a[68:71], v3 offset:36864
  v_mfma_f32_16x16x32_bf16 v[100:103], a[180:183], a[80:83], v[100:103]
  buffer_load_dwordx4 a[112:115], v2, s[8:11], s20 offen offset:2048
  v_mfma_f32_16x16x32_bf16 v[104:107], a[180:183], a[84:87], v[104:107]
  ds_read_b128 a[72:75], v3 offset:38912
  v_mfma_f32_16x16x32_bf16 v[108:111], a[180:183], a[88:91], v[108:111]
  s_add_u32 s20, s20, 3072
  v_mfma_f32_16x16x32_bf16 v[112:115], a[184:187], a[76:79], v[112:115]
  ds_read_b128 a[92:95], v14 offset:32768
  v_mfma_f32_16x16x32_bf16 v[116:119], a[184:187], a[80:83], v[116:119]
  v_mfma_f32_16x16x32_bf16 v[120:123], a[184:187], a[84:87], v[120:123]
  buffer_load_dwordx2 v[36:37], v237, s[12:15], s30 offen offset:32
  v_mfma_f32_16x16x32_bf16 v[124:127], a[184:187], a[88:91], v[124:127]
  buffer_load_dwordx2 v[38:39], v237, s[12:15], s30 offen offset:64
  s_waitcnt lgkmcnt(0)
  v_mfma_f32_16x16x32_bf16 v[80:83], a[116:119], a[60:63], v[80:83]
  ds_read_b128 a[76:79], v4 offset:32768
  v_mfma_f32_16x16x32_bf16 v[84:87], a[116:119], a[64:67], v[84:87]
  buffer_load_dwordx4 a[176:179], v2, s[8:11], s20 offen offset:0
  v_mfma_f32_16x16x32_bf16 v[88:91], a[116:119], a[68:71], v[88:91]
  ds_read_b128 a[80:83], v4 offset:34816
  buffer_load_dwordx2 v[40:41], v237, s[12:15], s30 offen offset:96
  v_mfma_f32_16x16x32_bf16 v[92:95], a[116:119], a[72:75], v[92:95]
  buffer_load_dwordx4 a[180:183], v2, s[8:11], s20 offen offset:1024
  v_mfma_f32_16x16x32_bf16 v[96:99], a[120:123], a[60:63], v[96:99]
  v_mfma_f32_16x16x32_bf16 v[68:71], a[92:95], a[92:95], v[68:71]
  ds_read_b128 a[84:87], v4 offset:36864
  v_mfma_f32_16x16x32_bf16 v[100:103], a[120:123], a[64:67], v[100:103]
  buffer_load_dwordx4 a[184:187], v2, s[8:11], s20 offen offset:2048
  v_mfma_f32_16x16x32_bf16 v[104:107], a[120:123], a[68:71], v[104:107]
  ds_read_b128 a[88:91], v4 offset:38912
  v_mfma_f32_16x16x32_bf16 v[108:111], a[120:123], a[72:75], v[108:111]
  s_add_u32 s20, s20, 3072
  v_mfma_f32_16x16x32_bf16 v[112:115], a[124:127], a[60:63], v[112:115]
  ds_read_b128 a[96:99], v15 offset:32768
  v_mfma_f32_16x16x32_bf16 v[116:119], a[124:127], a[64:67], v[116:119]
  v_mfma_f32_16x16x32_bf16 v[120:123], a[124:127], a[68:71], v[120:123]
  buffer_load_dwordx2 v[42:43], v237, s[12:15], s30 offen offset:128
  v_mfma_f32_16x16x32_bf16 v[124:127], a[124:127], a[72:75], v[124:127]
  buffer_load_dwordx2 v[44:45], v237, s[12:15], s30 offen offset:160
  s_waitcnt lgkmcnt(0)
  v_mfma_f32_16x16x32_bf16 v[80:83], a[188:191], a[76:79], v[80:83]
  ds_read_b128 a[60:63], v3 offset:40960
  v_mfma_f32_16x16x32_bf16 v[84:87], a[188:191], a[80:83], v[84:87]
  buffer_load_dwordx4 a[116:119], v2, s[8:11], s20 offen offset:0
  v_mfma_f32_16x16x32_bf16 v[88:91], a[188:191], a[84:87], v[88:91]
  ds_read_b128 a[64:67], v3 offset:43008
  buffer_load_dwordx2 v[46:47], v237, s[12:15], s30 offen offset:192
  v_mfma_f32_16x16x32_bf16 v[92:95], a[188:191], a[88:91], v[92:95]
  buffer_load_dwordx4 a[120:123], v2, s[8:11], s20 offen offset:1024
  v_mfma_f32_16x16x32_bf16 v[96:99], a[192:195], a[76:79], v[96:99]
  v_mfma_f32_16x16x32_bf16 v[68:71], a[96:99], a[96:99], v[68:71]
  ds_read_b128 a[68:71], v3 offset:45056
  v_mfma_f32_16x16x32_bf16 v[100:103], a[192:195], a[80:83], v[100:103]
  buffer_load_dwordx4 a[124:127], v2, s[8:11], s20 offen offset:2048
  v_mfma_f32_16x16x32_bf16 v[104:107], a[192:195], a[84:87], v[104:107]
  ds_read_b128 a[72:75], v3 offset:47104
  v_mfma_f32_16x16x32_bf16 v[108:111], a[192:195], a[88:91], v[108:111]
  s_add_u32 s20, s20, 3072
  v_mfma_f32_16x16x32_bf16 v[112:115], a[196:199], a[76:79], v[112:115]
  ds_read_b128 a[92:95], v14 offset:40960
  v_mfma_f32_16x16x32_bf16 v[116:119], a[196:199], a[80:83], v[116:119]
  v_mfma_f32_16x16x32_bf16 v[120:123], a[196:199], a[84:87], v[120:123]
  buffer_load_dwordx2 v[48:49], v237, s[12:15], s30 offen offset:224
  v_mfma_f32_16x16x32_bf16 v[124:127], a[196:199], a[88:91], v[124:127]
  buffer_load_dwordx2 v[50:51], v237, s[12:15], s30 offen offset:256
  s_waitcnt vmcnt(36) lgkmcnt(0)
  v_mfma_f32_16x16x32_bf16 v[80:83], a[128:131], a[60:63], v[80:83]
  ds_read_b128 a[76:79], v4 offset:40960
  v_mfma_f32_16x16x32_bf16 v[84:87], a[128:131], a[64:67], v[84:87]
  buffer_load_dwordx4 a[188:191], v2, s[8:11], s20 offen offset:0
  v_mfma_f32_16x16x32_bf16 v[88:91], a[128:131], a[68:71], v[88:91]
  ds_read_b128 a[80:83], v4 offset:43008
  v_mfma_f32_16x16x32_bf16 v[92:95], a[128:131], a[72:75], v[92:95]
  buffer_load_dwordx4 a[192:195], v2, s[8:11], s20 offen offset:1024
  v_mfma_f32_16x16x32_bf16 v[96:99], a[132:135], a[60:63], v[96:99]
  v_mfma_f32_16x16x32_bf16 v[68:71], a[92:95], a[92:95], v[68:71]
  ds_read_b128 a[84:87], v4 offset:45056
  v_mfma_f32_16x16x32_bf16 v[100:103], a[132:135], a[64:67], v[100:103]
  buffer_load_dwordx4 a[196:199], v2, s[8:11], s20 offen offset:2048
  v_mfma_f32_16x16x32_bf16 v[104:107], a[132:135], a[68:71], v[104:107]
  ds_read_b128 a[88:91], v4 offset:47104
  v_mfma_f32_16x16x32_bf16 v[108:111], a[132:135], a[72:75], v[108:111]
  s_add_u32 s20, s20, 3072
  v_mfma_f32_16x16x32_bf16 v[112:115], a[136:139], a[60:63], v[112:115]
  ds_read_b128 a[96:99], v15 offset:40960
  v_mfma_f32_16x16x32_bf16 v[116:119], a[136:139], a[64:67], v[116:119]
  v_mfma_f32_16x16x32_bf16 v[120:123], a[136:139], a[68:71], v[120:123]
  v_mfma_f32_16x16x32_bf16 v[124:127], a[136:139], a[72:75], v[124:127]
  s_waitcnt vmcnt(24) lgkmcnt(0)
  s_barrier
  v_mfma_f32_16x16x32_bf16 v[80:83], a[200:203], a[76:79], v[80:83]
  ds_read_b128 a[60:63], v3 offset:49152
  v_mfma_f32_16x16x32_bf16 v[84:87], a[200:203], a[80:83], v[84:87]
  buffer_load_dwordx4 a[128:131], v2, s[8:11], s20 offen offset:0
  v_mfma_f32_16x16x32_bf16 v[88:91], a[200:203], a[84:87], v[88:91]
  ds_read_b128 a[64:67], v3 offset:51200
  v_mfma_f32_16x16x32_bf16 v[92:95], a[200:203], a[88:91], v[92:95]
  buffer_load_dwordx4 a[132:135], v2, s[8:11], s20 offen offset:1024
  v_mfma_f32_16x16x32_bf16 v[96:99], a[204:207], a[76:79], v[96:99]
  v_mfma_f32_16x16x32_bf16 v[68:71], a[96:99], a[96:99], v[68:71]
  ds_read_b128 a[68:71], v3 offset:53248
  v_mfma_f32_16x16x32_bf16 v[100:103], a[204:207], a[80:83], v[100:103]
  buffer_load_dwordx4 a[136:139], v2, s[8:11], s20 offen offset:2048
  v_mfma_f32_16x16x32_bf16 v[104:107], a[204:207], a[84:87], v[104:107]
  ds_read_b128 a[72:75], v3 offset:55296
  v_mfma_f32_16x16x32_bf16 v[108:111], a[204:207], a[88:91], v[108:111]
  s_add_u32 s20, s20, 3072
  v_mfma_f32_16x16x32_bf16 v[112:115], a[208:211], a[76:79], v[112:115]
  ds_read_b128 a[92:95], v14 offset:49152
  v_mfma_f32_16x16x32_bf16 v[116:119], a[208:211], a[80:83], v[116:119]
  v_mfma_f32_16x16x32_bf16 v[120:123], a[208:211], a[84:87], v[120:123]
  v_mfma_f32_16x16x32_bf16 v[124:127], a[208:211], a[88:91], v[124:127]
  s_waitcnt lgkmcnt(0)
  v_mfma_f32_16x16x32_bf16 v[80:83], a[140:143], a[60:63], v[80:83]
  ds_read_b128 a[76:79], v4 offset:49152
  v_mfma_f32_16x16x32_bf16 v[84:87], a[140:143], a[64:67], v[84:87]
  buffer_load_dwordx4 a[200:203], v2, s[8:11], s20 offen offset:0
  v_mfma_f32_16x16x32_bf16 v[88:91], a[140:143], a[68:71], v[88:91]
  ds_read_b128 a[80:83], v4 offset:51200
  v_mfma_f32_16x16x32_bf16 v[92:95], a[140:143], a[72:75], v[92:95]
  buffer_load_dwordx4 a[204:207], v2, s[8:11], s20 offen offset:1024
  v_mfma_f32_16x16x32_bf16 v[96:99], a[144:147], a[60:63], v[96:99]
  v_mfma_f32_16x16x32_bf16 v[68:71], a[92:95], a[92:95], v[68:71]
  ds_read_b128 a[84:87], v4 offset:53248
  v_mfma_f32_16x16x32_bf16 v[100:103], a[144:147], a[64:67], v[100:103]
  buffer_load_dwordx4 a[208:211], v2, s[8:11], s20 offen offset:2048
  v_mfma_f32_16x16x32_bf16 v[104:107], a[144:147], a[68:71], v[104:107]
  ds_read_b128 a[88:91], v4 offset:55296
  v_mfma_f32_16x16x32_bf16 v[108:111], a[144:147], a[72:75], v[108:111]
  s_add_u32 s20, s20, 3072
  v_mfma_f32_16x16x32_bf16 v[112:115], a[148:151], a[60:63], v[112:115]
  ds_read_b128 a[96:99], v15 offset:49152
  v_mfma_f32_16x16x32_bf16 v[116:119], a[148:151], a[64:67], v[116:119]
  v_mfma_f32_16x16x32_bf16 v[120:123], a[148:151], a[68:71], v[120:123]
  v_mfma_f32_16x16x32_bf16 v[124:127], a[148:151], a[72:75], v[124:127]
  s_waitcnt lgkmcnt(0)
  v_mfma_f32_16x16x32_bf16 v[80:83], a[152:155], a[76:79], v[80:83]
  ds_read_b128 a[60:63], v3 offset:57344
  v_mfma_f32_16x16x32_bf16 v[84:87], a[152:155], a[80:83], v[84:87]
  buffer_load_dwordx4 a[140:143], v2, s[8:11], s20 offen offset:0
  v_mfma_f32_16x16x32_bf16 v[88:91], a[152:155], a[84:87], v[88:91]
  ds_read_b128 a[64:67], v3 offset:59392
  v_mfma_f32_16x16x32_bf16 v[92:95], a[152:155], a[88:91], v[92:95]
  buffer_load_dwordx4 a[144:147], v2, s[8:11], s20 offen offset:1024
  v_mfma_f32_16x16x32_bf16 v[96:99], a[156:159], a[76:79], v[96:99]
  v_mfma_f32_16x16x32_bf16 v[68:71], a[96:99], a[96:99], v[68:71]
  ds_read_b128 a[68:71], v3 offset:61440
  v_mfma_f32_16x16x32_bf16 v[100:103], a[156:159], a[80:83], v[100:103]
  buffer_load_dwordx4 a[148:151], v2, s[8:11], s20 offen offset:2048
  v_mfma_f32_16x16x32_bf16 v[104:107], a[156:159], a[84:87], v[104:107]
  ds_read_b128 a[72:75], v3 offset:63488
  v_mfma_f32_16x16x32_bf16 v[108:111], a[156:159], a[88:91], v[108:111]
  s_add_u32 s20, s20, 3072
  v_mfma_f32_16x16x32_bf16 v[112:115], a[160:163], a[76:79], v[112:115]
  ds_read_b128 a[92:95], v14 offset:57344
  v_mfma_f32_16x16x32_bf16 v[116:119], a[160:163], a[80:83], v[116:119]
  v_mfma_f32_16x16x32_bf16 v[120:123], a[160:163], a[84:87], v[120:123]
  v_mfma_f32_16x16x32_bf16 v[124:127], a[160:163], a[88:91], v[124:127]
  s_waitcnt vmcnt(30) lgkmcnt(0)
  v_mfma_f32_16x16x32_bf16 v[80:83], a[164:167], a[60:63], v[80:83]
  ds_read_b128 a[76:79], v4 offset:57344
  v_mfma_f32_16x16x32_bf16 v[84:87], a[164:167], a[64:67], v[84:87]
  buffer_load_dwordx4 a[152:155], v2, s[8:11], s20 offen offset:0
  v_mfma_f32_16x16x32_bf16 v[88:91], a[164:167], a[68:71], v[88:91]
  ds_read_b128 a[80:83], v4 offset:59392
  v_mfma_f32_16x16x32_bf16 v[92:95], a[164:167], a[72:75], v[92:95]
  buffer_load_dwordx4 a[156:159], v2, s[8:11], s20 offen offset:1024
  v_mfma_f32_16x16x32_bf16 v[96:99], a[168:171], a[60:63], v[96:99]
  v_mfma_f32_16x16x32_bf16 v[68:71], a[92:95], a[92:95], v[68:71]
  ds_read_b128 a[84:87], v4 offset:61440
  v_mfma_f32_16x16x32_bf16 v[100:103], a[168:171], a[64:67], v[100:103]
  buffer_load_dwordx4 a[160:163], v2, s[8:11], s20 offen offset:2048
  v_mfma_f32_16x16x32_bf16 v[104:107], a[168:171], a[68:71], v[104:107]
  ds_read_b128 a[88:91], v4 offset:63488
  v_mfma_f32_16x16x32_bf16 v[108:111], a[168:171], a[72:75], v[108:111]
  s_add_u32 s20, s20, 3072
  v_mfma_f32_16x16x32_bf16 v[112:115], a[172:175], a[60:63], v[112:115]
  ds_read_b128 a[96:99], v15 offset:57344
  v_mfma_f32_16x16x32_bf16 v[116:119], a[172:175], a[64:67], v[116:119]
  v_mfma_f32_16x16x32_bf16 v[120:123], a[172:175], a[68:71], v[120:123]
  v_mfma_f32_16x16x32_bf16 v[124:127], a[172:175], a[72:75], v[124:127]
  s_waitcnt vmcnt(29) lgkmcnt(0)
  v_mfma_f32_16x16x32_bf16 v[80:83], a[104:107], a[76:79], v[80:83]
  ds_read_b128 a[60:63], v5 offset:0
  v_mfma_f32_16x16x32_bf16 v[84:87], a[104:107], a[80:83], v[84:87]
  buffer_load_dwordx4 a[164:167], v2, s[8:11], s20 offen offset:0
  v_mfma_f32_16x16x32_bf16 v[88:91], a[104:107], a[84:87], v[88:91]
  ds_read_b128 a[64:67], v5 offset:2048
  v_mfma_f32_16x16x32_bf16 v[92:95], a[104:107], a[88:91], v[92:95]
  buffer_load_dwordx4 a[168:171], v2, s[8:11], s20 offen offset:1024
  v_mfma_f32_16x16x32_bf16 v[96:99], a[108:111], a[76:79], v[96:99]
  v_mfma_f32_16x16x32_bf16 v[68:71], a[96:99], a[96:99], v[68:71]
  ds_read_b128 a[68:71], v5 offset:4096
  v_mfma_f32_16x16x32_bf16 v[100:103], a[108:111], a[80:83], v[100:103]
  buffer_load_dwordx4 a[172:175], v2, s[8:11], s20 offen offset:2048
  v_mfma_f32_16x16x32_bf16 v[104:107], a[108:111], a[84:87], v[104:107]
  ds_read_b128 a[72:75], v5 offset:6144
  v_mfma_f32_16x16x32_bf16 v[108:111], a[108:111], a[88:91], v[108:111]
  s_add_u32 s20, s20, 3072
  v_mfma_f32_16x16x32_bf16 v[112:115], a[112:115], a[76:79], v[112:115]
  ds_read_b128 a[92:95], v16 offset:0
  v_mfma_f32_16x16x32_bf16 v[116:119], a[112:115], a[80:83], v[116:119]
  v_mfma_f32_16x16x32_bf16 v[120:123], a[112:115], a[84:87], v[120:123]
  v_mfma_f32_16x16x32_bf16 v[124:127], a[112:115], a[88:91], v[124:127]
  s_waitcnt vmcnt(26) lgkmcnt(0)
  v_mfma_f32_16x16x32_bf16 v[80:83], a[176:179], a[60:63], v[80:83]
  ds_read_b128 a[76:79], v6 offset:0
  v_mfma_f32_16x16x32_bf16 v[84:87], a[176:179], a[64:67], v[84:87]
  buffer_load_dwordx4 a[104:107], v2, s[8:11], s20 offen offset:0
  v_mfma_f32_16x16x32_bf16 v[88:91], a[176:179], a[68:71], v[88:91]
  ds_read_b128 a[80:83], v6 offset:2048
  v_mfma_f32_16x16x32_bf16 v[92:95], a[176:179], a[72:75], v[92:95]
  buffer_load_dwordx4 a[108:111], v2, s[8:11], s20 offen offset:1024
  v_mfma_f32_16x16x32_bf16 v[96:99], a[180:183], a[60:63], v[96:99]
  v_mfma_f32_16x16x32_bf16 v[68:71], a[92:95], a[92:95], v[68:71]
  ds_read_b128 a[84:87], v6 offset:4096
  v_mfma_f32_16x16x32_bf16 v[100:103], a[180:183], a[64:67], v[100:103]
  buffer_load_dwordx4 a[112:115], v2, s[8:11], s20 offen offset:2048
  v_mfma_f32_16x16x32_bf16 v[104:107], a[180:183], a[68:71], v[104:107]
  ds_read_b128 a[88:91], v6 offset:6144
  v_mfma_f32_16x16x32_bf16 v[108:111], a[180:183], a[72:75], v[108:111]
  s_add_u32 s20, s20, 3072
  v_mfma_f32_16x16x32_bf16 v[112:115], a[184:187], a[60:63], v[112:115]
  ds_read_b128 a[96:99], v17 offset:0
  v_mfma_f32_16x16x32_bf16 v[116:119], a[184:187], a[64:67], v[116:119]
  v_mfma_f32_16x16x32_bf16 v[120:123], a[184:187], a[68:71], v[120:123]
  v_mfma_f32_16x16x32_bf16 v[124:127], a[184:187], a[72:75], v[124:127]
  s_waitcnt vmcnt(23) lgkmcnt(0)
  v_mfma_f32_16x16x32_bf16 v[80:83], a[116:119], a[76:79], v[80:83]
  ds_read_b128 a[60:63], v3 offset:0
  v_mfma_f32_16x16x32_bf16 v[84:87], a[116:119], a[80:83], v[84:87]
  buffer_load_dwordx4 a[176:179], v2, s[8:11], s20 offen offset:0
  v_mfma_f32_16x16x32_bf16 v[88:91], a[116:119], a[84:87], v[88:91]
  ds_read_b128 a[64:67], v3 offset:2048
  v_mfma_f32_16x16x32_bf16 v[92:95], a[116:119], a[88:91], v[92:95]
  buffer_load_dwordx4 a[180:183], v2, s[8:11], s20 offen offset:1024
  v_mfma_f32_16x16x32_bf16 v[96:99], a[120:123], a[76:79], v[96:99]
  v_mfma_f32_16x16x32_bf16 v[68:71], a[96:99], a[96:99], v[68:71]
  ds_read_b128 a[68:71], v3 offset:4096
  v_mfma_f32_16x16x32_bf16 v[100:103], a[120:123], a[80:83], v[100:103]
  buffer_load_dwordx4 a[184:187], v2, s[8:11], s20 offen offset:2048
  v_mfma_f32_16x16x32_bf16 v[104:107], a[120:123], a[84:87], v[104:107]
  ds_read_b128 a[72:75], v3 offset:6144
  v_mfma_f32_16x16x32_bf16 v[108:111], a[120:123], a[88:91], v[108:111]
  s_add_u32 s20, s20, 3072
  v_mfma_f32_16x16x32_bf16 v[112:115], a[124:127], a[76:79], v[112:115]
  v_mfma_f32_16x16x32_bf16 v[116:119], a[124:127], a[80:83], v[116:119]
  v_mfma_f32_16x16x32_bf16 v[120:123], a[124:127], a[84:87], v[120:123]
  v_mfma_f32_16x16x32_bf16 v[124:127], a[124:127], a[88:91], v[124:127]
  s_nop 7
  v_and_b32 v244, 3, v1
  v_cmp_eq_u32 vcc, 1, v244
  s_nop 1
  v_cndmask_b32 v245, v68, v69, vcc
  v_cmp_eq_u32 vcc, 2, v244
  s_nop 1
  v_cndmask_b32 v245, v245, v70, vcc
  v_cmp_eq_u32 vcc, 3, v244
  s_nop 1
  v_cndmask_b32 v245, v245, v71, vcc
  v_mov_b32 v246, 0x3727c5ac
  v_fmac_f32 v246, 0x3ae38e39, v245
  v_rsq_f32 v246, v246
  v_lshrrev_b32 v247, 2, v225
  v_mul_f32 v246, v53, v246
  s_lshl_b32 s19, s18, 6
  v_lshlrev_b32 v248, 2, v225
  v_add_u32 v248, s19, v248
  v_add_u32 v248, 147456, v248
  v_cmp_eq_u32 vcc, v247, v226
  s_and_saveexec_b64 s[28:29], vcc
  ds_write_b32 v248, v246
  s_mov_b64 exec, s[28:29]
  s_waitcnt vmcnt(21) lgkmcnt(0)
  s_barrier
  v_lshlrev_b32 v249, 2, v225
  v_add_u32 v249, 147456, v249
  ds_read_b32 v18, v249 offset:0
  ds_read_b32 v19, v249 offset:64
  ds_read_b32 v20, v249 offset:128
  ds_read_b32 v21, v249 offset:192
  v_mfma_f32_16x16x32_bf16 v[128:131], a[188:191], a[60:63], 0
  ds_read_b128 a[76:79], v4 offset:0
  v_mfma_f32_16x16x32_bf16 v[132:135], a[188:191], a[64:67], 0
  buffer_load_dwordx4 a[116:119], v2, s[8:11], s20 offen offset:0
  v_lshlrev_b32 v22, 16, v34
  v_mfma_f32_16x16x32_bf16 v[136:139], a[188:191], a[68:71], 0
  ds_read_b128 a[80:83], v4 offset:2048
  v_and_b32 v23, 0xffff0000, v34
  v_mfma_f32_16x16x32_bf16 v[140:143], a[188:191], a[72:75], 0
  buffer_load_dwordx4 a[120:123], v2, s[8:11], s20 offen offset:1024
  v_mfma_f32_16x16x32_bf16 v[144:147], a[192:195], a[60:63], 0
  ds_read_b128 a[84:87], v4 offset:4096
  v_lshlrev_b32 v24, 16, v35
  v_mfma_f32_16x16x32_bf16 v[148:151], a[192:195], a[64:67], 0
  buffer_load_dwordx4 a[124:127], v2, s[8:11], s20 offen offset:2048
  v_and_b32 v25, 0xffff0000, v35
  v_mfma_f32_16x16x32_bf16 v[152:155], a[192:195], a[68:71], 0
  ds_read_b128 a[88:91], v4 offset:6144
  v_mul_f32 v22, v53, v22
  v_mfma_f32_16x16x32_bf16 v[156:159], a[192:195], a[72:75], 0
  s_add_u32 s20, s20, 3072
  v_mul_f32 v23, v53, v23
  v_mfma_f32_16x16x32_bf16 v[160:163], a[196:199], a[60:63], 0
  v_mul_f32 v24, v53, v24
  v_mul_f32 v25, v53, v25
  v_mfma_f32_16x16x32_bf16 v[164:167], a[196:199], a[64:67], 0
  v_lshlrev_b32 v26, 16, v36
  v_and_b32 v27, 0xffff0000, v36
  v_lshlrev_b32 v28, 16, v37
  v_mfma_f32_16x16x32_bf16 v[168:171], a[196:199], a[68:71], 0
  v_and_b32 v29, 0xffff0000, v37
  v_mul_f32 v26, v53, v26
  v_mfma_f32_16x16x32_bf16 v[172:175], a[196:199], a[72:75], 0
  v_mul_f32 v27, v53, v27
  v_mul_f32 v28, v53, v28
  s_waitcnt vmcnt(21) lgkmcnt(0)
  v_mfma_f32_16x16x32_bf16 v[128:131], a[128:131], a[76:79], v[128:131]
  ds_read_b128 a[60:63], v3 offset:8192
  v_mul_f32 v29, v53, v29
  v_mfma_f32_16x16x32_bf16 v[132:135], a[128:131], a[80:83], v[132:135]
  buffer_load_dwordx4 a[188:191], v2, s[8:11], s20 offen offset:0
  v_lshlrev_b32 v30, 16, v38
  v_mfma_f32_16x16x32_bf16 v[136:139], a[128:131], a[84:87], v[136:139]
  ds_read_b128 a[64:67], v3 offset:10240
  v_and_b32 v31, 0xffff0000, v38
  v_mfma_f32_16x16x32_bf16 v[140:143], a[128:131], a[88:91], v[140:143]
  buffer_load_dwordx4 a[192:195], v2, s[8:11], s20 offen offset:1024
  v_mfma_f32_16x16x32_bf16 v[144:147], a[132:135], a[76:79], v[144:147]
  ds_read_b128 a[68:71], v3 offset:12288
  v_lshlrev_b32 v32, 16, v39
  v_and_b32 v33, 0xffff0000, v39
  v_mfma_f32_16x16x32_bf16 v[148:151], a[132:135], a[80:83], v[148:151]
  buffer_load_dwordx4 a[196:199], v2, s[8:11], s20 offen offset:2048
  v_mfma_f32_16x16x32_bf16 v[152:155], a[132:135], a[84:87], v[152:155]
  ds_read_b128 a[72:75], v3 offset:14336
  v_mul_f32 v30, v53, v30
  v_mfma_f32_16x16x32_bf16 v[156:159], a[132:135], a[88:91], v[156:159]
  s_add_u32 s20, s20, 3072
  v_mul_f32 v31, v53, v31
  v_mul_f32 v32, v53, v32
  v_mfma_f32_16x16x32_bf16 v[160:163], a[136:139], a[76:79], v[160:163]
  v_mul_f32 v33, v53, v33
  v_mfma_f32_16x16x32_bf16 v[164:167], a[136:139], a[80:83], v[164:167]
  v_fma_f32 v54, v80, v18, v22
  v_fma_f32 v55, v81, v18, v23
  v_mfma_f32_16x16x32_bf16 v[168:171], a[136:139], a[84:87], v[168:171]
  v_fma_f32 v56, v82, v18, v24
  v_fma_f32 v57, v83, v18, v25
  v_fma_f32 v58, v54, v54, v52
  v_mfma_f32_16x16x32_bf16 v[172:175], a[136:139], a[88:91], v[172:175]
  v_fma_f32 v59, v55, v55, v52
  v_fma_f32 v60, v56, v56, v52
  s_waitcnt vmcnt(21) lgkmcnt(0)
  v_mfma_f32_16x16x32_bf16 v[128:131], a[200:203], a[60:63], v[128:131]
  ds_read_b128 a[76:79], v4 offset:8192
  v_fma_f32 v61, v57, v57, v52
  v_mul_f32 v58, v54, v58
  v_mfma_f32_16x16x32_bf16 v[132:135], a[200:203], a[64:67], v[132:135]
  buffer_load_dwordx4 a[128:131], v2, s[8:11], s20 offen offset:0
  v_mul_f32 v59, v55, v59
  v_mfma_f32_16x16x32_bf16 v[136:139], a[200:203], a[68:71], v[136:139]
  ds_read_b128 a[80:83], v4 offset:10240
  v_mul_f32 v60, v56, v60
  v_mul_f32 v61, v57, v61
  v_mfma_f32_16x16x32_bf16 v[140:143], a[200:203], a[72:75], v[140:143]
  buffer_load_dwordx4 a[132:135], v2, s[8:11], s20 offen offset:1024
  v_exp_f32_e64 v58, -v58
  v_mfma_f32_16x16x32_bf16 v[144:147], a[204:207], a[60:63], v[144:147]
  ds_read_b128 a[84:87], v4 offset:12288
  v_exp_f32_e64 v59, -v59
  v_mfma_f32_16x16x32_bf16 v[148:151], a[204:207], a[64:67], v[148:151]
  buffer_load_dwordx4 a[136:139], v2, s[8:11], s20 offen offset:2048
  v_mfma_f32_16x16x32_bf16 v[152:155], a[204:207], a[68:71], v[152:155]
  ds_read_b128 a[88:91], v4 offset:14336
  v_exp_f32_e64 v60, -v60
  v_mfma_f32_16x16x32_bf16 v[156:159], a[204:207], a[72:75], v[156:159]
  s_add_u32 s20, s20, 3072
  v_exp_f32_e64 v61, -v61
  v_mfma_f32_16x16x32_bf16 v[160:163], a[208:211], a[60:63], v[160:163]
  v_fma_f32 v58, v58, v53, v53
  v_fma_f32 v59, v59, v53, v53
  v_fma_f32 v60, v60, v53, v53
  v_mfma_f32_16x16x32_bf16 v[164:167], a[208:211], a[64:67], v[164:167]
  v_fma_f32 v61, v61, v53, v53
  v_rcp_f32 v58, v58
  v_mfma_f32_16x16x32_bf16 v[168:171], a[208:211], a[68:71], v[168:171]
  v_rcp_f32 v59, v59
  v_rcp_f32 v60, v60
  v_mfma_f32_16x16x32_bf16 v[172:175], a[208:211], a[72:75], v[172:175]
  v_rcp_f32 v61, v61
  s_waitcnt vmcnt(21) lgkmcnt(0)
  v_mfma_f32_16x16x32_bf16 v[128:131], a[140:143], a[76:79], v[128:131]
  ds_read_b128 a[60:63], v3 offset:16384
  v_mul_f32 v54, v54, v58
  v_mfma_f32_16x16x32_bf16 v[132:135], a[140:143], a[80:83], v[132:135]
  buffer_load_dwordx4 a[200:203], v2, s[8:11], s20 offen offset:0
  v_mul_f32 v55, v55, v59
  v_mfma_f32_16x16x32_bf16 v[136:139], a[140:143], a[84:87], v[136:139]
  ds_read_b128 a[64:67], v3 offset:18432
  v_mul_f32 v56, v56, v60
  v_mfma_f32_16x16x32_bf16 v[140:143], a[140:143], a[88:91], v[140:143]
  buffer_load_dwordx4 a[204:207], v2, s[8:11], s20 offen offset:1024
  v_mul_f32 v57, v57, v61
  v_mfma_f32_16x16x32_bf16 v[144:147], a[144:147], a[76:79], v[144:147]
  ds_read_b128 a[68:71], v3 offset:20480
  v_cvt_pk_bf16_f32 v62, v54, v55
  v_mfma_f32_16x16x32_bf16 v[148:151], a[144:147], a[80:83], v[148:151]
  buffer_load_dwordx4 a[208:211], v2, s[8:11], s20 offen offset:2048
  v_mfma_f32_16x16x32_bf16 v[152:155], a[144:147], a[84:87], v[152:155]
  ds_read_b128 a[72:75], v3 offset:22528
  v_cvt_pk_bf16_f32 v63, v56, v57
  v_mfma_f32_16x16x32_bf16 v[156:159], a[144:147], a[88:91], v[156:159]
  s_add_u32 s20, s20, 3072
  ds_write_b64 v11, v[62:63] offset:0
  v_fma_f32 v54, v84, v19, v22
  v_mfma_f32_16x16x32_bf16 v[160:163], a[148:151], a[76:79], v[160:163]
  v_fma_f32 v55, v85, v19, v23
  v_fma_f32 v56, v86, v19, v24
  v_mfma_f32_16x16x32_bf16 v[164:167], a[148:151], a[80:83], v[164:167]
  v_fma_f32 v57, v87, v19, v25
  v_fma_f32 v58, v54, v54, v52
  v_mfma_f32_16x16x32_bf16 v[168:171], a[148:151], a[84:87], v[168:171]
  v_fma_f32 v59, v55, v55, v52
  v_fma_f32 v60, v56, v56, v52
  v_fma_f32 v61, v57, v57, v52
  v_mfma_f32_16x16x32_bf16 v[172:175], a[148:151], a[88:91], v[172:175]
  v_mul_f32 v58, v54, v58
  v_mul_f32 v59, v55, v59
  s_waitcnt vmcnt(21) lgkmcnt(1)
  v_mfma_f32_16x16x32_bf16 v[128:131], a[152:155], a[60:63], v[128:131]
  ds_read_b128 a[76:79], v4 offset:16384
  v_mul_f32 v60, v56, v60
  v_mul_f32 v61, v57, v61
  v_mfma_f32_16x16x32_bf16 v[132:135], a[152:155], a[64:67], v[132:135]
  buffer_load_dwordx4 a[140:143], v2, s[8:11], s20 offen offset:0
  v_mfma_f32_16x16x32_bf16 v[136:139], a[152:155], a[68:71], v[136:139]
  ds_read_b128 a[80:83], v4 offset:18432
  v_exp_f32_e64 v58, -v58
  v_mfma_f32_16x16x32_bf16 v[140:143], a[152:155], a[72:75], v[140:143]
  buffer_load_dwordx4 a[144:147], v2, s[8:11], s20 offen offset:1024
  v_exp_f32_e64 v59, -v59
  v_mfma_f32_16x16x32_bf16 v[144:147], a[156:159], a[60:63], v[144:147]
  ds_read_b128 a[84:87], v4 offset:20480
  v_exp_f32_e64 v60, -v60
  v_mfma_f32_16x16x32_bf16 v[148:151], a[156:159], a[64:67], v[148:151]
  buffer_load_dwordx4 a[148:151], v2, s[8:11], s20 offen offset:2048
  v_mfma_f32_16x16x32_bf16 v[152:155], a[156:159], a[68:71], v[152:155]
  ds_read_b128 a[88:91], v4 offset:22528
  v_exp_f32_e64 v61, -v61
  v_mfma_f32_16x16x32_bf16 v[156:159], a[156:159], a[72:75], v[156:159]
  s_add_u32 s20, s20, 3072
  v_fma_f32 v58, v58, v53, v53
  v_fma_f32 v59, v59, v53, v53
  v_mfma_f32_16x16x32_bf16 v[160:163], a[160:163], a[60:63], v[160:163]
  v_fma_f32 v60, v60, v53, v53
  v_fma_f32 v61, v61, v53, v53
  v_rcp_f32 v58, v58
  v_mfma_f32_16x16x32_bf16 v[164:167], a[160:163], a[64:67], v[164:167]
  v_rcp_f32 v59, v59
  v_mfma_f32_16x16x32_bf16 v[168:171], a[160:163], a[68:71], v[168:171]
  v_rcp_f32 v60, v60
  v_rcp_f32 v61, v61
  v_mfma_f32_16x16x32_bf16 v[172:175], a[160:163], a[72:75], v[172:175]
  v_mul_f32 v54, v54, v58
  v_mul_f32 v55, v55, v59
  s_waitcnt vmcnt(21) lgkmcnt(0)
  v_mfma_f32_16x16x32_bf16 v[128:131], a[164:167], a[76:79], v[128:131]
  ds_read_b128 a[60:63], v3 offset:24576
  v_mul_f32 v56, v56, v60
  v_mfma_f32_16x16x32_bf16 v[132:135], a[164:167], a[80:83], v[132:135]
  buffer_load_dwordx4 a[152:155], v2, s[8:11], s20 offen offset:0
  v_mul_f32 v57, v57, v61
  v_mfma_f32_16x16x32_bf16 v[136:139], a[164:167], a[84:87], v[136:139]
  ds_read_b128 a[64:67], v3 offset:26624
  v_cvt_pk_bf16_f32 v64, v54, v55
  v_mfma_f32_16x16x32_bf16 v[140:143], a[164:167], a[88:91], v[140:143]
  buffer_load_dwordx4 a[156:159], v2, s[8:11], s20 offen offset:1024
  v_cvt_pk_bf16_f32 v65, v56, v57
  v_mfma_f32_16x16x32_bf16 v[144:147], a[168:171], a[76:79], v[144:147]
  ds_read_b128 a[68:71], v3 offset:28672
  ds_write_b64 v11, v[64:65] offset:2048
  v_mfma_f32_16x16x32_bf16 v[148:151], a[168:171], a[80:83], v[148:151]
  buffer_load_dwordx4 a[160:163], v2, s[8:11], s20 offen offset:2048
  v_mfma_f32_16x16x32_bf16 v[152:155], a[168:171], a[84:87], v[152:155]
  ds_read_b128 a[72:75], v3 offset:30720
  v_fma_f32 v54, v88, v20, v22
  v_mfma_f32_16x16x32_bf16 v[156:159], a[168:171], a[88:91], v[156:159]
  s_add_u32 s20, s20, 3072
  v_fma_f32 v55, v89, v20, v23
  v_fma_f32 v56, v90, v20, v24
  v_mfma_f32_16x16x32_bf16 v[160:163], a[172:175], a[76:79], v[160:163]
  v_fma_f32 v57, v91, v20, v25
  v_fma_f32 v58, v54, v54, v52
  v_mfma_f32_16x16x32_bf16 v[164:167], a[172:175], a[80:83], v[164:167]
  v_fma_f32 v59, v55, v55, v52
  v_fma_f32 v60, v56, v56, v52
  v_mfma_f32_16x16x32_bf16 v[168:171], a[172:175], a[84:87], v[168:171]
  v_fma_f32 v61, v57, v57, v52
  v_mul_f32 v58, v54, v58
  v_mul_f32 v59, v55, v59
  v_mfma_f32_16x16x32_bf16 v[172:175], a[172:175], a[88:91], v[172:175]
  v_mul_f32 v60, v56, v60
  v_mul_f32 v61, v57, v61
  s_waitcnt vmcnt(21) lgkmcnt(0)
  v_mfma_f32_16x16x32_bf16 v[128:131], a[104:107], a[60:63], v[128:131]
  ds_read_b128 a[76:79], v4 offset:24576
  v_exp_f32_e64 v58, -v58
  v_mfma_f32_16x16x32_bf16 v[132:135], a[104:107], a[64:67], v[132:135]
  buffer_load_dwordx4 a[164:167], v2, s[8:11], s20 offen offset:0
  v_exp_f32_e64 v59, -v59
  v_mfma_f32_16x16x32_bf16 v[136:139], a[104:107], a[68:71], v[136:139]
  ds_read_b128 a[80:83], v4 offset:26624
  v_exp_f32_e64 v60, -v60
  v_mfma_f32_16x16x32_bf16 v[140:143], a[104:107], a[72:75], v[140:143]
  buffer_load_dwordx4 a[168:171], v2, s[8:11], s20 offen offset:1024
  v_mfma_f32_16x16x32_bf16 v[144:147], a[108:111], a[60:63], v[144:147]
  ds_read_b128 a[84:87], v4 offset:28672
  v_exp_f32_e64 v61, -v61
  v_mfma_f32_16x16x32_bf16 v[148:151], a[108:111], a[64:67], v[148:151]
  buffer_load_dwordx4 a[172:175], v2, s[8:11], s20 offen offset:2048
  v_fma_f32 v58, v58, v53, v53
  v_mfma_f32_16x16x32_bf16 v[152:155], a[108:111], a[68:71], v[152:155]
  ds_read_b128 a[88:91], v4 offset:30720
  v_fma_f32 v59, v59, v53, v53
  v_fma_f32 v60, v60, v53, v53
  v_mfma_f32_16x16x32_bf16 v[156:159], a[108:111], a[72:75], v[156:159]
  s_add_u32 s20, s20, 3072
  v_fma_f32 v61, v61, v53, v53
  v_rcp_f32 v58, v58
  v_mfma_f32_16x16x32_bf16 v[160:163], a[112:115], a[60:63], v[160:163]
  v_rcp_f32 v59, v59
  v_mfma_f32_16x16x32_bf16 v[164:167], a[112:115], a[64:67], v[164:167]
  v_rcp_f32 v60, v60
  v_rcp_f32 v61, v61
  v_mfma_f32_16x16x32_bf16 v[168:171], a[112:115], a[68:71], v[168:171]
  v_mul_f32 v54, v54, v58
  v_mul_f32 v55, v55, v59
  v_mfma_f32_16x16x32_bf16 v[172:175], a[112:115], a[72:75], v[172:175]
  v_mul_f32 v56, v56, v60
  v_mul_f32 v57, v57, v61
  v_cvt_pk_bf16_f32 v62, v54, v55
  s_waitcnt vmcnt(21) lgkmcnt(0)
  v_mfma_f32_16x16x32_bf16 v[128:131], a[176:179], a[76:79], v[128:131]
  ds_read_b128 a[60:63], v3 offset:32768
  v_cvt_pk_bf16_f32 v63, v56, v57
  v_mfma_f32_16x16x32_bf16 v[132:135], a[176:179], a[80:83], v[132:135]
  buffer_load_dwordx4 a[104:107], v2, s[8:11], s20 offen offset:0
  ds_write_b64 v11, v[62:63] offset:4096
  v_mfma_f32_16x16x32_bf16 v[136:139], a[176:179], a[84:87], v[136:139]
  ds_read_b128 a[64:67], v3 offset:34816
  v_fma_f32 v54, v92, v21, v22
  v_mfma_f32_16x16x32_bf16 v[140:143], a[176:179], a[88:91], v[140:143]
  buffer_load_dwordx4 a[108:111], v2, s[8:11], s20 offen offset:1024
  v_fma_f32 v55, v93, v21, v23
  v_mfma_f32_16x16x32_bf16 v[144:147], a[180:183], a[76:79], v[144:147]
  ds_read_b128 a[68:71], v3 offset:36864
  v_fma_f32 v56, v94, v21, v24
  v_fma_f32 v57, v95, v21, v25
  v_mfma_f32_16x16x32_bf16 v[148:151], a[180:183], a[80:83], v[148:151]
  buffer_load_dwordx4 a[112:115], v2, s[8:11], s20 offen offset:2048
  v_mfma_f32_16x16x32_bf16 v[152:155], a[180:183], a[84:87], v[152:155]
  ds_read_b128 a[72:75], v3 offset:38912
  v_fma_f32 v58, v54, v54, v52
  v_fma_f32 v59, v55, v55, v52
  v_mfma_f32_16x16x32_bf16 v[156:159], a[180:183], a[88:91], v[156:159]
  s_add_u32 s20, s20, 3072
  v_fma_f32 v60, v56, v56, v52
  v_fma_f32 v61, v57, v57, v52
  v_mfma_f32_16x16x32_bf16 v[160:163], a[184:187], a[76:79], v[160:163]
  v_mul_f32 v58, v54, v58
  v_mul_f32 v59, v55, v59
  v_mfma_f32_16x16x32_bf16 v[164:167], a[184:187], a[80:83], v[164:167]
  v_mul_f32 v60, v56, v60
  v_mul_f32 v61, v57, v61
  v_mfma_f32_16x16x32_bf16 v[168:171], a[184:187], a[84:87], v[168:171]
  v_exp_f32_e64 v58, -v58
  v_exp_f32_e64 v59, -v59
  v_mfma_f32_16x16x32_bf16 v[172:175], a[184:187], a[88:91], v[172:175]
  v_exp_f32_e64 v60, -v60
  s_waitcnt vmcnt(21) lgkmcnt(0)
  v_mfma_f32_16x16x32_bf16 v[128:131], a[116:119], a[60:63], v[128:131]
  ds_read_b128 a[76:79], v4 offset:32768
  v_exp_f32_e64 v61, -v61
  v_mfma_f32_16x16x32_bf16 v[132:135], a[116:119], a[64:67], v[132:135]
  buffer_load_dwordx4 a[176:179], v2, s[8:11], s20 offen offset:0
  v_fma_f32 v58, v58, v53, v53
  v_mfma_f32_16x16x32_bf16 v[136:139], a[116:119], a[68:71], v[136:139]
  ds_read_b128 a[80:83], v4 offset:34816
  v_fma_f32 v59, v59, v53, v53
  v_mfma_f32_16x16x32_bf16 v[140:143], a[116:119], a[72:75], v[140:143]
  buffer_load_dwordx4 a[180:183], v2, s[8:11], s20 offen offset:1024
  v_fma_f32 v60, v60, v53, v53
  v_mfma_f32_16x16x32_bf16 v[144:147], a[120:123], a[60:63], v[144:147]
  ds_read_b128 a[84:87], v4 offset:36864
  v_fma_f32 v61, v61, v53, v53
  v_mfma_f32_16x16x32_bf16 v[148:151], a[120:123], a[64:67], v[148:151]
  buffer_load_dwordx4 a[184:187], v2, s[8:11], s20 offen offset:2048
  v_rcp_f32 v58, v58
  v_mfma_f32_16x16x32_bf16 v[152:155], a[120:123], a[68:71], v[152:155]
  ds_read_b128 a[88:91], v4 offset:38912
  v_rcp_f32 v59, v59
  v_mfma_f32_16x16x32_bf16 v[156:159], a[120:123], a[72:75], v[156:159]
  s_add_u32 s20, s20, 3072
  v_rcp_f32 v60, v60
  v_mfma_f32_16x16x32_bf16 v[160:163], a[124:127], a[60:63], v[160:163]
  v_rcp_f32 v61, v61
  v_mfma_f32_16x16x32_bf16 v[164:167], a[124:127], a[64:67], v[164:167]
  v_mul_f32 v54, v54, v58
  v_mul_f32 v55, v55, v59
  v_mul_f32 v56, v56, v60
  v_mfma_f32_16x16x32_bf16 v[168:171], a[124:127], a[68:71], v[168:171]
  v_mul_f32 v57, v57, v61
  v_cvt_pk_bf16_f32 v64, v54, v55
  v_cvt_pk_bf16_f32 v65, v56, v57
  v_mfma_f32_16x16x32_bf16 v[172:175], a[124:127], a[72:75], v[172:175]
  ds_write_b64 v11, v[64:65] offset:6144
  v_fma_f32 v54, v96, v18, v26
  s_waitcnt vmcnt(21) lgkmcnt(1)
  v_mfma_f32_16x16x32_bf16 v[128:131], a[188:191], a[76:79], v[128:131]
  ds_read_b128 a[60:63], v3 offset:40960
  v_fma_f32 v55, v97, v18, v27
  v_fma_f32 v56, v98, v18, v28
  v_mfma_f32_16x16x32_bf16 v[132:135], a[188:191], a[80:83], v[132:135]
  buffer_load_dwordx4 a[116:119], v2, s[8:11], s20 offen offset:0
  v_mfma_f32_16x16x32_bf16 v[136:139], a[188:191], a[84:87], v[136:139]
  ds_read_b128 a[64:67], v3 offset:43008
  v_fma_f32 v57, v99, v18, v29
  v_fma_f32 v58, v54, v54, v52
  v_mfma_f32_16x16x32_bf16 v[140:143], a[188:191], a[88:91], v[140:143]
  buffer_load_dwordx4 a[120:123], v2, s[8:11], s20 offen offset:1024
  v_mfma_f32_16x16x32_bf16 v[144:147], a[192:195], a[76:79], v[144:147]
  ds_read_b128 a[68:71], v3 offset:45056
  v_fma_f32 v59, v55, v55, v52
  v_fma_f32 v60, v56, v56, v52
  v_mfma_f32_16x16x32_bf16 v[148:151], a[192:195], a[80:83], v[148:151]
  buffer_load_dwordx4 a[124:127], v2, s[8:11], s20 offen offset:2048
  v_fma_f32 v61, v57, v57, v52
  v_mfma_f32_16x16x32_bf16 v[152:155], a[192:195], a[84:87], v[152:155]
  ds_read_b128 a[72:75], v3 offset:47104
  v_mul_f32 v58, v54, v58
  v_mfma_f32_16x16x32_bf16 v[156:159], a[192:195], a[88:91], v[156:159]
  s_add_u32 s20, s20, 3072
  v_mul_f32 v59, v55, v59
  v_mul_f32 v60, v56, v60
  v_mfma_f32_16x16x32_bf16 v[160:163], a[196:199], a[76:79], v[160:163]
  v_mul_f32 v61, v57, v61
  v_exp_f32_e64 v58, -v58
  v_mfma_f32_16x16x32_bf16 v[164:167], a[196:199], a[80:83], v[164:167]
  v_exp_f32_e64 v59, -v59
  v_mfma_f32_16x16x32_bf16 v[168:171], a[196:199], a[84:87], v[168:171]
  v_exp_f32_e64 v60, -v60
  v_mfma_f32_16x16x32_bf16 v[172:175], a[196:199], a[88:91], v[172:175]
  v_exp_f32_e64 v61, -v61
  v_fma_f32 v58, v58, v53, v53
  s_waitcnt vmcnt(21) lgkmcnt(0)
  v_mfma_f32_16x16x32_bf16 v[128:131], a[128:131], a[60:63], v[128:131]
  ds_read_b128 a[76:79], v4 offset:40960
  v_fma_f32 v59, v59, v53, v53
  v_fma_f32 v60, v60, v53, v53
  v_mfma_f32_16x16x32_bf16 v[132:135], a[128:131], a[64:67], v[132:135]
  buffer_load_dwordx4 a[188:191], v2, s[8:11], s20 offen offset:0
  v_mfma_f32_16x16x32_bf16 v[136:139], a[128:131], a[68:71], v[136:139]
  ds_read_b128 a[80:83], v4 offset:43008
  v_fma_f32 v61, v61, v53, v53
  v_rcp_f32 v58, v58
  v_mfma_f32_16x16x32_bf16 v[140:143], a[128:131], a[72:75], v[140:143]
  buffer_load_dwordx4 a[192:195], v2, s[8:11], s20 offen offset:1024
  v_mfma_f32_16x16x32_bf16 v[144:147], a[132:135], a[60:63], v[144:147]
  ds_read_b128 a[84:87], v4 offset:45056
  v_rcp_f32 v59, v59
  v_mfma_f32_16x16x32_bf16 v[148:151], a[132:135], a[64:67], v[148:151]
  buffer_load_dwordx4 a[196:199], v2, s[8:11], s20 offen offset:2048
  v_mfma_f32_16x16x32_bf16 v[152:155], a[132:135], a[68:71], v[152:155]
  ds_read_b128 a[88:91], v4 offset:47104
  v_rcp_f32 v60, v60
  v_mfma_f32_16x16x32_bf16 v[156:159], a[132:135], a[72:75], v[156:159]
  s_add_u32 s20, s20, 3072
  v_rcp_f32 v61, v61
  v_mfma_f32_16x16x32_bf16 v[160:163], a[136:139], a[60:63], v[160:163]
  v_mul_f32 v54, v54, v58
  v_mul_f32 v55, v55, v59
  v_mfma_f32_16x16x32_bf16 v[164:167], a[136:139], a[64:67], v[164:167]
  v_mul_f32 v56, v56, v60
  v_mul_f32 v57, v57, v61
  v_cvt_pk_bf16_f32 v62, v54, v55
  v_mfma_f32_16x16x32_bf16 v[168:171], a[136:139], a[68:71], v[168:171]
  v_cvt_pk_bf16_f32 v63, v56, v57
  ds_write_b64 v12, v[62:63] offset:0
  v_mfma_f32_16x16x32_bf16 v[172:175], a[136:139], a[72:75], v[172:175]
  v_fma_f32 v54, v100, v19, v26
  v_fma_f32 v55, v101, v19, v27
  v_fma_f32 v56, v102, v19, v28
  s_waitcnt vmcnt(21) lgkmcnt(1)
  v_mfma_f32_16x16x32_bf16 v[128:131], a[200:203], a[76:79], v[128:131]
  ds_read_b128 a[60:63], v3 offset:49152
  v_fma_f32 v57, v103, v19, v29
  v_fma_f32 v58, v54, v54, v52
  v_mfma_f32_16x16x32_bf16 v[132:135], a[200:203], a[80:83], v[132:135]
  buffer_load_dwordx4 a[128:131], v2, s[8:11], s20 offen offset:0
  v_mfma_f32_16x16x32_bf16 v[136:139], a[200:203], a[84:87], v[136:139]
  ds_read_b128 a[64:67], v3 offset:51200
  v_fma_f32 v59, v55, v55, v52
  v_fma_f32 v60, v56, v56, v52
  v_mfma_f32_16x16x32_bf16 v[140:143], a[200:203], a[88:91], v[140:143]
  buffer_load_dwordx4 a[132:135], v2, s[8:11], s20 offen offset:1024
  v_fma_f32 v61, v57, v57, v52
  v_mfma_f32_16x16x32_bf16 v[144:147], a[204:207], a[76:79], v[144:147]
  ds_read_b128 a[68:71], v3 offset:53248
  v_mul_f32 v58, v54, v58
  v_mfma_f32_16x16x32_bf16 v[148:151], a[204:207], a[80:83], v[148:151]
  buffer_load_dwordx4 a[136:139], v2, s[8:11], s20 offen offset:2048
  v_mul_f32 v59, v55, v59
  v_mfma_f32_16x16x32_bf16 v[152:155], a[204:207], a[84:87], v[152:155]
  ds_read_b128 a[72:75], v3 offset:55296
  v_mul_f32 v60, v56, v60
  v_mul_f32 v61, v57, v61
  v_mfma_f32_16x16x32_bf16 v[156:159], a[204:207], a[88:91], v[156:159]
  s_add_u32 s20, s20, 3072
  v_exp_f32_e64 v58, -v58
  v_mfma_f32_16x16x32_bf16 v[160:163], a[208:211], a[76:79], v[160:163]
  v_exp_f32_e64 v59, -v59
  v_mfma_f32_16x16x32_bf16 v[164:167], a[208:211], a[80:83], v[164:167]
  v_exp_f32_e64 v60, -v60
  v_mfma_f32_16x16x32_bf16 v[168:171], a[208:211], a[84:87], v[168:171]
  v_exp_f32_e64 v61, -v61
  v_fma_f32 v58, v58, v53, v53
  v_mfma_f32_16x16x32_bf16 v[172:175], a[208:211], a[88:91], v[172:175]
  v_fma_f32 v59, v59, v53, v53
  v_fma_f32 v60, v60, v53, v53
  v_fma_f32 v61, v61, v53, v53
  s_waitcnt vmcnt(21) lgkmcnt(0)
  v_mfma_f32_16x16x32_bf16 v[128:131], a[140:143], a[60:63], v[128:131]
  ds_read_b128 a[76:79], v4 offset:49152
  v_rcp_f32 v58, v58
  v_mfma_f32_16x16x32_bf16 v[132:135], a[140:143], a[64:67], v[132:135]
  buffer_load_dwordx4 a[200:203], v2, s[8:11], s20 offen offset:0
  v_mfma_f32_16x16x32_bf16 v[136:139], a[140:143], a[68:71], v[136:139]
  ds_read_b128 a[80:83], v4 offset:51200
  v_rcp_f32 v59, v59
  v_mfma_f32_16x16x32_bf16 v[140:143], a[140:143], a[72:75], v[140:143]
  buffer_load_dwordx4 a[204:207], v2, s[8:11], s20 offen offset:1024
  v_mfma_f32_16x16x32_bf16 v[144:147], a[144:147], a[60:63], v[144:147]
  ds_read_b128 a[84:87], v4 offset:53248
  v_rcp_f32 v60, v60
  v_mfma_f32_16x16x32_bf16 v[148:151], a[144:147], a[64:67], v[148:151]
  buffer_load_dwordx4 a[208:211], v2, s[8:11], s20 offen offset:2048
  v_rcp_f32 v61, v61
  v_mfma_f32_16x16x32_bf16 v[152:155], a[144:147], a[68:71], v[152:155]
  ds_read_b128 a[88:91], v4 offset:55296
  v_mul_f32 v54, v54, v58
  v_mfma_f32_16x16x32_bf16 v[156:159], a[144:147], a[72:75], v[156:159]
  s_add_u32 s20, s20, 3072
  v_mul_f32 v55, v55, v59
  v_mul_f32 v56, v56, v60
  v_mfma_f32_16x16x32_bf16 v[160:163], a[148:151], a[60:63], v[160:163]
  v_mul_f32 v57, v57, v61
  v_cvt_pk_bf16_f32 v64, v54, v55
  v_mfma_f32_16x16x32_bf16 v[164:167], a[148:151], a[64:67], v[164:167]
  v_cvt_pk_bf16_f32 v65, v56, v57
  ds_write_b64 v12, v[64:65] offset:2048
  v_fma_f32 v54, v104, v20, v26
  v_mfma_f32_16x16x32_bf16 v[168:171], a[148:151], a[68:71], v[168:171]
  v_fma_f32 v55, v105, v20, v27
  v_fma_f32 v56, v106, v20, v28
  v_mfma_f32_16x16x32_bf16 v[172:175], a[148:151], a[72:75], v[172:175]
  v_fma_f32 v57, v107, v20, v29
  v_fma_f32 v58, v54, v54, v52
  v_fma_f32 v59, v55, v55, v52
  s_waitcnt vmcnt(21) lgkmcnt(1)
  v_mfma_f32_16x16x32_bf16 v[128:131], a[152:155], a[76:79], v[128:131]
  ds_read_b128 a[60:63], v3 offset:57344
  v_fma_f32 v60, v56, v56, v52
  v_fma_f32 v61, v57, v57, v52
  v_mfma_f32_16x16x32_bf16 v[132:135], a[152:155], a[80:83], v[132:135]
  buffer_load_dwordx4 a[140:143], v2, s[8:11], s20 offen offset:0
  v_mul_f32 v58, v54, v58
  v_mfma_f32_16x16x32_bf16 v[136:139], a[152:155], a[84:87], v[136:139]
  ds_read_b128 a[64:67], v3 offset:59392
  v_mul_f32 v59, v55, v59
  v_mul_f32 v60, v56, v60
  v_mfma_f32_16x16x32_bf16 v[140:143], a[152:155], a[88:91], v[140:143]
  buffer_load_dwordx4 a[144:147], v2, s[8:11], s20 offen offset:1024
  v_mul_f32 v61, v57, v61
  v_mfma_f32_16x16x32_bf16 v[144:147], a[156:159], a[76:79], v[144:147]
  ds_read_b128 a[68:71], v3 offset:61440
  v_exp_f32_e64 v58, -v58
  v_mfma_f32_16x16x32_bf16 v[148:151], a[156:159], a[80:83], v[148:151]
  buffer_load_dwordx4 a[148:151], v2, s[8:11], s20 offen offset:2048
  v_mfma_f32_16x16x32_bf16 v[152:155], a[156:159], a[84:87], v[152:155]
  ds_read_b128 a[72:75], v3 offset:63488
  v_exp_f32_e64 v59, -v59
  v_mfma_f32_16x16x32_bf16 v[156:159], a[156:159], a[88:91], v[156:159]
  s_add_u32 s20, s20, 3072
  v_exp_f32_e64 v60, -v60
  v_mfma_f32_16x16x32_bf16 v[160:163], a[160:163], a[76:79], v[160:163]
  v_exp_f32_e64 v61, -v61
  v_fma_f32 v58, v58, v53, v53
  v_mfma_f32_16x16x32_bf16 v[164:167], a[160:163], a[80:83], v[164:167]
  v_fma_f32 v59, v59, v53, v53
  v_fma_f32 v60, v60, v53, v53
  v_fma_f32 v61, v61, v53, v53
  v_mfma_f32_16x16x32_bf16 v[168:171], a[160:163], a[84:87], v[168:171]
  v_rcp_f32 v58, v58
  v_rcp_f32 v59, v59
  v_mfma_f32_16x16x32_bf16 v[172:175], a[160:163], a[88:91], v[172:175]
  v_rcp_f32 v60, v60
  s_waitcnt vmcnt(21) lgkmcnt(0)
  v_mfma_f32_16x16x32_bf16 v[128:131], a[164:167], a[60:63], v[128:131]
  ds_read_b128 a[76:79], v4 offset:57344
  v_rcp_f32 v61, v61
  v_mfma_f32_16x16x32_bf16 v[132:135], a[164:167], a[64:67], v[132:135]
  buffer_load_dwordx4 a[152:155], v2, s[8:11], s20 offen offset:0
  v_mfma_f32_16x16x32_bf16 v[136:139], a[164:167], a[68:71], v[136:139]
  ds_read_b128 a[80:83], v4 offset:59392
  v_mul_f32 v54, v54, v58
  v_mfma_f32_16x16x32_bf16 v[140:143], a[164:167], a[72:75], v[140:143]
  buffer_load_dwordx4 a[156:159], v2, s[8:11], s20 offen offset:1024
  v_mul_f32 v55, v55, v59
  v_mfma_f32_16x16x32_bf16 v[144:147], a[168:171], a[60:63], v[144:147]
  ds_read_b128 a[84:87], v4 offset:61440
  v_mul_f32 v56, v56, v60
  v_mfma_f32_16x16x32_bf16 v[148:151], a[168:171], a[64:67], v[148:151]
  buffer_load_dwordx4 a[160:163], v2, s[8:11], s20 offen offset:2048
  v_mfma_f32_16x16x32_bf16 v[152:155], a[168:171], a[68:71], v[152:155]
  ds_read_b128 a[88:91], v4 offset:63488
  v_mul_f32 v57, v57, v61
  v_cvt_pk_bf16_f32 v62, v54, v55
  v_mfma_f32_16x16x32_bf16 v[156:159], a[168:171], a[72:75], v[156:159]
  s_add_u32 s20, s20, 3072
  v_cvt_pk_bf16_f32 v63, v56, v57
  v_mfma_f32_16x16x32_bf16 v[160:163], a[172:175], a[60:63], v[160:163]
  ds_write_b64 v12, v[62:63] offset:4096
  v_fma_f32 v54, v108, v21, v26
  v_mfma_f32_16x16x32_bf16 v[164:167], a[172:175], a[64:67], v[164:167]
  v_fma_f32 v55, v109, v21, v27
  v_fma_f32 v56, v110, v21, v28
  v_mfma_f32_16x16x32_bf16 v[168:171], a[172:175], a[68:71], v[168:171]
  v_fma_f32 v57, v111, v21, v29
  v_fma_f32 v58, v54, v54, v52
  v_fma_f32 v59, v55, v55, v52
  v_mfma_f32_16x16x32_bf16 v[172:175], a[172:175], a[72:75], v[172:175]
  v_fma_f32 v60, v56, v56, v52
  v_fma_f32 v61, v57, v57, v52
  s_waitcnt vmcnt(21) lgkmcnt(1)
  v_mfma_f32_16x16x32_bf16 v[128:131], a[104:107], a[76:79], v[128:131]
  ds_read_b128 a[60:63], v5 offset:0
  v_mul_f32 v58, v54, v58
  v_mul_f32 v59, v55, v59
  v_mfma_f32_16x16x32_bf16 v[132:135], a[104:107], a[80:83], v[132:135]
  buffer_load_dwordx4 a[164:167], v2, s[8:11], s20 offen offset:0
  v_mul_f32 v60, v56, v60
  v_mfma_f32_16x16x32_bf16 v[136:139], a[104:107], a[84:87], v[136:139]
  ds_read_b128 a[64:67], v5 offset:2048
  v_mul_f32 v61, v57, v61
  v_exp_f32_e64 v58, -v58
  v_mfma_f32_16x16x32_bf16 v[140:143], a[104:107], a[88:91], v[140:143]
  buffer_load_dwordx4 a[168:171], v2, s[8:11], s20 offen offset:1024
  v_mfma_f32_16x16x32_bf16 v[144:147], a[108:111], a[76:79], v[144:147]
  ds_read_b128 a[68:71], v5 offset:4096
  v_exp_f32_e64 v59, -v59
  v_mfma_f32_16x16x32_bf16 v[148:151], a[108:111], a[80:83], v[148:151]
  buffer_load_dwordx4 a[172:175], v2, s[8:11], s20 offen offset:2048
  v_exp_f32_e64 v60, -v60
  v_mfma_f32_16x16x32_bf16 v[152:155], a[108:111], a[84:87], v[152:155]
  ds_read_b128 a[72:75], v5 offset:6144
  v_exp_f32_e64 v61, -v61
  v_mfma_f32_16x16x32_bf16 v[156:159], a[108:111], a[88:91], v[156:159]
  s_add_u32 s20, s20, 3072
  v_fma_f32 v58, v58, v53, v53
  v_mfma_f32_16x16x32_bf16 v[160:163], a[112:115], a[76:79], v[160:163]
  v_fma_f32 v59, v59, v53, v53
  v_fma_f32 v60, v60, v53, v53
  v_fma_f32 v61, v61, v53, v53
  v_mfma_f32_16x16x32_bf16 v[164:167], a[112:115], a[80:83], v[164:167]
  v_rcp_f32 v58, v58
  v_rcp_f32 v59, v59
  v_mfma_f32_16x16x32_bf16 v[168:171], a[112:115], a[84:87], v[168:171]
  v_rcp_f32 v60, v60
  v_mfma_f32_16x16x32_bf16 v[172:175], a[112:115], a[88:91], v[172:175]
  v_rcp_f32 v61, v61
  v_mul_f32 v54, v54, v58
  s_waitcnt vmcnt(21) lgkmcnt(0)
  v_mfma_f32_16x16x32_bf16 v[128:131], a[176:179], a[60:63], v[128:131]
  ds_read_b128 a[76:79], v6 offset:0
  v_mul_f32 v55, v55, v59
  v_mfma_f32_16x16x32_bf16 v[132:135], a[176:179], a[64:67], v[132:135]
  buffer_load_dwordx4 a[104:107], v2, s[8:11], s20 offen offset:0
  v_mul_f32 v56, v56, v60
  v_mfma_f32_16x16x32_bf16 v[136:139], a[176:179], a[68:71], v[136:139]
  ds_read_b128 a[80:83], v6 offset:2048
  v_mul_f32 v57, v57, v61
  v_mfma_f32_16x16x32_bf16 v[140:143], a[176:179], a[72:75], v[140:143]
  buffer_load_dwordx4 a[108:111], v2, s[8:11], s20 offen offset:1024
  v_cvt_pk_bf16_f32 v64, v54, v55
  v_mfma_f32_16x16x32_bf16 v[144:147], a[180:183], a[60:63], v[144:147]
  ds_read_b128 a[84:87], v6 offset:4096
  v_cvt_pk_bf16_f32 v65, v56, v57
  v_mfma_f32_16x16x32_bf16 v[148:151], a[180:183], a[64:67], v[148:151]
  buffer_load_dwordx4 a[112:115], v2, s[8:11], s20 offen offset:2048
  v_mfma_f32_16x16x32_bf16 v[152:155], a[180:183], a[68:71], v[152:155]
  ds_read_b128 a[88:91], v6 offset:6144
  ds_write_b64 v12, v[64:65] offset:6144
  v_mfma_f32_16x16x32_bf16 v[156:159], a[180:183], a[72:75], v[156:159]
  s_add_u32 s20, s20, 3072
  v_fma_f32 v54, v112, v18, v30
  v_fma_f32 v55, v113, v18, v31
  v_mfma_f32_16x16x32_bf16 v[160:163], a[184:187], a[60:63], v[160:163]
  v_fma_f32 v56, v114, v18, v32
  v_fma_f32 v57, v115, v18, v33
  v_mfma_f32_16x16x32_bf16 v[164:167], a[184:187], a[64:67], v[164:167]
  v_fma_f32 v58, v54, v54, v52
  v_fma_f32 v59, v55, v55, v52
  v_mfma_f32_16x16x32_bf16 v[168:171], a[184:187], a[68:71], v[168:171]
  v_fma_f32 v60, v56, v56, v52
  v_fma_f32 v61, v57, v57, v52
  v_mul_f32 v58, v54, v58
  v_mfma_f32_16x16x32_bf16 v[172:175], a[184:187], a[72:75], v[172:175]
  v_mul_f32 v59, v55, v59
  v_mul_f32 v60, v56, v60
  s_waitcnt vmcnt(21) lgkmcnt(1)
  v_mfma_f32_16x16x32_bf16 v[128:131], a[116:119], a[76:79], v[128:131]
  ds_read_b128 a[60:63], v3 offset:0
  v_mul_f32 v61, v57, v61
  v_exp_f32_e64 v58, -v58
  v_mfma_f32_16x16x32_bf16 v[132:135], a[116:119], a[80:83], v[132:135]
  buffer_load_dwordx4 a[176:179], v2, s[8:11], s20 offen offset:0
  v_mfma_f32_16x16x32_bf16 v[136:139], a[116:119], a[84:87], v[136:139]
  ds_read_b128 a[64:67], v3 offset:2048
  v_exp_f32_e64 v59, -v59
  v_mfma_f32_16x16x32_bf16 v[140:143], a[116:119], a[88:91], v[140:143]
  buffer_load_dwordx4 a[180:183], v2, s[8:11], s20 offen offset:1024
  v_exp_f32_e64 v60, -v60
  v_mfma_f32_16x16x32_bf16 v[144:147], a[120:123], a[76:79], v[144:147]
  ds_read_b128 a[68:71], v3 offset:4096
  v_exp_f32_e64 v61, -v61
  v_mfma_f32_16x16x32_bf16 v[148:151], a[120:123], a[80:83], v[148:151]
  buffer_load_dwordx4 a[184:187], v2, s[8:11], s20 offen offset:2048
  v_mfma_f32_16x16x32_bf16 v[152:155], a[120:123], a[84:87], v[152:155]
  ds_read_b128 a[72:75], v3 offset:6144
  v_fma_f32 v58, v58, v53, v53
  v_fma_f32 v59, v59, v53, v53
  v_mfma_f32_16x16x32_bf16 v[156:159], a[120:123], a[88:91], v[156:159]
  s_add_u32 s20, s20, 3072
  v_fma_f32 v60, v60, v53, v53
  v_fma_f32 v61, v61, v53, v53
  v_mfma_f32_16x16x32_bf16 v[160:163], a[124:127], a[76:79], v[160:163]
  v_rcp_f32 v58, v58
  v_rcp_f32 v59, v59
  v_mfma_f32_16x16x32_bf16 v[164:167], a[124:127], a[80:83], v[164:167]
  v_rcp_f32 v60, v60
  v_mfma_f32_16x16x32_bf16 v[168:171], a[124:127], a[84:87], v[168:171]
  v_rcp_f32 v61, v61
  v_mul_f32 v54, v54, v58
  v_mfma_f32_16x16x32_bf16 v[172:175], a[124:127], a[88:91], v[172:175]
  v_mul_f32 v55, v55, v59
  v_mul_f32 v56, v56, v60
  v_mul_f32 v57, v57, v61
  s_waitcnt vmcnt(21) lgkmcnt(0)
  v_mfma_f32_16x16x32_bf16 v[176:179], a[188:191], a[60:63], 0
  ds_read_b128 a[76:79], v4 offset:0
  v_cvt_pk_bf16_f32 v62, v54, v55
  v_mfma_f32_16x16x32_bf16 v[180:183], a[188:191], a[64:67], 0
  buffer_load_dwordx4 a[116:119], v2, s[8:11], s20 offen offset:0
  v_cvt_pk_bf16_f32 v63, v56, v57
  v_mfma_f32_16x16x32_bf16 v[184:187], a[188:191], a[68:71], 0
  ds_read_b128 a[80:83], v4 offset:2048
  ds_write_b64 v13, v[62:63] offset:0
  v_mfma_f32_16x16x32_bf16 v[188:191], a[188:191], a[72:75], 0
  buffer_load_dwordx4 a[120:123], v2, s[8:11], s20 offen offset:1024
  v_mfma_f32_16x16x32_bf16 v[192:195], a[192:195], a[60:63], 0
  ds_read_b128 a[84:87], v4 offset:4096
  v_fma_f32 v54, v116, v19, v30
  v_mfma_f32_16x16x32_bf16 v[196:199], a[192:195], a[64:67], 0
  buffer_load_dwordx4 a[124:127], v2, s[8:11], s20 offen offset:2048
  v_fma_f32 v55, v117, v19, v31
  v_mfma_f32_16x16x32_bf16 v[200:203], a[192:195], a[68:71], 0
  ds_read_b128 a[88:91], v4 offset:6144
  v_fma_f32 v56, v118, v19, v32
  v_mfma_f32_16x16x32_bf16 v[204:207], a[192:195], a[72:75], 0
  s_add_u32 s20, s20, 3072
  v_fma_f32 v57, v119, v19, v33
  v_fma_f32 v58, v54, v54, v52
  v_mfma_f32_16x16x32_bf16 v[208:211], a[196:199], a[60:63], 0
  v_fma_f32 v59, v55, v55, v52
  v_fma_f32 v60, v56, v56, v52
  v_mfma_f32_16x16x32_bf16 v[212:215], a[196:199], a[64:67], 0
  v_fma_f32 v61, v57, v57, v52
  v_mul_f32 v58, v54, v58
  v_mfma_f32_16x16x32_bf16 v[216:219], a[196:199], a[68:71], 0
  v_mul_f32 v59, v55, v59
  v_mul_f32 v60, v56, v60
  v_mul_f32 v61, v57, v61
  v_mfma_f32_16x16x32_bf16 v[220:223], a[196:199], a[72:75], 0
  v_exp_f32_e64 v58, -v58
  s_waitcnt vmcnt(21) lgkmcnt(0)
  v_mfma_f32_16x16x32_bf16 v[176:179], a[128:131], a[76:79], v[176:179]
  ds_read_b128 a[60:63], v3 offset:8192
  v_exp_f32_e64 v59, -v59
  v_mfma_f32_16x16x32_bf16 v[180:183], a[128:131], a[80:83], v[180:183]
  buffer_load_dwordx4 a[188:191], v2, s[8:11], s20 offen offset:0
  v_mfma_f32_16x16x32_bf16 v[184:187], a[128:131], a[84:87], v[184:187]
  ds_read_b128 a[64:67], v3 offset:10240
  v_exp_f32_e64 v60, -v60
  v_mfma_f32_16x16x32_bf16 v[188:191], a[128:131], a[88:91], v[188:191]
  buffer_load_dwordx4 a[192:195], v2, s[8:11], s20 offen offset:1024
  v_exp_f32_e64 v61, -v61
  v_mfma_f32_16x16x32_bf16 v[192:195], a[132:135], a[76:79], v[192:195]
  ds_read_b128 a[68:71], v3 offset:12288
  v_fma_f32 v58, v58, v53, v53
  v_fma_f32 v59, v59, v53, v53
  v_mfma_f32_16x16x32_bf16 v[196:199], a[132:135], a[80:83], v[196:199]
  buffer_load_dwordx4 a[196:199], v2, s[8:11], s20 offen offset:2048
  v_fma_f32 v60, v60, v53, v53
  v_mfma_f32_16x16x32_bf16 v[200:203], a[132:135], a[84:87], v[200:203]
  ds_read_b128 a[72:75], v3 offset:14336
  v_fma_f32 v61, v61, v53, v53
  v_mfma_f32_16x16x32_bf16 v[204:207], a[132:135], a[88:91], v[204:207]
  s_add_u32 s20, s20, 3072
  v_rcp_f32 v58, v58
  v_mfma_f32_16x16x32_bf16 v[208:211], a[136:139], a[76:79], v[208:211]
  v_rcp_f32 v59, v59
  v_rcp_f32 v60, v60
  v_mfma_f32_16x16x32_bf16 v[212:215], a[136:139], a[80:83], v[212:215]
  v_rcp_f32 v61, v61
  v_mfma_f32_16x16x32_bf16 v[216:219], a[136:139], a[84:87], v[216:219]
  v_mul_f32 v54, v54, v58
  v_mul_f32 v55, v55, v59
  v_mul_f32 v56, v56, v60
  v_mfma_f32_16x16x32_bf16 v[220:223], a[136:139], a[88:91], v[220:223]
  v_mul_f32 v57, v57, v61
  v_cvt_pk_bf16_f32 v64, v54, v55
  v_cvt_pk_bf16_f32 v65, v56, v57
  s_waitcnt vmcnt(21) lgkmcnt(0)
  v_mfma_f32_16x16x32_bf16 v[176:179], a[200:203], a[60:63], v[176:179]
  ds_read_b128 a[76:79], v4 offset:8192
  ds_write_b64 v13, v[64:65] offset:2048
  v_mfma_f32_16x16x32_bf16 v[180:183], a[200:203], a[64:67], v[180:183]
  buffer_load_dwordx4 a[128:131], v2, s[8:11], s20 offen offset:0
  v_fma_f32 v54, v120, v20, v30
  v_mfma_f32_16x16x32_bf16 v[184:187], a[200:203], a[68:71], v[184:187]
  ds_read_b128 a[80:83], v4 offset:10240
  v_fma_f32 v55, v121, v20, v31
  v_fma_f32 v56, v122, v20, v32
  v_mfma_f32_16x16x32_bf16 v[188:191], a[200:203], a[72:75], v[188:191]
  buffer_load_dwordx4 a[132:135], v2, s[8:11], s20 offen offset:1024
  v_mfma_f32_16x16x32_bf16 v[192:195], a[204:207], a[60:63], v[192:195]
  ds_read_b128 a[84:87], v4 offset:12288
  v_fma_f32 v57, v123, v20, v33
  v_fma_f32 v58, v54, v54, v52
  v_mfma_f32_16x16x32_bf16 v[196:199], a[204:207], a[64:67], v[196:199]
  buffer_load_dwordx4 a[136:139], v2, s[8:11], s20 offen offset:2048
  v_fma_f32 v59, v55, v55, v52
  v_mfma_f32_16x16x32_bf16 v[200:203], a[204:207], a[68:71], v[200:203]
  ds_read_b128 a[88:91], v4 offset:14336
  v_fma_f32 v60, v56, v56, v52
  v_mfma_f32_16x16x32_bf16 v[204:207], a[204:207], a[72:75], v[204:207]
  s_add_u32 s20, s20, 3072
  v_fma_f32 v61, v57, v57, v52
  v_mul_f32 v58, v54, v58
  v_mfma_f32_16x16x32_bf16 v[208:211], a[208:211], a[60:63], v[208:211]
  v_mul_f32 v59, v55, v59
  v_mul_f32 v60, v56, v60
  v_mul_f32 v61, v57, v61
  v_mfma_f32_16x16x32_bf16 v[212:215], a[208:211], a[64:67], v[212:215]
  v_exp_f32_e64 v58, -v58
  v_mfma_f32_16x16x32_bf16 v[216:219], a[208:211], a[68:71], v[216:219]
  v_exp_f32_e64 v59, -v59
  v_exp_f32_e64 v60, -v60
  v_mfma_f32_16x16x32_bf16 v[220:223], a[208:211], a[72:75], v[220:223]
  v_exp_f32_e64 v61, -v61
  s_waitcnt vmcnt(21) lgkmcnt(0)
  v_mfma_f32_16x16x32_bf16 v[176:179], a[140:143], a[76:79], v[176:179]
  ds_read_b128 a[60:63], v3 offset:16384
  v_fma_f32 v58, v58, v53, v53
  v_fma_f32 v59, v59, v53, v53
  v_mfma_f32_16x16x32_bf16 v[180:183], a[140:143], a[80:83], v[180:183]
  buffer_load_dwordx4 a[200:203], v2, s[8:11], s20 offen offset:0
  v_mfma_f32_16x16x32_bf16 v[184:187], a[140:143], a[84:87], v[184:187]
  ds_read_b128 a[64:67], v3 offset:18432
  v_fma_f32 v60, v60, v53, v53
  v_fma_f32 v61, v61, v53, v53
  v_mfma_f32_16x16x32_bf16 v[188:191], a[140:143], a[88:91], v[188:191]
  buffer_load_dwordx4 a[204:207], v2, s[8:11], s20 offen offset:1024
  v_mfma_f32_16x16x32_bf16 v[192:195], a[144:147], a[76:79], v[192:195]
  ds_read_b128 a[68:71], v3 offset:20480
  v_rcp_f32 v58, v58
  v_mfma_f32_16x16x32_bf16 v[196:199], a[144:147], a[80:83], v[196:199]
  buffer_load_dwordx4 a[208:211], v2, s[8:11], s20 offen offset:2048
  v_rcp_f32 v59, v59
  v_mfma_f32_16x16x32_bf16 v[200:203], a[144:147], a[84:87], v[200:203]
  ds_read_b128 a[72:75], v3 offset:22528
  v_mfma_f32_16x16x32_bf16 v[204:207], a[144:147], a[88:91], v[204:207]
  s_add_u32 s20, s20, 3072
  v_rcp_f32 v60, v60
  v_mfma_f32_16x16x32_bf16 v[208:211], a[148:151], a[76:79], v[208:211]
  v_rcp_f32 v61, v61
  v_mul_f32 v54, v54, v58
  v_mfma_f32_16x16x32_bf16 v[212:215], a[148:151], a[80:83], v[212:215]
  v_mul_f32 v55, v55, v59
  v_mul_f32 v56, v56, v60
  v_mul_f32 v57, v57, v61
  v_mfma_f32_16x16x32_bf16 v[216:219], a[148:151], a[84:87], v[216:219]
  v_cvt_pk_bf16_f32 v62, v54, v55
  v_cvt_pk_bf16_f32 v63, v56, v57
  ds_write_b64 v13, v[62:63] offset:4096
  v_mfma_f32_16x16x32_bf16 v[220:223], a[148:151], a[88:91], v[220:223]
  v_fma_f32 v54, v124, v21, v30
  v_fma_f32 v55, v125, v21, v31
  s_waitcnt vmcnt(21) lgkmcnt(1)
  v_mfma_f32_16x16x32_bf16 v[176:179], a[152:155], a[60:63], v[176:179]
  ds_read_b128 a[76:79], v4 offset:16384
  v_fma_f32 v56, v126, v21, v32
  v_fma_f32 v57, v127, v21, v33
  v_mfma_f32_16x16x32_bf16 v[180:183], a[152:155], a[64:67], v[180:183]
  buffer_load_dwordx4 a[140:143], v2, s[8:11], s20 offen offset:0
  v_mfma_f32_16x16x32_bf16 v[184:187], a[152:155], a[68:71], v[184:187]
  ds_read_b128 a[80:83], v4 offset:18432
  v_fma_f32 v58, v54, v54, v52
  v_fma_f32 v59, v55, v55, v52
  v_mfma_f32_16x16x32_bf16 v[188:191], a[152:155], a[72:75], v[188:191]
  buffer_load_dwordx4 a[144:147], v2, s[8:11], s20 offen offset:1024
  v_fma_f32 v60, v56, v56, v52
  v_mfma_f32_16x16x32_bf16 v[192:195], a[156:159], a[60:63], v[192:195]
  ds_read_b128 a[84:87], v4 offset:20480
  v_fma_f32 v61, v57, v57, v52
  v_mfma_f32_16x16x32_bf16 v[196:199], a[156:159], a[64:67], v[196:199]
  buffer_load_dwordx4 a[148:151], v2, s[8:11], s20 offen offset:2048
  v_mul_f32 v58, v54, v58
  v_mfma_f32_16x16x32_bf16 v[200:203], a[156:159], a[68:71], v[200:203]
  ds_read_b128 a[88:91], v4 offset:22528
  v_mul_f32 v59, v55, v59
  v_mul_f32 v60, v56, v60
  v_mfma_f32_16x16x32_bf16 v[204:207], a[156:159], a[72:75], v[204:207]
  s_add_u32 s20, s20, 3072
  v_mul_f32 v61, v57, v61
  v_mfma_f32_16x16x32_bf16 v[208:211], a[160:163], a[60:63], v[208:211]
  v_exp_f32_e64 v58, -v58
  v_exp_f32_e64 v59, -v59
  v_mfma_f32_16x16x32_bf16 v[212:215], a[160:163], a[64:67], v[212:215]
  v_exp_f32_e64 v60, -v60
  v_mfma_f32_16x16x32_bf16 v[216:219], a[160:163], a[68:71], v[216:219]
  v_exp_f32_e64 v61, -v61
  v_mfma_f32_16x16x32_bf16 v[220:223], a[160:163], a[72:75], v[220:223]
  v_fma_f32 v58, v58, v53, v53
  v_fma_f32 v59, v59, v53, v53
  v_fma_f32 v60, v60, v53, v53
  s_waitcnt vmcnt(21) lgkmcnt(0)
  v_mfma_f32_16x16x32_bf16 v[176:179], a[164:167], a[76:79], v[176:179]
  ds_read_b128 a[60:63], v3 offset:24576
  buffer_load_dwordx4 a[152:155], v2, s[8:11], s20 offen offset:0
  v_mfma_f32_16x16x32_bf16 v[180:183], a[164:167], a[80:83], v[180:183]
  ds_read_b128 a[64:67], v3 offset:26624
  v_fma_f32 v61, v61, v53, v53
  v_rcp_f32 v58, v58
  v_mfma_f32_16x16x32_bf16 v[184:187], a[164:167], a[84:87], v[184:187]
  buffer_load_dwordx4 a[156:159], v2, s[8:11], s20 offen offset:1024
  v_mfma_f32_16x16x32_bf16 v[188:191], a[164:167], a[88:91], v[188:191]
  ds_read_b128 a[68:71], v3 offset:28672
  v_rcp_f32 v59, v59
  v_mfma_f32_16x16x32_bf16 v[192:195], a[168:171], a[76:79], v[192:195]
  buffer_load_dwordx4 a[160:163], v2, s[8:11], s20 offen offset:2048
  v_rcp_f32 v60, v60
  v_mfma_f32_16x16x32_bf16 v[196:199], a[168:171], a[80:83], v[196:199]
  ds_read_b128 a[72:75], v3 offset:30720
  s_add_u32 s20, s20, 3072
  v_rcp_f32 v61, v61
  v_mfma_f32_16x16x32_bf16 v[200:203], a[168:171], a[84:87], v[200:203]
  buffer_load_dwordx4 a[212:215], v2, s[8:11], s20 offen offset:0
  v_mfma_f32_16x16x32_bf16 v[204:207], a[168:171], a[88:91], v[204:207]
  buffer_load_dwordx4 a[216:219], v2, s[8:11], s20 offen offset:1024
  v_mul_f32 v54, v54, v58
  v_mul_f32 v55, v55, v59
  v_mfma_f32_16x16x32_bf16 v[208:211], a[172:175], a[76:79], v[208:211]
  buffer_load_dwordx4 a[220:223], v2, s[8:11], s20 offen offset:2048
  v_mul_f32 v56, v56, v60
  v_mfma_f32_16x16x32_bf16 v[212:215], a[172:175], a[80:83], v[212:215]
  s_add_u32 s20, s20, 3072
  v_mul_f32 v57, v57, v61
  v_cvt_pk_bf16_f32 v64, v54, v55
  v_mfma_f32_16x16x32_bf16 v[216:219], a[172:175], a[84:87], v[216:219]
  v_cvt_pk_bf16_f32 v65, v56, v57
  ds_write_b64 v13, v[64:65] offset:6144
  v_mfma_f32_16x16x32_bf16 v[220:223], a[172:175], a[88:91], v[220:223]
  v_lshlrev_b32 v22, 16, v40
  v_and_b32 v23, 0xffff0000, v40
  v_lshlrev_b32 v24, 16, v41
  s_waitcnt vmcnt(24) lgkmcnt(1)
  v_mfma_f32_16x16x32_bf16 v[176:179], a[104:107], a[60:63], v[176:179]
  ds_read_b128 a[76:79], v4 offset:24576
  v_and_b32 v25, 0xffff0000, v41
  v_mfma_f32_16x16x32_bf16 v[180:183], a[104:107], a[64:67], v[180:183]
  buffer_load_dwordx4 a[164:167], v2, s[8:11], s20 offen offset:0
  v_mul_f32 v22, v53, v22
  v_mfma_f32_16x16x32_bf16 v[184:187], a[104:107], a[68:71], v[184:187]
  ds_read_b128 a[80:83], v4 offset:26624
  v_mul_f32 v23, v53, v23
  v_mfma_f32_16x16x32_bf16 v[188:191], a[104:107], a[72:75], v[188:191]
  buffer_load_dwordx4 a[168:171], v2, s[8:11], s20 offen offset:1024
  v_mfma_f32_16x16x32_bf16 v[192:195], a[108:111], a[60:63], v[192:195]
  ds_read_b128 a[84:87], v4 offset:28672
  v_mul_f32 v24, v53, v24
  v_mul_f32 v25, v53, v25
  v_mfma_f32_16x16x32_bf16 v[196:199], a[108:111], a[64:67], v[196:199]
  buffer_load_dwordx4 a[172:175], v2, s[8:11], s20 offen offset:2048
  v_mfma_f32_16x16x32_bf16 v[200:203], a[108:111], a[68:71], v[200:203]
  ds_read_b128 a[88:91], v4 offset:30720
  v_lshlrev_b32 v26, 16, v42
  v_mfma_f32_16x16x32_bf16 v[204:207], a[108:111], a[72:75], v[204:207]
  s_add_u32 s20, s20, 3072
  v_and_b32 v27, 0xffff0000, v42
  v_lshlrev_b32 v28, 16, v43
  v_mfma_f32_16x16x32_bf16 v[208:211], a[112:115], a[60:63], v[208:211]
  v_and_b32 v29, 0xffff0000, v43
  v_mul_f32 v26, v53, v26
  v_mfma_f32_16x16x32_bf16 v[212:215], a[112:115], a[64:67], v[212:215]
  v_mul_f32 v27, v53, v27
  v_mul_f32 v28, v53, v28
  v_mfma_f32_16x16x32_bf16 v[216:219], a[112:115], a[68:71], v[216:219]
  v_mul_f32 v29, v53, v29
  v_lshlrev_b32 v30, 16, v44
  v_and_b32 v31, 0xffff0000, v44
  v_mfma_f32_16x16x32_bf16 v[220:223], a[112:115], a[72:75], v[220:223]
  v_lshlrev_b32 v32, 16, v45
  v_and_b32 v33, 0xffff0000, v45
  s_waitcnt vmcnt(24) lgkmcnt(0)
  v_mfma_f32_16x16x32_bf16 v[176:179], a[176:179], a[76:79], v[176:179]
  ds_read_b128 a[60:63], v3 offset:32768
  v_mul_f32 v30, v53, v30
  v_mfma_f32_16x16x32_bf16 v[180:183], a[176:179], a[80:83], v[180:183]
  buffer_load_dwordx4 a[104:107], v2, s[8:11], s20 offen offset:0
  v_mul_f32 v31, v53, v31
  v_mfma_f32_16x16x32_bf16 v[184:187], a[176:179], a[84:87], v[184:187]
  ds_read_b128 a[64:67], v3 offset:34816
  v_mul_f32 v32, v53, v32
  v_mfma_f32_16x16x32_bf16 v[188:191], a[176:179], a[88:91], v[188:191]
  buffer_load_dwordx4 a[108:111], v2, s[8:11], s20 offen offset:1024
  v_mul_f32 v33, v53, v33
  v_mfma_f32_16x16x32_bf16 v[192:195], a[180:183], a[76:79], v[192:195]
  ds_read_b128 a[68:71], v3 offset:36864
  v_fma_f32 v54, v128, v18, v22
  v_mfma_f32_16x16x32_bf16 v[196:199], a[180:183], a[80:83], v[196:199]
  buffer_load_dwordx4 a[112:115], v2, s[8:11], s20 offen offset:2048
  v_fma_f32 v55, v129, v18, v23
  v_mfma_f32_16x16x32_bf16 v[200:203], a[180:183], a[84:87], v[200:203]
  ds_read_b128 a[72:75], v3 offset:38912
  v_fma_f32 v56, v130, v18, v24
  v_mfma_f32_16x16x32_bf16 v[204:207], a[180:183], a[88:91], v[204:207]
  s_add_u32 s20, s20, 3072
  v_fma_f32 v57, v131, v18, v25
  v_mfma_f32_16x16x32_bf16 v[208:211], a[184:187], a[76:79], v[208:211]
  v_fma_f32 v58, v54, v54, v52
  v_fma_f32 v59, v55, v55, v52
  v_fma_f32 v60, v56, v56, v52
  v_mfma_f32_16x16x32_bf16 v[212:215], a[184:187], a[80:83], v[212:215]
  v_fma_f32 v61, v57, v57, v52
  v_mul_f32 v58, v54, v58
  v_mfma_f32_16x16x32_bf16 v[216:219], a[184:187], a[84:87], v[216:219]
  v_mul_f32 v59, v55, v59
  v_mul_f32 v60, v56, v60
  v_mul_f32 v61, v57, v61
  v_mfma_f32_16x16x32_bf16 v[220:223], a[184:187], a[88:91], v[220:223]
  v_exp_f32_e64 v58, -v58
  s_waitcnt vmcnt(24) lgkmcnt(0)
  v_mfma_f32_16x16x32_bf16 v[176:179], a[116:119], a[60:63], v[176:179]
  ds_read_b128 a[76:79], v4 offset:32768
  v_exp_f32_e64 v59, -v59
  v_mfma_f32_16x16x32_bf16 v[180:183], a[116:119], a[64:67], v[180:183]
  buffer_load_dwordx4 a[176:179], v2, s[8:11], s20 offen offset:0
  v_mfma_f32_16x16x32_bf16 v[184:187], a[116:119], a[68:71], v[184:187]
  ds_read_b128 a[80:83], v4 offset:34816
  v_exp_f32_e64 v60, -v60
  v_mfma_f32_16x16x32_bf16 v[188:191], a[116:119], a[72:75], v[188:191]
  buffer_load_dwordx4 a[180:183], v2, s[8:11], s20 offen offset:1024
  v_exp_f32_e64 v61, -v61
  v_mfma_f32_16x16x32_bf16 v[192:195], a[120:123], a[60:63], v[192:195]
  ds_read_b128 a[84:87], v4 offset:36864
  v_fma_f32 v58, v58, v53, v53
  v_fma_f32 v59, v59, v53, v53
  v_mfma_f32_16x16x32_bf16 v[196:199], a[120:123], a[64:67], v[196:199]
  buffer_load_dwordx4 a[184:187], v2, s[8:11], s20 offen offset:2048
  v_fma_f32 v60, v60, v53, v53
  v_mfma_f32_16x16x32_bf16 v[200:203], a[120:123], a[68:71], v[200:203]
  ds_read_b128 a[88:91], v4 offset:38912
  v_fma_f32 v61, v61, v53, v53
  v_mfma_f32_16x16x32_bf16 v[204:207], a[120:123], a[72:75], v[204:207]
  s_mov_b32 s20, s21
  v_rcp_f32 v58, v58
  v_mfma_f32_16x16x32_bf16 v[208:211], a[124:127], a[60:63], v[208:211]
  v_rcp_f32 v59, v59
  v_rcp_f32 v60, v60
  v_mfma_f32_16x16x32_bf16 v[212:215], a[124:127], a[64:67], v[212:215]
  v_rcp_f32 v61, v61
  v_mfma_f32_16x16x32_bf16 v[216:219], a[124:127], a[68:71], v[216:219]
  v_mul_f32 v54, v54, v58
  v_mul_f32 v55, v55, v59
  v_mul_f32 v56, v56, v60
  v_mfma_f32_16x16x32_bf16 v[220:223], a[124:127], a[72:75], v[220:223]
  v_mul_f32 v57, v57, v61
  v_cvt_pk_bf16_f32 v62, v54, v55
  v_cvt_pk_bf16_f32 v63, v56, v57
  s_waitcnt vmcnt(24) lgkmcnt(0)
  v_mfma_f32_16x16x32_bf16 v[176:179], a[188:191], a[76:79], v[176:179]
  ds_read_b128 a[60:63], v3 offset:40960
  ds_write_b64 v11, v[62:63] offset:24576
  v_mfma_f32_16x16x32_bf16 v[180:183], a[188:191], a[80:83], v[180:183]
  buffer_load_dwordx4 a[224:227], v2, s[8:11], s20 offen offset:0
  v_fma_f32 v54, v132, v19, v22
  v_mfma_f32_16x16x32_bf16 v[184:187], a[188:191], a[84:87], v[184:187]
  ds_read_b128 a[64:67], v3 offset:43008
  v_fma_f32 v55, v133, v19, v23
  v_fma_f32 v56, v134, v19, v24
  v_mfma_f32_16x16x32_bf16 v[188:191], a[188:191], a[88:91], v[188:191]
  buffer_load_dwordx4 a[228:231], v2, s[8:11], s20 offen offset:1024
  v_mfma_f32_16x16x32_bf16 v[192:195], a[192:195], a[76:79], v[192:195]
  ds_read_b128 a[68:71], v3 offset:45056
  v_fma_f32 v57, v135, v19, v25
  v_fma_f32 v58, v54, v54, v52
  v_mfma_f32_16x16x32_bf16 v[196:199], a[192:195], a[80:83], v[196:199]
  buffer_load_dwordx4 a[232:235], v2, s[8:11], s20 offen offset:2048
  v_fma_f32 v59, v55, v55, v52
  v_mfma_f32_16x16x32_bf16 v[200:203], a[192:195], a[84:87], v[200:203]
  ds_read_b128 a[72:75], v3 offset:47104
  v_fma_f32 v60, v56, v56, v52
  v_mfma_f32_16x16x32_bf16 v[204:207], a[192:195], a[88:91], v[204:207]
  s_add_u32 s20, s20, 3072
  v_fma_f32 v61, v57, v57, v52
  v_mul_f32 v58, v54, v58
  v_mfma_f32_16x16x32_bf16 v[208:211], a[196:199], a[76:79], v[208:211]
  v_mul_f32 v59, v55, v59
  v_mul_f32 v60, v56, v60
  v_mul_f32 v61, v57, v61
  v_mfma_f32_16x16x32_bf16 v[212:215], a[196:199], a[80:83], v[212:215]
  v_exp_f32_e64 v58, -v58
  v_mfma_f32_16x16x32_bf16 v[216:219], a[196:199], a[84:87], v[216:219]
  v_exp_f32_e64 v59, -v59
  v_exp_f32_e64 v60, -v60
  v_mfma_f32_16x16x32_bf16 v[220:223], a[196:199], a[88:91], v[220:223]
  v_exp_f32_e64 v61, -v61
  s_waitcnt vmcnt(24) lgkmcnt(0)
  v_mfma_f32_16x16x32_bf16 v[176:179], a[128:131], a[60:63], v[176:179]
  ds_read_b128 a[76:79], v4 offset:40960
  v_fma_f32 v58, v58, v53, v53
  v_fma_f32 v59, v59, v53, v53
  v_mfma_f32_16x16x32_bf16 v[180:183], a[128:131], a[64:67], v[180:183]
  buffer_load_dwordx4 a[236:239], v2, s[8:11], s20 offen offset:0
  v_mfma_f32_16x16x32_bf16 v[184:187], a[128:131], a[68:71], v[184:187]
  ds_read_b128 a[80:83], v4 offset:43008
  v_fma_f32 v60, v60, v53, v53
  v_fma_f32 v61, v61, v53, v53
  v_mfma_f32_16x16x32_bf16 v[188:191], a[128:131], a[72:75], v[188:191]
  buffer_load_dwordx4 a[240:243], v2, s[8:11], s20 offen offset:1024
  v_mfma_f32_16x16x32_bf16 v[192:195], a[132:135], a[60:63], v[192:195]
  ds_read_b128 a[84:87], v4 offset:45056
  v_rcp_f32 v58, v58
  v_mfma_f32_16x16x32_bf16 v[196:199], a[132:135], a[64:67], v[196:199]
  buffer_load_dwordx4 a[244:247], v2, s[8:11], s20 offen offset:2048
  v_mfma_f32_16x16x32_bf16 v[200:203], a[132:135], a[68:71], v[200:203]
  ds_read_b128 a[88:91], v4 offset:47104
  v_rcp_f32 v59, v59
  v_mfma_f32_16x16x32_bf16 v[204:207], a[132:135], a[72:75], v[204:207]
  s_add_u32 s20, s20, 3072
  v_rcp_f32 v60, v60
  v_mfma_f32_16x16x32_bf16 v[208:211], a[136:139], a[60:63], v[208:211]
  v_rcp_f32 v61, v61
  v_mul_f32 v54, v54, v58
  v_mfma_f32_16x16x32_bf16 v[212:215], a[136:139], a[64:67], v[212:215]
  v_mul_f32 v55, v55, v59
  v_mul_f32 v56, v56, v60
  v_mfma_f32_16x16x32_bf16 v[216:219], a[136:139], a[68:71], v[216:219]
  v_mul_f32 v57, v57, v61
  v_cvt_pk_bf16_f32 v64, v54, v55
  v_cvt_pk_bf16_f32 v65, v56, v57
  v_mfma_f32_16x16x32_bf16 v[220:223], a[136:139], a[72:75], v[220:223]
  ds_write_b64 v11, v[64:65] offset:26624
  v_fma_f32 v54, v136, v20, v22
  s_waitcnt vmcnt(24) lgkmcnt(1)
  v_mfma_f32_16x16x32_bf16 v[176:179], a[200:203], a[76:79], v[176:179]
  ds_read_b128 a[60:63], v3 offset:49152
  v_fma_f32 v55, v137, v20, v23
  v_fma_f32 v56, v138, v20, v24
  v_mfma_f32_16x16x32_bf16 v[180:183], a[200:203], a[80:83], v[180:183]
  buffer_load_dwordx4 a[0:3], v2, s[8:11], s20 offen offset:0
  v_mfma_f32_16x16x32_bf16 v[184:187], a[200:203], a[84:87], v[184:187]
  ds_read_b128 a[64:67], v3 offset:51200
  v_fma_f32 v57, v139, v20, v25
  v_fma_f32 v58, v54, v54, v52
  v_mfma_f32_16x16x32_bf16 v[188:191], a[200:203], a[88:91], v[188:191]
  buffer_load_dwordx4 a[4:7], v2, s[8:11], s20 offen offset:1024
  v_fma_f32 v59, v55, v55, v52
  v_mfma_f32_16x16x32_bf16 v[192:195], a[204:207], a[76:79], v[192:195]
  ds_read_b128 a[68:71], v3 offset:53248
  v_fma_f32 v60, v56, v56, v52
  v_mfma_f32_16x16x32_bf16 v[196:199], a[204:207], a[80:83], v[196:199]
  buffer_load_dwordx4 a[8:11], v2, s[8:11], s20 offen offset:2048
  v_fma_f32 v61, v57, v57, v52
  v_mfma_f32_16x16x32_bf16 v[200:203], a[204:207], a[84:87], v[200:203]
  ds_read_b128 a[72:75], v3 offset:55296
  v_mul_f32 v58, v54, v58
  v_mul_f32 v59, v55, v59
  v_mfma_f32_16x16x32_bf16 v[204:207], a[204:207], a[88:91], v[204:207]
  s_add_u32 s20, s20, 3072
  v_mul_f32 v60, v56, v60
  v_mfma_f32_16x16x32_bf16 v[208:211], a[208:211], a[76:79], v[208:211]
  v_mul_f32 v61, v57, v61
  v_exp_f32_e64 v58, -v58
  v_mfma_f32_16x16x32_bf16 v[212:215], a[208:211], a[80:83], v[212:215]
  v_exp_f32_e64 v59, -v59
  v_mfma_f32_16x16x32_bf16 v[216:219], a[208:211], a[84:87], v[216:219]
  v_exp_f32_e64 v60, -v60
  v_exp_f32_e64 v61, -v61
  v_mfma_f32_16x16x32_bf16 v[220:223], a[208:211], a[88:91], v[220:223]
  v_fma_f32 v58, v58, v53, v53
  v_fma_f32 v59, v59, v53, v53
  s_waitcnt vmcnt(24) lgkmcnt(0)
  v_mfma_f32_16x16x32_bf16 v[176:179], a[140:143], a[60:63], v[176:179]
  ds_read_b128 a[76:79], v4 offset:49152
  v_fma_f32 v60, v60, v53, v53
  v_fma_f32 v61, v61, v53, v53
  v_mfma_f32_16x16x32_bf16 v[180:183], a[140:143], a[64:67], v[180:183]
  buffer_load_dwordx4 a[12:15], v2, s[8:11], s20 offen offset:0
  v_mfma_f32_16x16x32_bf16 v[184:187], a[140:143], a[68:71], v[184:187]
  ds_read_b128 a[80:83], v4 offset:51200
  v_rcp_f32 v58, v58
  v_mfma_f32_16x16x32_bf16 v[188:191], a[140:143], a[72:75], v[188:191]
  buffer_load_dwordx4 a[16:19], v2, s[8:11], s20 offen offset:1024
  v_mfma_f32_16x16x32_bf16 v[192:195], a[144:147], a[60:63], v[192:195]
  ds_read_b128 a[84:87], v4 offset:53248
  v_rcp_f32 v59, v59
  v_mfma_f32_16x16x32_bf16 v[196:199], a[144:147], a[64:67], v[196:199]
  buffer_load_dwordx4 a[20:23], v2, s[8:11], s20 offen offset:2048
  v_rcp_f32 v60, v60
  v_mfma_f32_16x16x32_bf16 v[200:203], a[144:147], a[68:71], v[200:203]
  ds_read_b128 a[88:91], v4 offset:55296
  v_mfma_f32_16x16x32_bf16 v[204:207], a[144:147], a[72:75], v[204:207]
  s_add_u32 s20, s20, 3072
  v_rcp_f32 v61, v61
  v_mul_f32 v54, v54, v58
  v_mfma_f32_16x16x32_bf16 v[208:211], a[148:151], a[60:63], v[208:211]
  v_mul_f32 v55, v55, v59
  v_mul_f32 v56, v56, v60
  v_mfma_f32_16x16x32_bf16 v[212:215], a[148:151], a[64:67], v[212:215]
  v_mul_f32 v57, v57, v61
  v_cvt_pk_bf16_f32 v62, v54, v55
  v_cvt_pk_bf16_f32 v63, v56, v57
  v_mfma_f32_16x16x32_bf16 v[216:219], a[148:151], a[68:71], v[216:219]
  ds_write_b64 v11, v[62:63] offset:28672
  v_fma_f32 v54, v140, v21, v22
  v_mfma_f32_16x16x32_bf16 v[220:223], a[148:151], a[72:75], v[220:223]
  v_fma_f32 v55, v141, v21, v23
  v_fma_f32 v56, v142, v21, v24
  v_fma_f32 v57, v143, v21, v25
  s_waitcnt vmcnt(24) lgkmcnt(1)
  v_mfma_f32_16x16x32_bf16 v[176:179], a[152:155], a[76:79], v[176:179]
  ds_read_b128 a[60:63], v3 offset:57344
  v_fma_f32 v58, v54, v54, v52
  v_fma_f32 v59, v55, v55, v52
  v_mfma_f32_16x16x32_bf16 v[180:183], a[152:155], a[80:83], v[180:183]
  buffer_load_dwordx4 a[24:27], v2, s[8:11], s20 offen offset:0
  v_fma_f32 v60, v56, v56, v52
  v_mfma_f32_16x16x32_bf16 v[184:187], a[152:155], a[84:87], v[184:187]
  ds_read_b128 a[64:67], v3 offset:59392
  v_fma_f32 v61, v57, v57, v52
  v_mfma_f32_16x16x32_bf16 v[188:191], a[152:155], a[88:91], v[188:191]
  buffer_load_dwordx4 a[28:31], v2, s[8:11], s20 offen offset:1024
  v_mul_f32 v58, v54, v58
  v_mfma_f32_16x16x32_bf16 v[192:195], a[156:159], a[76:79], v[192:195]
  ds_read_b128 a[68:71], v3 offset:61440
  v_mul_f32 v59, v55, v59
  v_mul_f32 v60, v56, v60
  v_mfma_f32_16x16x32_bf16 v[196:199], a[156:159], a[80:83], v[196:199]
  buffer_load_dwordx4 a[32:35], v2, s[8:11], s20 offen offset:2048
  v_mul_f32 v61, v57, v61
  v_mfma_f32_16x16x32_bf16 v[200:203], a[156:159], a[84:87], v[200:203]
  ds_read_b128 a[72:75], v3 offset:63488
  v_exp_f32_e64 v58, -v58
  v_mfma_f32_16x16x32_bf16 v[204:207], a[156:159], a[88:91], v[204:207]
  s_add_u32 s20, s20, 3072
  v_exp_f32_e64 v59, -v59
  v_mfma_f32_16x16x32_bf16 v[208:211], a[160:163], a[76:79], v[208:211]
  v_exp_f32_e64 v60, -v60
  v_mfma_f32_16x16x32_bf16 v[212:215], a[160:163], a[80:83], v[212:215]
  v_exp_f32_e64 v61, -v61
  v_fma_f32 v58, v58, v53, v53
  v_mfma_f32_16x16x32_bf16 v[216:219], a[160:163], a[84:87], v[216:219]
  v_fma_f32 v59, v59, v53, v53
  v_fma_f32 v60, v60, v53, v53
  v_mfma_f32_16x16x32_bf16 v[220:223], a[160:163], a[88:91], v[220:223]
  v_fma_f32 v61, v61, v53, v53
  v_rcp_f32 v58, v58
  s_waitcnt vmcnt(24) lgkmcnt(0)
  v_mfma_f32_16x16x32_bf16 v[176:179], a[212:215], a[60:63], v[176:179]
  ds_read_b128 a[76:79], v4 offset:57344
  buffer_load_dwordx4 a[36:39], v2, s[8:11], s20 offen offset:0
  v_mfma_f32_16x16x32_bf16 v[180:183], a[212:215], a[64:67], v[180:183]
  ds_read_b128 a[80:83], v4 offset:59392
  v_rcp_f32 v59, v59
  v_mfma_f32_16x16x32_bf16 v[184:187], a[212:215], a[68:71], v[184:187]
  buffer_load_dwordx4 a[40:43], v2, s[8:11], s20 offen offset:1024
  v_rcp_f32 v60, v60
  v_mfma_f32_16x16x32_bf16 v[188:191], a[212:215], a[72:75], v[188:191]
  ds_read_b128 a[84:87], v4 offset:61440
  v_rcp_f32 v61, v61
  v_mfma_f32_16x16x32_bf16 v[192:195], a[216:219], a[60:63], v[192:195]
  buffer_load_dwordx4 a[44:47], v2, s[8:11], s20 offen offset:2048
  v_mul_f32 v54, v54, v58
  v_mfma_f32_16x16x32_bf16 v[196:199], a[216:219], a[64:67], v[196:199]
  ds_read_b128 a[88:91], v4 offset:63488
  s_add_u32 s20, s20, 3072
  v_mul_f32 v55, v55, v59
  v_mfma_f32_16x16x32_bf16 v[200:203], a[216:219], a[68:71], v[200:203]
  buffer_load_dwordx4 a[48:51], v2, s[8:11], s20 offen offset:0
  v_mul_f32 v56, v56, v60
  v_mfma_f32_16x16x32_bf16 v[204:207], a[216:219], a[72:75], v[204:207]
  buffer_load_dwordx4 a[52:55], v2, s[8:11], s20 offen offset:1024
  v_mul_f32 v57, v57, v61
  v_cvt_pk_bf16_f32 v64, v54, v55
  v_mfma_f32_16x16x32_bf16 v[208:211], a[220:223], a[60:63], v[208:211]
  buffer_load_dwordx4 a[56:59], v2, s[8:11], s20 offen offset:2048
  v_cvt_pk_bf16_f32 v65, v56, v57
  v_mfma_f32_16x16x32_bf16 v[212:215], a[220:223], a[64:67], v[212:215]
  s_add_u32 s20, s20, 3072
  ds_write_b64 v11, v[64:65] offset:30720
  v_fma_f32 v54, v144, v18, v26
  v_mfma_f32_16x16x32_bf16 v[216:219], a[220:223], a[68:71], v[216:219]
  v_fma_f32 v55, v145, v18, v27
  v_fma_f32 v56, v146, v18, v28
  v_fma_f32 v57, v147, v18, v29
  v_mfma_f32_16x16x32_bf16 v[220:223], a[220:223], a[72:75], v[220:223]
  v_fma_f32 v58, v54, v54, v52
  v_fma_f32 v59, v55, v55, v52
  v_fma_f32 v60, v56, v56, v52
  s_waitcnt vmcnt(27) lgkmcnt(1)
  v_mfma_f32_16x16x32_bf16 v[176:179], a[164:167], a[76:79], v[176:179]
  ds_read_b128 a[60:63], v5 offset:0
  v_fma_f32 v61, v57, v57, v52
  v_mul_f32 v58, v54, v58
  v_mfma_f32_16x16x32_bf16 v[180:183], a[164:167], a[80:83], v[180:183]
  buffer_load_dwordx4 v[80:83], v2, s[8:11], s20 offen offset:0
  v_mul_f32 v59, v55, v59
  v_mfma_f32_16x16x32_bf16 v[184:187], a[164:167], a[84:87], v[184:187]
  ds_read_b128 a[64:67], v5 offset:2048
  v_mul_f32 v60, v56, v60
  v_mul_f32 v61, v57, v61
  v_mfma_f32_16x16x32_bf16 v[188:191], a[164:167], a[88:91], v[188:191]
  buffer_load_dwordx4 v[84:87], v2, s[8:11], s20 offen offset:1024
  v_mfma_f32_16x16x32_bf16 v[192:195], a[168:171], a[76:79], v[192:195]
  ds_read_b128 a[68:71], v5 offset:4096
  v_exp_f32_e64 v58, -v58
  v_mfma_f32_16x16x32_bf16 v[196:199], a[168:171], a[80:83], v[196:199]
  buffer_load_dwordx4 v[88:91], v2, s[8:11], s20 offen offset:2048
  v_exp_f32_e64 v59, -v59
  v_mfma_f32_16x16x32_bf16 v[200:203], a[168:171], a[84:87], v[200:203]
  ds_read_b128 a[72:75], v5 offset:6144
  v_mfma_f32_16x16x32_bf16 v[204:207], a[168:171], a[88:91], v[204:207]
  s_add_u32 s20, s20, 3072
  v_exp_f32_e64 v60, -v60
  v_mfma_f32_16x16x32_bf16 v[208:211], a[172:175], a[76:79], v[208:211]
  v_exp_f32_e64 v61, -v61
  v_fma_f32 v58, v58, v53, v53
  v_fma_f32 v59, v59, v53, v53
  v_mfma_f32_16x16x32_bf16 v[212:215], a[172:175], a[80:83], v[212:215]
  v_fma_f32 v60, v60, v53, v53
  v_fma_f32 v61, v61, v53, v53
  v_mfma_f32_16x16x32_bf16 v[216:219], a[172:175], a[84:87], v[216:219]
  v_rcp_f32 v58, v58
  v_rcp_f32 v59, v59
  v_mfma_f32_16x16x32_bf16 v[220:223], a[172:175], a[88:91], v[220:223]
  v_rcp_f32 v60, v60
  s_waitcnt vmcnt(27) lgkmcnt(0)
  v_mfma_f32_16x16x32_bf16 v[176:179], a[104:107], a[60:63], v[176:179]
  ds_read_b128 a[76:79], v6 offset:0
  v_rcp_f32 v61, v61
  v_mfma_f32_16x16x32_bf16 v[180:183], a[104:107], a[64:67], v[180:183]
  buffer_load_dwordx4 v[92:95], v2, s[8:11], s20 offen offset:0
  v_mfma_f32_16x16x32_bf16 v[184:187], a[104:107], a[68:71], v[184:187]
  ds_read_b128 a[80:83], v6 offset:2048
  v_mul_f32 v54, v54, v58
  v_mfma_f32_16x16x32_bf16 v[188:191], a[104:107], a[72:75], v[188:191]
  buffer_load_dwordx4 v[96:99], v2, s[8:11], s20 offen offset:1024
  v_mul_f32 v55, v55, v59
  v_mfma_f32_16x16x32_bf16 v[192:195], a[108:111], a[60:63], v[192:195]
  ds_read_b128 a[84:87], v6 offset:4096
  v_mul_f32 v56, v56, v60
  v_mfma_f32_16x16x32_bf16 v[196:199], a[108:111], a[64:67], v[196:199]
  buffer_load_dwordx4 v[100:103], v2, s[8:11], s20 offen offset:2048
  v_mul_f32 v57, v57, v61
  v_mfma_f32_16x16x32_bf16 v[200:203], a[108:111], a[68:71], v[200:203]
  ds_read_b128 a[88:91], v6 offset:6144
  v_cvt_pk_bf16_f32 v62, v54, v55
  v_mfma_f32_16x16x32_bf16 v[204:207], a[108:111], a[72:75], v[204:207]
  s_add_u32 s20, s20, 3072
  v_cvt_pk_bf16_f32 v63, v56, v57
  v_mfma_f32_16x16x32_bf16 v[208:211], a[112:115], a[60:63], v[208:211]
  ds_write_b64 v12, v[62:63] offset:24576
  v_fma_f32 v54, v148, v19, v26
  v_fma_f32 v55, v149, v19, v27
  v_mfma_f32_16x16x32_bf16 v[212:215], a[112:115], a[64:67], v[212:215]
  v_fma_f32 v56, v150, v19, v28
  v_fma_f32 v57, v151, v19, v29
  v_mfma_f32_16x16x32_bf16 v[216:219], a[112:115], a[68:71], v[216:219]
  v_fma_f32 v58, v54, v54, v52
  v_fma_f32 v59, v55, v55, v52
  v_fma_f32 v60, v56, v56, v52
  v_mfma_f32_16x16x32_bf16 v[220:223], a[112:115], a[72:75], v[220:223]
  v_fma_f32 v61, v57, v57, v52
  v_mul_f32 v58, v54, v58
  s_waitcnt vmcnt(27) lgkmcnt(0)
  s_barrier
  v_mfma_f32_16x16x32_bf16 v[176:179], a[176:179], a[76:79], v[176:179]
  ds_read_b128 a[60:63], v7 offset:0
  v_mul_f32 v59, v55, v59
  v_mul_f32 v60, v56, v60
  v_mfma_f32_16x16x32_bf16 v[180:183], a[176:179], a[80:83], v[180:183]
  buffer_load_dwordx4 v[104:107], v2, s[8:11], s20 offen offset:0
  v_mul_f32 v61, v57, v61
  v_mfma_f32_16x16x32_bf16 v[184:187], a[176:179], a[84:87], v[184:187]
  ds_read_b128 a[64:67], v7 offset:2048
  v_exp_f32_e64 v58, -v58
  v_mfma_f32_16x16x32_bf16 v[188:191], a[176:179], a[88:91], v[188:191]
  buffer_load_dwordx4 v[108:111], v2, s[8:11], s20 offen offset:1024
  v_exp_f32_e64 v59, -v59
  v_mfma_f32_16x16x32_bf16 v[192:195], a[180:183], a[76:79], v[192:195]
  ds_read_b128 a[68:71], v7 offset:4096
  v_exp_f32_e64 v60, -v60
  v_mfma_f32_16x16x32_bf16 v[196:199], a[180:183], a[80:83], v[196:199]
  buffer_load_dwordx4 v[112:115], v2, s[8:11], s20 offen offset:2048
  v_mfma_f32_16x16x32_bf16 v[200:203], a[180:183], a[84:87], v[200:203]
  ds_read_b128 a[72:75], v7 offset:6144
  v_exp_f32_e64 v61, -v61
  v_mfma_f32_16x16x32_bf16 v[204:207], a[180:183], a[88:91], v[204:207]
  s_add_u32 s20, s20, 3072
  v_fma_f32 v58, v58, v53, v53
  v_fma_f32 v59, v59, v53, v53
  v_mfma_f32_16x16x32_bf16 v[208:211], a[184:187], a[76:79], v[208:211]
  v_fma_f32 v60, v60, v53, v53
  v_fma_f32 v61, v61, v53, v53
  v_rcp_f32 v58, v58
  v_mfma_f32_16x16x32_bf16 v[212:215], a[184:187], a[80:83], v[212:215]
  v_rcp_f32 v59, v59
  v_mfma_f32_16x16x32_bf16 v[216:219], a[184:187], a[84:87], v[216:219]
  v_rcp_f32 v60, v60
  v_rcp_f32 v61, v61
  v_mfma_f32_16x16x32_bf16 v[220:223], a[184:187], a[88:91], v[220:223]
  v_mul_f32 v54, v54, v58
  v_mul_f32 v55, v55, v59
  s_waitcnt vmcnt(27) lgkmcnt(0)
  v_mfma_f32_16x16x32_bf16 a[104:107], a[224:227], a[60:63], 0
  buffer_load_dwordx4 v[116:119], v2, s[8:11], s20 offen offset:0
  v_mfma_f32_16x16x32_bf16 a[108:111], a[224:227], a[64:67], 0
  v_mul_f32 v56, v56, v60
  v_mul_f32 v57, v57, v61
  v_mfma_f32_16x16x32_bf16 a[112:115], a[224:227], a[68:71], 0
  buffer_load_dwordx4 v[120:123], v2, s[8:11], s20 offen offset:1024
  v_mfma_f32_16x16x32_bf16 a[116:119], a[224:227], a[72:75], 0
  v_cvt_pk_bf16_f32 v64, v54, v55
  v_cvt_pk_bf16_f32 v65, v56, v57
  v_mfma_f32_16x16x32_bf16 a[120:123], a[228:231], a[60:63], 0
  buffer_load_dwordx4 v[124:127], v2, s[8:11], s20 offen offset:2048
  v_mfma_f32_16x16x32_bf16 a[124:127], a[228:231], a[64:67], 0
  ds_write_b64 v12, v[64:65] offset:26624
  v_fma_f32 v54, v152, v20, v26
  v_mfma_f32_16x16x32_bf16 a[128:131], a[228:231], a[68:71], 0
  s_add_u32 s20, s20, 3072
  v_fma_f32 v55, v153, v20, v27
  v_mfma_f32_16x16x32_bf16 a[132:135], a[228:231], a[72:75], 0
  v_fma_f32 v56, v154, v20, v28
  v_fma_f32 v57, v155, v20, v29
  v_mfma_f32_16x16x32_bf16 a[136:139], a[232:235], a[60:63], 0
  v_fma_f32 v58, v54, v54, v52
  v_fma_f32 v59, v55, v55, v52
  v_mfma_f32_16x16x32_bf16 a[140:143], a[232:235], a[64:67], 0
  v_fma_f32 v60, v56, v56, v52
  v_fma_f32 v61, v57, v57, v52
  v_mfma_f32_16x16x32_bf16 a[144:147], a[232:235], a[68:71], 0
  v_mul_f32 v58, v54, v58
  v_mul_f32 v59, v55, v59
  v_mfma_f32_16x16x32_bf16 a[148:151], a[232:235], a[72:75], 0
  v_mul_f32 v60, v56, v60
  v_mul_f32 v61, v57, v61
  s_waitcnt vmcnt(27)
  v_mfma_f32_16x16x32_bf16 a[152:155], a[236:239], a[60:63], 0
  v_exp_f32_e64 v58, -v58
  v_mfma_f32_16x16x32_bf16 a[156:159], a[236:239], a[64:67], 0
  v_exp_f32_e64 v59, -v59
  v_mfma_f32_16x16x32_bf16 a[160:163], a[236:239], a[68:71], 0
  v_exp_f32_e64 v60, -v60
  v_mfma_f32_16x16x32_bf16 a[164:167], a[236:239], a[72:75], 0
  v_exp_f32_e64 v61, -v61
  v_mfma_f32_16x16x32_bf16 a[168:171], a[240:243], a[60:63], 0
  v_fma_f32 v58, v58, v53, v53
  v_fma_f32 v59, v59, v53, v53
  v_mfma_f32_16x16x32_bf16 a[172:175], a[240:243], a[64:67], 0
  v_fma_f32 v60, v60, v53, v53
  v_fma_f32 v61, v61, v53, v53
  v_mfma_f32_16x16x32_bf16 a[176:179], a[240:243], a[68:71], 0
  v_rcp_f32 v58, v58
  v_mfma_f32_16x16x32_bf16 a[180:183], a[240:243], a[72:75], 0
  v_rcp_f32 v59, v59
  v_mfma_f32_16x16x32_bf16 a[184:187], a[244:247], a[60:63], 0
  v_rcp_f32 v60, v60
  v_mfma_f32_16x16x32_bf16 a[188:191], a[244:247], a[64:67], 0
  v_rcp_f32 v61, v61
  v_mfma_f32_16x16x32_bf16 a[192:195], a[244:247], a[68:71], 0
  v_mul_f32 v54, v54, v58
  v_mul_f32 v55, v55, v59
  v_mfma_f32_16x16x32_bf16 a[196:199], a[244:247], a[72:75], 0
  v_mul_f32 v56, v56, v60
  v_mul_f32 v57, v57, v61
  s_waitcnt vmcnt(24)
  v_mfma_f32_16x16x32_bf16 a[200:203], a[0:3], a[60:63], 0
  ds_read_b128 a[76:79], v8 offset:0
  v_cvt_pk_bf16_f32 v62, v54, v55
  v_mfma_f32_16x16x32_bf16 a[204:207], a[0:3], a[64:67], 0
  v_cvt_pk_bf16_f32 v63, v56, v57
  ds_write_b64 v12, v[62:63] offset:28672
  v_mfma_f32_16x16x32_bf16 a[208:211], a[0:3], a[68:71], 0
  ds_read_b128 a[80:83], v8 offset:2048
  v_mfma_f32_16x16x32_bf16 a[212:215], a[0:3], a[72:75], 0
  v_fma_f32 v54, v156, v21, v26
  v_fma_f32 v55, v157, v21, v27
  v_mfma_f32_16x16x32_bf16 a[216:219], a[4:7], a[60:63], 0
  ds_read_b128 a[84:87], v8 offset:4096
  v_fma_f32 v56, v158, v21, v28
  v_mfma_f32_16x16x32_bf16 a[220:223], a[4:7], a[64:67], 0
  v_fma_f32 v57, v159, v21, v29
  v_fma_f32 v58, v54, v54, v52
  v_mfma_f32_16x16x32_bf16 a[224:227], a[4:7], a[68:71], 0
  ds_read_b128 a[88:91], v8 offset:6144
  v_fma_f32 v59, v55, v55, v52
  v_mfma_f32_16x16x32_bf16 a[228:231], a[4:7], a[72:75], 0
  v_fma_f32 v60, v56, v56, v52
  v_fma_f32 v61, v57, v57, v52
  v_mfma_f32_16x16x32_bf16 a[232:235], a[8:11], a[60:63], 0
  v_mul_f32 v58, v54, v58
  v_mul_f32 v59, v55, v59
  v_mfma_f32_16x16x32_bf16 a[236:239], a[8:11], a[64:67], 0
  v_mul_f32 v60, v56, v60
  v_mul_f32 v61, v57, v61
  v_mfma_f32_16x16x32_bf16 a[240:243], a[8:11], a[68:71], 0
  v_exp_f32_e64 v58, -v58
  v_mfma_f32_16x16x32_bf16 a[244:247], a[8:11], a[72:75], 0
  v_exp_f32_e64 v59, -v59
  s_waitcnt vmcnt(21) lgkmcnt(0)
  v_mfma_f32_16x16x32_bf16 a[104:107], a[12:15], a[76:79], a[104:107]
  buffer_load_dwordx4 a[0:3], v2, s[8:11], s20 offen offset:0
  v_mfma_f32_16x16x32_bf16 a[108:111], a[12:15], a[80:83], a[108:111]
  v_exp_f32_e64 v60, -v60
  v_exp_f32_e64 v61, -v61
  v_mfma_f32_16x16x32_bf16 a[112:115], a[12:15], a[84:87], a[112:115]
  buffer_load_dwordx4 a[4:7], v2, s[8:11], s20 offen offset:1024
  v_mfma_f32_16x16x32_bf16 a[116:119], a[12:15], a[88:91], a[116:119]
  v_fma_f32 v58, v58, v53, v53
  v_fma_f32 v59, v59, v53, v53
  v_mfma_f32_16x16x32_bf16 a[120:123], a[16:19], a[76:79], a[120:123]
  buffer_load_dwordx4 a[8:11], v2, s[8:11], s20 offen offset:2048
  v_fma_f32 v60, v60, v53, v53
  v_mfma_f32_16x16x32_bf16 a[124:127], a[16:19], a[80:83], a[124:127]
  v_fma_f32 v61, v61, v53, v53
  v_rcp_f32 v58, v58
  v_mfma_f32_16x16x32_bf16 a[128:131], a[16:19], a[84:87], a[128:131]
  s_add_u32 s20, s20, 3072
  v_mfma_f32_16x16x32_bf16 a[132:135], a[16:19], a[88:91], a[132:135]
  v_rcp_f32 v59, v59
  v_rcp_f32 v60, v60
  v_mfma_f32_16x16x32_bf16 a[136:139], a[20:23], a[76:79], a[136:139]
  v_rcp_f32 v61, v61
  v_mfma_f32_16x16x32_bf16 a[140:143], a[20:23], a[80:83], a[140:143]
  v_mul_f32 v54, v54, v58
  v_mul_f32 v55, v55, v59
  v_mfma_f32_16x16x32_bf16 a[144:147], a[20:23], a[84:87], a[144:147]
  v_mul_f32 v56, v56, v60
  v_mul_f32 v57, v57, v61
  v_cvt_pk_bf16_f32 v64, v54, v55
  v_mfma_f32_16x16x32_bf16 a[148:151], a[20:23], a[88:91], a[148:151]
  v_cvt_pk_bf16_f32 v65, v56, v57
  ds_write_b64 v12, v[64:65] offset:30720
  s_waitcnt vmcnt(21)
  v_mfma_f32_16x16x32_bf16 a[152:155], a[24:27], a[76:79], a[152:155]
  buffer_load_dwordx4 a[12:15], v2, s[8:11], s20 offen offset:0
  v_mfma_f32_16x16x32_bf16 a[156:159], a[24:27], a[80:83], a[156:159]
  v_fma_f32 v54, v160, v18, v30
  v_fma_f32 v55, v161, v18, v31
  v_fma_f32 v56, v162, v18, v32
  v_mfma_f32_16x16x32_bf16 a[160:163], a[24:27], a[84:87], a[160:163]
  buffer_load_dwordx4 a[16:19], v2, s[8:11], s20 offen offset:1024
  v_mfma_f32_16x16x32_bf16 a[164:167], a[24:27], a[88:91], a[164:167]
  v_fma_f32 v57, v163, v18, v33
  v_fma_f32 v58, v54, v54, v52
  v_mfma_f32_16x16x32_bf16 a[168:171], a[28:31], a[76:79], a[168:171]
  buffer_load_dwordx4 a[20:23], v2, s[8:11], s20 offen offset:2048
  v_fma_f32 v59, v55, v55, v52
  v_mfma_f32_16x16x32_bf16 a[172:175], a[28:31], a[80:83], a[172:175]
  v_fma_f32 v60, v56, v56, v52
  v_fma_f32 v61, v57, v57, v52
  v_mfma_f32_16x16x32_bf16 a[176:179], a[28:31], a[84:87], a[176:179]
  s_add_u32 s20, s20, 3072
  v_mul_f32 v58, v54, v58
  v_mfma_f32_16x16x32_bf16 a[180:183], a[28:31], a[88:91], a[180:183]
  v_mul_f32 v59, v55, v59
  v_mul_f32 v60, v56, v60
  v_mul_f32 v61, v57, v61
  v_mfma_f32_16x16x32_bf16 a[184:187], a[32:35], a[76:79], a[184:187]
  v_exp_f32_e64 v58, -v58
  v_mfma_f32_16x16x32_bf16 a[188:191], a[32:35], a[80:83], a[188:191]
  v_exp_f32_e64 v59, -v59
  v_mfma_f32_16x16x32_bf16 a[192:195], a[32:35], a[84:87], a[192:195]
  v_exp_f32_e64 v60, -v60
  v_mfma_f32_16x16x32_bf16 a[196:199], a[32:35], a[88:91], a[196:199]
  v_exp_f32_e64 v61, -v61
  v_fma_f32 v58, v58, v53, v53
  s_waitcnt vmcnt(21)
  v_mfma_f32_16x16x32_bf16 a[200:203], a[36:39], a[76:79], a[200:203]
  ds_read_b128 a[60:63], v7 offset:8192
  v_fma_f32 v59, v59, v53, v53
  v_fma_f32 v60, v60, v53, v53
  v_mfma_f32_16x16x32_bf16 a[204:207], a[36:39], a[80:83], a[204:207]
  buffer_load_dwordx4 a[24:27], v2, s[8:11], s20 offen offset:0
  v_mfma_f32_16x16x32_bf16 a[208:211], a[36:39], a[84:87], a[208:211]
  ds_read_b128 a[64:67], v7 offset:10240
  v_fma_f32 v61, v61, v53, v53
  v_rcp_f32 v58, v58
  v_mfma_f32_16x16x32_bf16 a[212:215], a[36:39], a[88:91], a[212:215]
  buffer_load_dwordx4 a[28:31], v2, s[8:11], s20 offen offset:1024
  v_mfma_f32_16x16x32_bf16 a[216:219], a[40:43], a[76:79], a[216:219]
  ds_read_b128 a[68:71], v7 offset:12288
  v_rcp_f32 v59, v59
  v_mfma_f32_16x16x32_bf16 a[220:223], a[40:43], a[80:83], a[220:223]
  buffer_load_dwordx4 a[32:35], v2, s[8:11], s20 offen offset:2048
  v_mfma_f32_16x16x32_bf16 a[224:227], a[40:43], a[84:87], a[224:227]
  ds_read_b128 a[72:75], v7 offset:14336
  v_rcp_f32 v60, v60
  v_mfma_f32_16x16x32_bf16 a[228:231], a[40:43], a[88:91], a[228:231]
  s_add_u32 s20, s20, 3072
  v_rcp_f32 v61, v61
  v_mfma_f32_16x16x32_bf16 a[232:235], a[44:47], a[76:79], a[232:235]
  v_mul_f32 v54, v54, v58
  v_mul_f32 v55, v55, v59
  v_mfma_f32_16x16x32_bf16 a[236:239], a[44:47], a[80:83], a[236:239]
  v_mul_f32 v56, v56, v60
  v_mul_f32 v57, v57, v61
  v_cvt_pk_bf16_f32 v62, v54, v55
  v_mfma_f32_16x16x32_bf16 a[240:243], a[44:47], a[84:87], a[240:243]
  v_cvt_pk_bf16_f32 v63, v56, v57
  ds_write_b64 v13, v[62:63] offset:24576
  v_mfma_f32_16x16x32_bf16 a[244:247], a[44:47], a[88:91], a[244:247]
  v_fma_f32 v54, v164, v19, v30
  v_fma_f32 v55, v165, v19, v31
  v_fma_f32 v56, v166, v19, v32
  s_waitcnt vmcnt(21) lgkmcnt(1)
  v_mfma_f32_16x16x32_bf16 a[104:107], a[48:51], a[60:63], a[104:107]
  buffer_load_dwordx4 a[36:39], v2, s[8:11], s20 offen offset:0
  v_mfma_f32_16x16x32_bf16 a[108:111], a[48:51], a[64:67], a[108:111]
  v_fma_f32 v57, v167, v19, v33
  v_fma_f32 v58, v54, v54, v52
  v_fma_f32 v59, v55, v55, v52
  v_mfma_f32_16x16x32_bf16 a[112:115], a[48:51], a[68:71], a[112:115]
  buffer_load_dwordx4 a[40:43], v2, s[8:11], s20 offen offset:1024
  v_mfma_f32_16x16x32_bf16 a[116:119], a[48:51], a[72:75], a[116:119]
  v_fma_f32 v60, v56, v56, v52
  v_fma_f32 v61, v57, v57, v52
  v_mfma_f32_16x16x32_bf16 a[120:123], a[52:55], a[60:63], a[120:123]
  buffer_load_dwordx4 a[44:47], v2, s[8:11], s20 offen offset:2048
  v_mfma_f32_16x16x32_bf16 a[124:127], a[52:55], a[64:67], a[124:127]
  v_mul_f32 v58, v54, v58
  v_mul_f32 v59, v55, v59
  v_mul_f32 v60, v56, v60
  v_mfma_f32_16x16x32_bf16 a[128:131], a[52:55], a[68:71], a[128:131]
  s_add_u32 s20, s20, 3072
  v_mul_f32 v61, v57, v61
  v_mfma_f32_16x16x32_bf16 a[132:135], a[52:55], a[72:75], a[132:135]
  v_exp_f32_e64 v58, -v58
  v_mfma_f32_16x16x32_bf16 a[136:139], a[56:59], a[60:63], a[136:139]
  v_exp_f32_e64 v59, -v59
  v_mfma_f32_16x16x32_bf16 a[140:143], a[56:59], a[64:67], a[140:143]
  v_exp_f32_e64 v60, -v60
  v_mfma_f32_16x16x32_bf16 a[144:147], a[56:59], a[68:71], a[144:147]
  v_exp_f32_e64 v61, -v61
  v_fma_f32 v58, v58, v53, v53
  v_mfma_f32_16x16x32_bf16 a[148:151], a[56:59], a[72:75], a[148:151]
  v_fma_f32 v59, v59, v53, v53
  v_fma_f32 v60, v60, v53, v53
  s_waitcnt vmcnt(21)
  v_mfma_f32_16x16x32_bf16 a[152:155], v[80:83], a[60:63], a[152:155]
  buffer_load_dwordx4 a[48:51], v2, s[8:11], s20 offen offset:0
  v_mfma_f32_16x16x32_bf16 a[156:159], v[80:83], a[64:67], a[156:159]
  v_fma_f32 v61, v61, v53, v53
  v_rcp_f32 v58, v58
  v_mfma_f32_16x16x32_bf16 a[160:163], v[80:83], a[68:71], a[160:163]
  buffer_load_dwordx4 a[52:55], v2, s[8:11], s20 offen offset:1024
  v_mfma_f32_16x16x32_bf16 a[164:167], v[80:83], a[72:75], a[164:167]
  v_rcp_f32 v59, v59
  v_mfma_f32_16x16x32_bf16 a[168:171], v[84:87], a[60:63], a[168:171]
  buffer_load_dwordx4 a[56:59], v2, s[8:11], s20 offen offset:2048
  v_mfma_f32_16x16x32_bf16 a[172:175], v[84:87], a[64:67], a[172:175]
  v_rcp_f32 v60, v60
  v_rcp_f32 v61, v61
  v_mfma_f32_16x16x32_bf16 a[176:179], v[84:87], a[68:71], a[176:179]
  s_add_u32 s20, s20, 3072
  v_mul_f32 v54, v54, v58
  v_mfma_f32_16x16x32_bf16 a[180:183], v[84:87], a[72:75], a[180:183]
  v_mul_f32 v55, v55, v59
  v_mul_f32 v56, v56, v60
  v_mfma_f32_16x16x32_bf16 a[184:187], v[88:91], a[60:63], a[184:187]
  v_mul_f32 v57, v57, v61
  v_cvt_pk_bf16_f32 v64, v54, v55
  v_mfma_f32_16x16x32_bf16 a[188:191], v[88:91], a[64:67], a[188:191]
  v_cvt_pk_bf16_f32 v65, v56, v57
  ds_write_b64 v13, v[64:65] offset:26624
  v_mfma_f32_16x16x32_bf16 a[192:195], v[88:91], a[68:71], a[192:195]
  v_fma_f32 v54, v168, v20, v30
  v_fma_f32 v55, v169, v20, v31
  v_fma_f32 v56, v170, v20, v32
  v_mfma_f32_16x16x32_bf16 a[196:199], v[88:91], a[72:75], a[196:199]
  v_fma_f32 v57, v171, v20, v33
  v_fma_f32 v58, v54, v54, v52
  s_waitcnt vmcnt(21)
  v_mfma_f32_16x16x32_bf16 a[200:203], v[92:95], a[60:63], a[200:203]
  ds_read_b128 a[76:79], v8 offset:8192
  v_fma_f32 v59, v55, v55, v52
  v_fma_f32 v60, v56, v56, v52
  v_mfma_f32_16x16x32_bf16 a[204:207], v[92:95], a[64:67], a[204:207]
  buffer_load_dwordx4 v[80:83], v2, s[8:11], s20 offen offset:0
  v_fma_f32 v61, v57, v57, v52
  v_mfma_f32_16x16x32_bf16 a[208:211], v[92:95], a[68:71], a[208:211]
  ds_read_b128 a[80:83], v8 offset:10240
  v_mul_f32 v58, v54, v58
  v_mul_f32 v59, v55, v59
  v_mfma_f32_16x16x32_bf16 a[212:215], v[92:95], a[72:75], a[212:215]
  buffer_load_dwordx4 v[84:87], v2, s[8:11], s20 offen offset:1024
  v_mfma_f32_16x16x32_bf16 a[216:219], v[96:99], a[60:63], a[216:219]
  ds_read_b128 a[84:87], v8 offset:12288
  v_mul_f32 v60, v56, v60
  v_mul_f32 v61, v57, v61
  v_mfma_f32_16x16x32_bf16 a[220:223], v[96:99], a[64:67], a[220:223]
  buffer_load_dwordx4 v[88:91], v2, s[8:11], s20 offen offset:2048
  v_exp_f32_e64 v58, -v58
  v_mfma_f32_16x16x32_bf16 a[224:227], v[96:99], a[68:71], a[224:227]
  ds_read_b128 a[88:91], v8 offset:14336
  v_mfma_f32_16x16x32_bf16 a[228:231], v[96:99], a[72:75], a[228:231]
  s_add_u32 s20, s20, 3072
  v_exp_f32_e64 v59, -v59
  v_mfma_f32_16x16x32_bf16 a[232:235], v[100:103], a[60:63], a[232:235]
  v_exp_f32_e64 v60, -v60
  v_exp_f32_e64 v61, -v61
  v_mfma_f32_16x16x32_bf16 a[236:239], v[100:103], a[64:67], a[236:239]
  v_fma_f32 v58, v58, v53, v53
  v_fma_f32 v59, v59, v53, v53
  v_mfma_f32_16x16x32_bf16 a[240:243], v[100:103], a[68:71], a[240:243]
  v_fma_f32 v60, v60, v53, v53
  v_fma_f32 v61, v61, v53, v53
  v_rcp_f32 v58, v58
  v_mfma_f32_16x16x32_bf16 a[244:247], v[100:103], a[72:75], a[244:247]
  v_rcp_f32 v59, v59
  s_waitcnt vmcnt(21) lgkmcnt(0)
  v_mfma_f32_16x16x32_bf16 a[104:107], v[104:107], a[76:79], a[104:107]
  buffer_load_dwordx4 v[92:95], v2, s[8:11], s20 offen offset:0
  v_mfma_f32_16x16x32_bf16 a[108:111], v[104:107], a[80:83], a[108:111]
  v_rcp_f32 v60, v60
  v_mfma_f32_16x16x32_bf16 a[112:115], v[104:107], a[84:87], a[112:115]
  buffer_load_dwordx4 v[96:99], v2, s[8:11], s20 offen offset:1024
  v_mfma_f32_16x16x32_bf16 a[116:119], v[104:107], a[88:91], a[116:119]
  v_rcp_f32 v61, v61
  v_mul_f32 v54, v54, v58
  v_mfma_f32_16x16x32_bf16 a[120:123], v[108:111], a[76:79], a[120:123]
  buffer_load_dwordx4 v[100:103], v2, s[8:11], s20 offen offset:2048
  v_mfma_f32_16x16x32_bf16 a[124:127], v[108:111], a[80:83], a[124:127]
  v_mul_f32 v55, v55, v59
  v_mul_f32 v56, v56, v60
  v_mfma_f32_16x16x32_bf16 a[128:131], v[108:111], a[84:87], a[128:131]
  s_add_u32 s20, s20, 3072
  v_mul_f32 v57, v57, v61
  v_mfma_f32_16x16x32_bf16 a[132:135], v[108:111], a[88:91], a[132:135]
  v_cvt_pk_bf16_f32 v62, v54, v55
  v_cvt_pk_bf16_f32 v63, v56, v57
  v_mfma_f32_16x16x32_bf16 a[136:139], v[112:115], a[76:79], a[136:139]
  ds_write_b64 v13, v[62:63] offset:28672
  v_fma_f32 v54, v172, v21, v30
  v_mfma_f32_16x16x32_bf16 a[140:143], v[112:115], a[80:83], a[140:143]
  v_fma_f32 v55, v173, v21, v31
  v_fma_f32 v56, v174, v21, v32
  v_fma_f32 v57, v175, v21, v33
  v_mfma_f32_16x16x32_bf16 a[144:147], v[112:115], a[84:87], a[144:147]
  v_fma_f32 v58, v54, v54, v52
  v_fma_f32 v59, v55, v55, v52
  v_mfma_f32_16x16x32_bf16 a[148:151], v[112:115], a[88:91], a[148:151]
  v_fma_f32 v60, v56, v56, v52
  v_fma_f32 v61, v57, v57, v52
  s_waitcnt vmcnt(21)
  v_mfma_f32_16x16x32_bf16 a[152:155], v[116:119], a[76:79], a[152:155]
  buffer_load_dwordx4 v[104:107], v2, s[8:11], s20 offen offset:0
  v_mul_f32 v58, v54, v58
  v_mfma_f32_16x16x32_bf16 a[156:159], v[116:119], a[80:83], a[156:159]
  v_mul_f32 v59, v55, v59
  v_mul_f32 v60, v56, v60
  v_mfma_f32_16x16x32_bf16 a[160:163], v[116:119], a[84:87], a[160:163]
  buffer_load_dwordx4 v[108:111], v2, s[8:11], s20 offen offset:1024
  v_mul_f32 v61, v57, v61
  v_mfma_f32_16x16x32_bf16 a[164:167], v[116:119], a[88:91], a[164:167]
  v_exp_f32_e64 v58, -v58
  v_mfma_f32_16x16x32_bf16 a[168:171], v[120:123], a[76:79], a[168:171]
  buffer_load_dwordx4 v[112:115], v2, s[8:11], s20 offen offset:2048
  v_exp_f32_e64 v59, -v59
  v_mfma_f32_16x16x32_bf16 a[172:175], v[120:123], a[80:83], a[172:175]
  v_exp_f32_e64 v60, -v60
  v_mfma_f32_16x16x32_bf16 a[176:179], v[120:123], a[84:87], a[176:179]
  s_add_u32 s20, s20, 3072
  v_exp_f32_e64 v61, -v61
  v_mfma_f32_16x16x32_bf16 a[180:183], v[120:123], a[88:91], a[180:183]
  v_fma_f32 v58, v58, v53, v53
  v_fma_f32 v59, v59, v53, v53
  v_mfma_f32_16x16x32_bf16 a[184:187], v[124:127], a[76:79], a[184:187]
  v_fma_f32 v60, v60, v53, v53
  v_fma_f32 v61, v61, v53, v53
  v_rcp_f32 v58, v58
  v_mfma_f32_16x16x32_bf16 a[188:191], v[124:127], a[80:83], a[188:191]
  v_rcp_f32 v59, v59
  v_mfma_f32_16x16x32_bf16 a[192:195], v[124:127], a[84:87], a[192:195]
  v_rcp_f32 v60, v60
  v_mfma_f32_16x16x32_bf16 a[196:199], v[124:127], a[88:91], a[196:199]
  v_rcp_f32 v61, v61
  v_mul_f32 v54, v54, v58
  s_waitcnt vmcnt(21)
  v_mfma_f32_16x16x32_bf16 a[200:203], a[0:3], a[76:79], a[200:203]
  ds_read_b128 a[60:63], v7 offset:16384
  v_mul_f32 v55, v55, v59
  v_mfma_f32_16x16x32_bf16 a[204:207], a[0:3], a[80:83], a[204:207]
  buffer_load_dwordx4 v[116:119], v2, s[8:11], s20 offen offset:0
  v_mul_f32 v56, v56, v60
  v_mfma_f32_16x16x32_bf16 a[208:211], a[0:3], a[84:87], a[208:211]
  ds_read_b128 a[64:67], v7 offset:18432
  v_mul_f32 v57, v57, v61
  v_mfma_f32_16x16x32_bf16 a[212:215], a[0:3], a[88:91], a[212:215]
  buffer_load_dwordx4 v[120:123], v2, s[8:11], s20 offen offset:1024
  v_mfma_f32_16x16x32_bf16 a[216:219], a[4:7], a[76:79], a[216:219]
  ds_read_b128 a[68:71], v7 offset:20480
  v_cvt_pk_bf16_f32 v64, v54, v55
  v_mfma_f32_16x16x32_bf16 a[220:223], a[4:7], a[80:83], a[220:223]
  buffer_load_dwordx4 v[124:127], v2, s[8:11], s20 offen offset:2048
  v_cvt_pk_bf16_f32 v65, v56, v57
  v_mfma_f32_16x16x32_bf16 a[224:227], a[4:7], a[84:87], a[224:227]
  ds_read_b128 a[72:75], v7 offset:22528
  ds_write_b64 v13, v[64:65] offset:30720
  v_mfma_f32_16x16x32_bf16 a[228:231], a[4:7], a[88:91], a[228:231]
  s_add_u32 s20, s20, 3072
  v_mfma_f32_16x16x32_bf16 a[232:235], a[8:11], a[76:79], a[232:235]
  v_lshlrev_b32 v22, 16, v46
  v_and_b32 v23, 0xffff0000, v46
  v_mfma_f32_16x16x32_bf16 a[236:239], a[8:11], a[80:83], a[236:239]
  v_lshlrev_b32 v24, 16, v47
  v_and_b32 v25, 0xffff0000, v47
  v_mfma_f32_16x16x32_bf16 a[240:243], a[8:11], a[84:87], a[240:243]
  v_mul_f32 v22, v53, v22
  v_mul_f32 v23, v53, v23
  v_mul_f32 v24, v53, v24
  v_mfma_f32_16x16x32_bf16 a[244:247], a[8:11], a[88:91], a[244:247]
  v_mul_f32 v25, v53, v25
  v_lshlrev_b32 v26, 16, v48
  s_waitcnt vmcnt(21) lgkmcnt(1)
  v_mfma_f32_16x16x32_bf16 a[104:107], a[12:15], a[60:63], a[104:107]
  buffer_load_dwordx4 a[0:3], v2, s[8:11], s20 offen offset:0
  v_mfma_f32_16x16x32_bf16 a[108:111], a[12:15], a[64:67], a[108:111]
  v_and_b32 v27, 0xffff0000, v48
  v_lshlrev_b32 v28, 16, v49
  v_mfma_f32_16x16x32_bf16 a[112:115], a[12:15], a[68:71], a[112:115]
  buffer_load_dwordx4 a[4:7], v2, s[8:11], s20 offen offset:1024
  v_mfma_f32_16x16x32_bf16 a[116:119], a[12:15], a[72:75], a[116:119]
  v_and_b32 v29, 0xffff0000, v49
  v_mul_f32 v26, v53, v26
  v_mfma_f32_16x16x32_bf16 a[120:123], a[16:19], a[60:63], a[120:123]
  buffer_load_dwordx4 a[8:11], v2, s[8:11], s20 offen offset:2048
  v_mfma_f32_16x16x32_bf16 a[124:127], a[16:19], a[64:67], a[124:127]
  v_mul_f32 v27, v53, v27
  v_mul_f32 v28, v53, v28
  v_mfma_f32_16x16x32_bf16 a[128:131], a[16:19], a[68:71], a[128:131]
  s_add_u32 s20, s20, 3072
  v_mul_f32 v29, v53, v29
  v_mfma_f32_16x16x32_bf16 a[132:135], a[16:19], a[72:75], a[132:135]
  v_lshlrev_b32 v30, 16, v50
  v_and_b32 v31, 0xffff0000, v50
  v_mfma_f32_16x16x32_bf16 a[136:139], a[20:23], a[60:63], a[136:139]
  v_lshlrev_b32 v32, 16, v51
  v_and_b32 v33, 0xffff0000, v51
  v_mfma_f32_16x16x32_bf16 a[140:143], a[20:23], a[64:67], a[140:143]
  v_mul_f32 v30, v53, v30
  v_mul_f32 v31, v53, v31
  v_mfma_f32_16x16x32_bf16 a[144:147], a[20:23], a[68:71], a[144:147]
  v_mul_f32 v32, v53, v32
  v_mul_f32 v33, v53, v33
  v_mfma_f32_16x16x32_bf16 a[148:151], a[20:23], a[72:75], a[148:151]
  v_fma_f32 v54, v176, v18, v22
  v_fma_f32 v55, v177, v18, v23
  s_waitcnt vmcnt(21)
  v_mfma_f32_16x16x32_bf16 a[152:155], a[24:27], a[60:63], a[152:155]
  buffer_load_dwordx4 a[12:15], v2, s[8:11], s20 offen offset:0
  v_fma_f32 v56, v178, v18, v24
  v_mfma_f32_16x16x32_bf16 a[156:159], a[24:27], a[64:67], a[156:159]
  buffer_load_dwordx4 a[16:19], v2, s[8:11], s20 offen offset:1024
  v_fma_f32 v57, v179, v18, v25
  v_mfma_f32_16x16x32_bf16 a[160:163], a[24:27], a[68:71], a[160:163]
  buffer_load_dwordx4 a[20:23], v2, s[8:11], s20 offen offset:2048
  v_fma_f32 v58, v54, v54, v52
  v_mfma_f32_16x16x32_bf16 a[164:167], a[24:27], a[72:75], a[164:167]
  s_add_u32 s20, s20, 3072
  v_fma_f32 v59, v55, v55, v52
  v_fma_f32 v60, v56, v56, v52
  v_mfma_f32_16x16x32_bf16 a[168:171], a[28:31], a[60:63], a[168:171]
  buffer_load_dwordx4 v[128:131], v2, s[8:11], s20 offen offset:0
  v_fma_f32 v61, v57, v57, v52
  v_mfma_f32_16x16x32_bf16 a[172:175], a[28:31], a[64:67], a[172:175]
  buffer_load_dwordx4 v[132:135], v2, s[8:11], s20 offen offset:1024
  v_mul_f32 v58, v54, v58
  v_mfma_f32_16x16x32_bf16 a[176:179], a[28:31], a[68:71], a[176:179]
  buffer_load_dwordx4 v[136:139], v2, s[8:11], s20 offen offset:2048
  v_mfma_f32_16x16x32_bf16 a[180:183], a[28:31], a[72:75], a[180:183]
  s_add_u32 s20, s20, 3072
  v_mul_f32 v59, v55, v59
  v_mul_f32 v60, v56, v60
  v_mfma_f32_16x16x32_bf16 a[184:187], a[32:35], a[60:63], a[184:187]
  v_mul_f32 v61, v57, v61
  v_exp_f32_e64 v58, -v58
  v_mfma_f32_16x16x32_bf16 a[188:191], a[32:35], a[64:67], a[188:191]
  v_exp_f32_e64 v59, -v59
  v_exp_f32_e64 v60, -v60
  v_mfma_f32_16x16x32_bf16 a[192:195], a[32:35], a[68:71], a[192:195]
  v_exp_f32_e64 v61, -v61
  v_mfma_f32_16x16x32_bf16 a[196:199], a[32:35], a[72:75], a[196:199]
  v_fma_f32 v58, v58, v53, v53
  v_fma_f32 v59, v59, v53, v53
  v_fma_f32 v60, v60, v53, v53
  s_waitcnt vmcnt(24)
  v_mfma_f32_16x16x32_bf16 a[200:203], a[36:39], a[60:63], a[200:203]
  ds_read_b128 a[76:79], v8 offset:16384
  buffer_load_dwordx4 a[24:27], v2, s[8:11], s20 offen offset:0
  v_mfma_f32_16x16x32_bf16 a[204:207], a[36:39], a[64:67], a[204:207]
  ds_read_b128 a[80:83], v8 offset:18432
  v_fma_f32 v61, v61, v53, v53
  v_rcp_f32 v58, v58
  v_mfma_f32_16x16x32_bf16 a[208:211], a[36:39], a[68:71], a[208:211]
  buffer_load_dwordx4 a[28:31], v2, s[8:11], s20 offen offset:1024
  v_mfma_f32_16x16x32_bf16 a[212:215], a[36:39], a[72:75], a[212:215]
  ds_read_b128 a[84:87], v8 offset:20480
  v_rcp_f32 v59, v59
  v_rcp_f32 v60, v60
  v_mfma_f32_16x16x32_bf16 a[216:219], a[40:43], a[60:63], a[216:219]
  buffer_load_dwordx4 a[32:35], v2, s[8:11], s20 offen offset:2048
  v_mfma_f32_16x16x32_bf16 a[220:223], a[40:43], a[64:67], a[220:223]
  ds_read_b128 a[88:91], v8 offset:22528
  s_add_u32 s20, s20, 3072
  v_rcp_f32 v61, v61
  v_mfma_f32_16x16x32_bf16 a[224:227], a[40:43], a[68:71], a[224:227]
  buffer_load_dwordx4 v[140:143], v2, s[8:11], s20 offen offset:0
  v_mul_f32 v54, v54, v58
  v_mfma_f32_16x16x32_bf16 a[228:231], a[40:43], a[72:75], a[228:231]
  buffer_load_dwordx4 v[144:147], v2, s[8:11], s20 offen offset:1024
  v_mul_f32 v55, v55, v59
  v_mfma_f32_16x16x32_bf16 a[232:235], a[44:47], a[60:63], a[232:235]
  buffer_load_dwordx4 v[148:151], v2, s[8:11], s20 offen offset:2048
  v_mul_f32 v56, v56, v60
  v_mul_f32 v57, v57, v61
  v_mfma_f32_16x16x32_bf16 a[236:239], a[44:47], a[64:67], a[236:239]
  s_add_u32 s20, s20, 3072
  v_cvt_pk_bf16_f32 v62, v54, v55
  v_cvt_pk_bf16_f32 v63, v56, v57
  v_mfma_f32_16x16x32_bf16 a[240:243], a[44:47], a[68:71], a[240:243]
  ds_write_b64 v11, v[62:63] offset:49152
  v_fma_f32 v54, v180, v19, v22
  v_fma_f32 v55, v181, v19, v23
  v_mfma_f32_16x16x32_bf16 a[244:247], a[44:47], a[72:75], a[244:247]
  v_fma_f32 v56, v182, v19, v24
  v_fma_f32 v57, v183, v19, v25
  v_fma_f32 v58, v54, v54, v52
  s_waitcnt vmcnt(27) lgkmcnt(1)
  v_mfma_f32_16x16x32_bf16 a[104:107], a[48:51], a[76:79], a[104:107]
  buffer_load_dwordx4 a[36:39], v2, s[8:11], s20 offen offset:0
  v_fma_f32 v59, v55, v55, v52
  v_mfma_f32_16x16x32_bf16 a[108:111], a[48:51], a[80:83], a[108:111]
  buffer_load_dwordx4 a[40:43], v2, s[8:11], s20 offen offset:1024
  v_fma_f32 v60, v56, v56, v52
  v_mfma_f32_16x16x32_bf16 a[112:115], a[48:51], a[84:87], a[112:115]
  buffer_load_dwordx4 a[44:47], v2, s[8:11], s20 offen offset:2048
  v_fma_f32 v61, v57, v57, v52
  v_mfma_f32_16x16x32_bf16 a[116:119], a[48:51], a[88:91], a[116:119]
  s_add_u32 s20, s20, 3072
  v_mul_f32 v58, v54, v58
  v_mul_f32 v59, v55, v59
  v_mfma_f32_16x16x32_bf16 a[120:123], a[52:55], a[76:79], a[120:123]
  buffer_load_dwordx4 v[152:155], v2, s[8:11], s20 offen offset:0
  v_mul_f32 v60, v56, v60
  v_mfma_f32_16x16x32_bf16 a[124:127], a[52:55], a[80:83], a[124:127]
  buffer_load_dwordx4 v[156:159], v2, s[8:11], s20 offen offset:1024
  v_mul_f32 v61, v57, v61
  v_mfma_f32_16x16x32_bf16 a[128:131], a[52:55], a[84:87], a[128:131]
  buffer_load_dwordx4 v[160:163], v2, s[8:11], s20 offen offset:2048
  v_exp_f32_e64 v58, -v58
  v_mfma_f32_16x16x32_bf16 a[132:135], a[52:55], a[88:91], a[132:135]
  s_add_u32 s20, s20, 3072
  v_exp_f32_e64 v59, -v59
  v_mfma_f32_16x16x32_bf16 a[136:139], a[56:59], a[76:79], a[136:139]
  v_exp_f32_e64 v60, -v60
  v_mfma_f32_16x16x32_bf16 a[140:143], a[56:59], a[80:83], a[140:143]
  v_exp_f32_e64 v61, -v61
  v_fma_f32 v58, v58, v53, v53
  v_fma_f32 v59, v59, v53, v53
  v_mfma_f32_16x16x32_bf16 a[144:147], a[56:59], a[84:87], a[144:147]
  v_fma_f32 v60, v60, v53, v53
  v_fma_f32 v61, v61, v53, v53
  v_mfma_f32_16x16x32_bf16 a[148:151], a[56:59], a[88:91], a[148:151]
  v_rcp_f32 v58, v58
  v_rcp_f32 v59, v59
  s_waitcnt vmcnt(30)
  v_mfma_f32_16x16x32_bf16 a[152:155], v[80:83], a[76:79], a[152:155]
  buffer_load_dwordx4 a[48:51], v2, s[8:11], s20 offen offset:0
  v_mfma_f32_16x16x32_bf16 a[156:159], v[80:83], a[80:83], a[156:159]
  v_rcp_f32 v60, v60
  v_mfma_f32_16x16x32_bf16 a[160:163], v[80:83], a[84:87], a[160:163]
  buffer_load_dwordx4 a[52:55], v2, s[8:11], s20 offen offset:1024
  v_mfma_f32_16x16x32_bf16 a[164:167], v[80:83], a[88:91], a[164:167]
  v_rcp_f32 v61, v61
  v_mul_f32 v54, v54, v58
  v_mfma_f32_16x16x32_bf16 a[168:171], v[84:87], a[76:79], a[168:171]
  buffer_load_dwordx4 a[56:59], v2, s[8:11], s20 offen offset:2048
  v_mfma_f32_16x16x32_bf16 a[172:175], v[84:87], a[80:83], a[172:175]
  v_mul_f32 v55, v55, v59
  v_mul_f32 v56, v56, v60
  v_mfma_f32_16x16x32_bf16 a[176:179], v[84:87], a[84:87], a[176:179]
  s_add_u32 s20, s20, 3072
  v_mul_f32 v57, v57, v61
  v_mfma_f32_16x16x32_bf16 a[180:183], v[84:87], a[88:91], a[180:183]
  v_cvt_pk_bf16_f32 v64, v54, v55
  v_cvt_pk_bf16_f32 v65, v56, v57
  v_mfma_f32_16x16x32_bf16 a[184:187], v[88:91], a[76:79], a[184:187]
  ds_write_b64 v11, v[64:65] offset:51200
  v_fma_f32 v54, v184, v20, v22
  v_mfma_f32_16x16x32_bf16 a[188:191], v[88:91], a[80:83], a[188:191]
  v_fma_f32 v55, v185, v20, v23
  v_fma_f32 v56, v186, v20, v24
  v_mfma_f32_16x16x32_bf16 a[192:195], v[88:91], a[84:87], a[192:195]
  v_fma_f32 v57, v187, v20, v25
  v_fma_f32 v58, v54, v54, v52
  v_mfma_f32_16x16x32_bf16 a[196:199], v[88:91], a[88:91], a[196:199]
  v_fma_f32 v59, v55, v55, v52
  v_fma_f32 v60, v56, v56, v52
  s_waitcnt vmcnt(30) lgkmcnt(0)
  s_barrier
  v_mfma_f32_16x16x32_bf16 a[200:203], v[92:95], a[76:79], a[200:203]
  ds_read_b128 a[60:63], v7 offset:24576
  v_fma_f32 v61, v57, v57, v52
  v_mul_f32 v58, v54, v58
  v_mfma_f32_16x16x32_bf16 a[204:207], v[92:95], a[80:83], a[204:207]
  buffer_load_dwordx4 v[80:83], v2, s[8:11], s20 offen offset:0
  v_mul_f32 v59, v55, v59
  v_mfma_f32_16x16x32_bf16 a[208:211], v[92:95], a[84:87], a[208:211]
  ds_read_b128 a[64:67], v7 offset:26624
  v_mul_f32 v60, v56, v60
  v_mul_f32 v61, v57, v61
  v_mfma_f32_16x16x32_bf16 a[212:215], v[92:95], a[88:91], a[212:215]
  buffer_load_dwordx4 v[84:87], v2, s[8:11], s20 offen offset:1024
  v_exp_f32_e64 v58, -v58
  v_mfma_f32_16x16x32_bf16 a[216:219], v[96:99], a[76:79], a[216:219]
  ds_read_b128 a[68:71], v7 offset:28672
  v_exp_f32_e64 v59, -v59
  v_mfma_f32_16x16x32_bf16 a[220:223], v[96:99], a[80:83], a[220:223]
  buffer_load_dwordx4 v[88:91], v2, s[8:11], s20 offen offset:2048
  v_mfma_f32_16x16x32_bf16 a[224:227], v[96:99], a[84:87], a[224:227]
  ds_read_b128 a[72:75], v7 offset:30720
  v_exp_f32_e64 v60, -v60
  v_mfma_f32_16x16x32_bf16 a[228:231], v[96:99], a[88:91], a[228:231]
  s_add_u32 s20, s20, 3072
  v_exp_f32_e64 v61, -v61
  v_mfma_f32_16x16x32_bf16 a[232:235], v[100:103], a[76:79], a[232:235]
  v_fma_f32 v58, v58, v53, v53
  v_fma_f32 v59, v59, v53, v53
  v_fma_f32 v60, v60, v53, v53
  v_mfma_f32_16x16x32_bf16 a[236:239], v[100:103], a[80:83], a[236:239]
  v_fma_f32 v61, v61, v53, v53
  v_rcp_f32 v58, v58
  v_mfma_f32_16x16x32_bf16 a[240:243], v[100:103], a[84:87], a[240:243]
  v_rcp_f32 v59, v59
  v_rcp_f32 v60, v60
  v_mfma_f32_16x16x32_bf16 a[244:247], v[100:103], a[88:91], a[244:247]
  v_rcp_f32 v61, v61
  s_waitcnt vmcnt(30) lgkmcnt(0)
  v_mfma_f32_16x16x32_bf16 a[104:107], v[104:107], a[60:63], a[104:107]
  buffer_load_dwordx4 v[92:95], v2, s[8:11], s20 offen offset:0
  v_mfma_f32_16x16x32_bf16 a[108:111], v[104:107], a[64:67], a[108:111]
  v_mul_f32 v54, v54, v58
  v_mul_f32 v55, v55, v59
  v_mfma_f32_16x16x32_bf16 a[112:115], v[104:107], a[68:71], a[112:115]
  buffer_load_dwordx4 v[96:99], v2, s[8:11], s20 offen offset:1024
  v_mfma_f32_16x16x32_bf16 a[116:119], v[104:107], a[72:75], a[116:119]
  v_mul_f32 v56, v56, v60
  v_mul_f32 v57, v57, v61
  v_mfma_f32_16x16x32_bf16 a[120:123], v[108:111], a[60:63], a[120:123]
  buffer_load_dwordx4 v[100:103], v2, s[8:11], s20 offen offset:2048
  v_mfma_f32_16x16x32_bf16 a[124:127], v[108:111], a[64:67], a[124:127]
  v_cvt_pk_bf16_f32 v62, v54, v55
  v_cvt_pk_bf16_f32 v63, v56, v57
  v_mfma_f32_16x16x32_bf16 a[128:131], v[108:111], a[68:71], a[128:131]
  s_add_u32 s20, s20, 3072
  ds_write_b64 v11, v[62:63] offset:53248
  v_mfma_f32_16x16x32_bf16 a[132:135], v[108:111], a[72:75], a[132:135]
  v_fma_f32 v54, v188, v21, v22
  v_fma_f32 v55, v189, v21, v23
  v_mfma_f32_16x16x32_bf16 a[136:139], v[112:115], a[60:63], a[136:139]
  v_fma_f32 v56, v190, v21, v24
  v_fma_f32 v57, v191, v21, v25
  v_mfma_f32_16x16x32_bf16 a[140:143], v[112:115], a[64:67], a[140:143]
  v_fma_f32 v58, v54, v54, v52
  v_fma_f32 v59, v55, v55, v52
  v_mfma_f32_16x16x32_bf16 a[144:147], v[112:115], a[68:71], a[144:147]
  v_fma_f32 v60, v56, v56, v52
  v_fma_f32 v61, v57, v57, v52
  v_mfma_f32_16x16x32_bf16 a[148:151], v[112:115], a[72:75], a[148:151]
  v_mul_f32 v58, v54, v58
  v_mul_f32 v59, v55, v59
  s_waitcnt vmcnt(30)
  v_mfma_f32_16x16x32_bf16 a[152:155], v[116:119], a[60:63], a[152:155]
  buffer_load_dwordx4 v[104:107], v2, s[8:11], s20 offen offset:0
  v_mul_f32 v60, v56, v60
  v_mfma_f32_16x16x32_bf16 a[156:159], v[116:119], a[64:67], a[156:159]
  v_mul_f32 v61, v57, v61
  v_exp_f32_e64 v58, -v58
  v_mfma_f32_16x16x32_bf16 a[160:163], v[116:119], a[68:71], a[160:163]
  buffer_load_dwordx4 v[108:111], v2, s[8:11], s20 offen offset:1024
  v_mfma_f32_16x16x32_bf16 a[164:167], v[116:119], a[72:75], a[164:167]
  v_exp_f32_e64 v59, -v59
  v_mfma_f32_16x16x32_bf16 a[168:171], v[120:123], a[60:63], a[168:171]
  buffer_load_dwordx4 v[112:115], v2, s[8:11], s20 offen offset:2048
  v_exp_f32_e64 v60, -v60
  v_mfma_f32_16x16x32_bf16 a[172:175], v[120:123], a[64:67], a[172:175]
  v_exp_f32_e64 v61, -v61
  v_mfma_f32_16x16x32_bf16 a[176:179], v[120:123], a[68:71], a[176:179]
  s_add_u32 s20, s20, 3072
  v_fma_f32 v58, v58, v53, v53
  v_fma_f32 v59, v59, v53, v53
  v_mfma_f32_16x16x32_bf16 a[180:183], v[120:123], a[72:75], a[180:183]
  v_fma_f32 v60, v60, v53, v53
  v_fma_f32 v61, v61, v53, v53
  v_mfma_f32_16x16x32_bf16 a[184:187], v[124:127], a[60:63], a[184:187]
  v_rcp_f32 v58, v58
  v_rcp_f32 v59, v59
  v_mfma_f32_16x16x32_bf16 a[188:191], v[124:127], a[64:67], a[188:191]
  v_rcp_f32 v60, v60
  v_mfma_f32_16x16x32_bf16 a[192:195], v[124:127], a[68:71], a[192:195]
  v_rcp_f32 v61, v61
  v_mfma_f32_16x16x32_bf16 a[196:199], v[124:127], a[72:75], a[196:199]
  v_mul_f32 v54, v54, v58
  v_mul_f32 v55, v55, v59
  v_mul_f32 v56, v56, v60
  s_waitcnt vmcnt(30)
  v_mfma_f32_16x16x32_bf16 a[200:203], a[0:3], a[60:63], a[200:203]
  ds_read_b128 a[76:79], v8 offset:24576
  v_mul_f32 v57, v57, v61
  v_mfma_f32_16x16x32_bf16 a[204:207], a[0:3], a[64:67], a[204:207]
  buffer_load_dwordx4 v[116:119], v2, s[8:11], s20 offen offset:0
  v_cvt_pk_bf16_f32 v64, v54, v55
  v_mfma_f32_16x16x32_bf16 a[208:211], a[0:3], a[68:71], a[208:211]
  ds_read_b128 a[80:83], v8 offset:26624
  v_cvt_pk_bf16_f32 v65, v56, v57
  v_mfma_f32_16x16x32_bf16 a[212:215], a[0:3], a[72:75], a[212:215]
  buffer_load_dwordx4 v[120:123], v2, s[8:11], s20 offen offset:1024
  v_mfma_f32_16x16x32_bf16 a[216:219], a[4:7], a[60:63], a[216:219]
  ds_read_b128 a[84:87], v8 offset:28672
  ds_write_b64 v11, v[64:65] offset:55296
  v_mfma_f32_16x16x32_bf16 a[220:223], a[4:7], a[64:67], a[220:223]
  buffer_load_dwordx4 v[124:127], v2, s[8:11], s20 offen offset:2048
  v_mfma_f32_16x16x32_bf16 a[224:227], a[4:7], a[68:71], a[224:227]
  ds_read_b128 a[88:91], v8 offset:30720
  v_fma_f32 v54, v192, v18, v26
  v_fma_f32 v55, v193, v18, v27
  v_mfma_f32_16x16x32_bf16 a[228:231], a[4:7], a[72:75], a[228:231]
  s_add_u32 s20, s20, 3072
  v_fma_f32 v56, v194, v18, v28
  v_mfma_f32_16x16x32_bf16 a[232:235], a[8:11], a[60:63], a[232:235]
  v_fma_f32 v57, v195, v18, v29
  v_fma_f32 v58, v54, v54, v52
  v_mfma_f32_16x16x32_bf16 a[236:239], a[8:11], a[64:67], a[236:239]
  v_fma_f32 v59, v55, v55, v52
  v_fma_f32 v60, v56, v56, v52
  v_mfma_f32_16x16x32_bf16 a[240:243], a[8:11], a[68:71], a[240:243]
  v_fma_f32 v61, v57, v57, v52
  v_mul_f32 v58, v54, v58
  v_mul_f32 v59, v55, v59
  v_mfma_f32_16x16x32_bf16 a[244:247], a[8:11], a[72:75], a[244:247]
  v_mul_f32 v60, v56, v60
  v_mul_f32 v61, v57, v61
  s_waitcnt vmcnt(30) lgkmcnt(0)
  v_mfma_f32_16x16x32_bf16 a[104:107], a[12:15], a[76:79], a[104:107]
  buffer_load_dwordx4 a[0:3], v2, s[8:11], s20 offen offset:0
  v_mfma_f32_16x16x32_bf16 a[108:111], a[12:15], a[80:83], a[108:111]
  v_exp_f32_e64 v58, -v58
  v_exp_f32_e64 v59, -v59
  v_mfma_f32_16x16x32_bf16 a[112:115], a[12:15], a[84:87], a[112:115]
  buffer_load_dwordx4 a[4:7], v2, s[8:11], s20 offen offset:1024
  v_mfma_f32_16x16x32_bf16 a[116:119], a[12:15], a[88:91], a[116:119]
  v_exp_f32_e64 v60, -v60
  v_mfma_f32_16x16x32_bf16 a[120:123], a[16:19], a[76:79], a[120:123]
  buffer_load_dwordx4 a[8:11], v2, s[8:11], s20 offen offset:2048
  v_exp_f32_e64 v61, -v61
  v_mfma_f32_16x16x32_bf16 a[124:127], a[16:19], a[80:83], a[124:127]
  v_fma_f32 v58, v58, v53, v53
  v_fma_f32 v59, v59, v53, v53
  v_mfma_f32_16x16x32_bf16 a[128:131], a[16:19], a[84:87], a[128:131]
  s_add_u32 s20, s20, 3072
  v_fma_f32 v60, v60, v53, v53
  v_fma_f32 v61, v61, v53, v53
  v_mfma_f32_16x16x32_bf16 a[132:135], a[16:19], a[88:91], a[132:135]
  v_rcp_f32 v58, v58
  v_mfma_f32_16x16x32_bf16 a[136:139], a[20:23], a[76:79], a[136:139]
  v_rcp_f32 v59, v59
  v_rcp_f32 v60, v60
  v_mfma_f32_16x16x32_bf16 a[140:143], a[20:23], a[80:83], a[140:143]
  v_rcp_f32 v61, v61
  v_mfma_f32_16x16x32_bf16 a[144:147], a[20:23], a[84:87], a[144:147]
  v_mul_f32 v54, v54, v58
  v_mul_f32 v55, v55, v59
  v_mfma_f32_16x16x32_bf16 a[148:151], a[20:23], a[88:91], a[148:151]
  v_mul_f32 v56, v56, v60
  v_mul_f32 v57, v57, v61
  v_cvt_pk_bf16_f32 v62, v54, v55
  s_waitcnt vmcnt(30)
  v_mfma_f32_16x16x32_bf16 a[152:155], v[128:131], a[76:79], a[152:155]
  buffer_load_dwordx4 a[12:15], v2, s[8:11], s20 offen offset:0
  v_mfma_f32_16x16x32_bf16 a[156:159], v[128:131], a[80:83], a[156:159]
  v_cvt_pk_bf16_f32 v63, v56, v57
  ds_write_b64 v12, v[62:63] offset:49152
  v_mfma_f32_16x16x32_bf16 a[160:163], v[128:131], a[84:87], a[160:163]
  buffer_load_dwordx4 a[16:19], v2, s[8:11], s20 offen offset:1024
  v_mfma_f32_16x16x32_bf16 a[164:167], v[128:131], a[88:91], a[164:167]
  v_fma_f32 v54, v196, v19, v26
  v_fma_f32 v55, v197, v19, v27
  v_fma_f32 v56, v198, v19, v28
  v_mfma_f32_16x16x32_bf16 a[168:171], v[132:135], a[76:79], a[168:171]
  buffer_load_dwordx4 a[20:23], v2, s[8:11], s20 offen offset:2048
  v_mfma_f32_16x16x32_bf16 a[172:175], v[132:135], a[80:83], a[172:175]
  v_fma_f32 v57, v199, v19, v29
  v_fma_f32 v58, v54, v54, v52
  v_mfma_f32_16x16x32_bf16 a[176:179], v[132:135], a[84:87], a[176:179]
  s_add_u32 s20, s20, 3072
  v_fma_f32 v59, v55, v55, v52
  v_fma_f32 v60, v56, v56, v52
  v_mfma_f32_16x16x32_bf16 a[180:183], v[132:135], a[88:91], a[180:183]
  v_fma_f32 v61, v57, v57, v52
  v_mul_f32 v58, v54, v58
  v_mfma_f32_16x16x32_bf16 a[184:187], v[136:139], a[76:79], a[184:187]
  v_mul_f32 v59, v55, v59
  v_mul_f32 v60, v56, v60
  v_mfma_f32_16x16x32_bf16 a[188:191], v[136:139], a[80:83], a[188:191]
  v_mul_f32 v61, v57, v61
  v_exp_f32_e64 v58, -v58
  v_mfma_f32_16x16x32_bf16 a[192:195], v[136:139], a[84:87], a[192:195]
  v_exp_f32_e64 v59, -v59
  v_mfma_f32_16x16x32_bf16 a[196:199], v[136:139], a[88:91], a[196:199]
  v_exp_f32_e64 v60, -v60
  s_waitcnt vmcnt(30)
  v_mfma_f32_16x16x32_bf16 a[200:203], a[24:27], a[76:79], a[200:203]
  ds_read_b128 a[60:63], v7 offset:32768
  v_exp_f32_e64 v61, -v61
  v_mfma_f32_16x16x32_bf16 a[204:207], a[24:27], a[80:83], a[204:207]
  buffer_load_dwordx4 v[128:131], v2, s[8:11], s20 offen offset:0
  v_fma_f32 v58, v58, v53, v53
  v_mfma_f32_16x16x32_bf16 a[208:211], a[24:27], a[84:87], a[208:211]
  ds_read_b128 a[64:67], v7 offset:34816
  v_fma_f32 v59, v59, v53, v53
  v_mfma_f32_16x16x32_bf16 a[212:215], a[24:27], a[88:91], a[212:215]
  buffer_load_dwordx4 v[132:135], v2, s[8:11], s20 offen offset:1024
  v_fma_f32 v60, v60, v53, v53
  v_mfma_f32_16x16x32_bf16 a[216:219], a[28:31], a[76:79], a[216:219]
  ds_read_b128 a[68:71], v7 offset:36864
  v_fma_f32 v61, v61, v53, v53
  v_mfma_f32_16x16x32_bf16 a[220:223], a[28:31], a[80:83], a[220:223]
  buffer_load_dwordx4 v[136:139], v2, s[8:11], s20 offen offset:2048
  v_rcp_f32 v58, v58
  v_mfma_f32_16x16x32_bf16 a[224:227], a[28:31], a[84:87], a[224:227]
  ds_read_b128 a[72:75], v7 offset:38912
  v_rcp_f32 v59, v59
  v_mfma_f32_16x16x32_bf16 a[228:231], a[28:31], a[88:91], a[228:231]
  s_add_u32 s20, s20, 3072
  v_rcp_f32 v60, v60
  v_mfma_f32_16x16x32_bf16 a[232:235], a[32:35], a[76:79], a[232:235]
  v_rcp_f32 v61, v61
  v_mfma_f32_16x16x32_bf16 a[236:239], a[32:35], a[80:83], a[236:239]
  v_mul_f32 v54, v54, v58
  v_mul_f32 v55, v55, v59
  v_mul_f32 v56, v56, v60
  v_mfma_f32_16x16x32_bf16 a[240:243], a[32:35], a[84:87], a[240:243]
  v_mul_f32 v57, v57, v61
  v_cvt_pk_bf16_f32 v64, v54, v55
  v_cvt_pk_bf16_f32 v65, v56, v57
  v_mfma_f32_16x16x32_bf16 a[244:247], a[32:35], a[88:91], a[244:247]
  ds_write_b64 v12, v[64:65] offset:51200
  v_fma_f32 v54, v200, v20, v26
  s_waitcnt vmcnt(30) lgkmcnt(1)
  v_mfma_f32_16x16x32_bf16 a[104:107], v[140:143], a[60:63], a[104:107]
  buffer_load_dwordx4 a[24:27], v2, s[8:11], s20 offen offset:0
  v_mfma_f32_16x16x32_bf16 a[108:111], v[140:143], a[64:67], a[108:111]
  v_fma_f32 v55, v201, v20, v27
  v_fma_f32 v56, v202, v20, v28
  v_fma_f32 v57, v203, v20, v29
  v_mfma_f32_16x16x32_bf16 a[112:115], v[140:143], a[68:71], a[112:115]
  buffer_load_dwordx4 a[28:31], v2, s[8:11], s20 offen offset:1024
  v_mfma_f32_16x16x32_bf16 a[116:119], v[140:143], a[72:75], a[116:119]
  v_fma_f32 v58, v54, v54, v52
  v_fma_f32 v59, v55, v55, v52
  v_mfma_f32_16x16x32_bf16 a[120:123], v[144:147], a[60:63], a[120:123]
  buffer_load_dwordx4 a[32:35], v2, s[8:11], s20 offen offset:2048
  v_fma_f32 v60, v56, v56, v52
  v_mfma_f32_16x16x32_bf16 a[124:127], v[144:147], a[64:67], a[124:127]
  v_fma_f32 v61, v57, v57, v52
  v_mul_f32 v58, v54, v58
  v_mfma_f32_16x16x32_bf16 a[128:131], v[144:147], a[68:71], a[128:131]
  s_add_u32 s20, s20, 3072
  v_mul_f32 v59, v55, v59
  v_mfma_f32_16x16x32_bf16 a[132:135], v[144:147], a[72:75], a[132:135]
  v_mul_f32 v60, v56, v60
  v_mul_f32 v61, v57, v61
  v_mfma_f32_16x16x32_bf16 a[136:139], v[148:151], a[60:63], a[136:139]
  v_exp_f32_e64 v58, -v58
  v_exp_f32_e64 v59, -v59
  v_mfma_f32_16x16x32_bf16 a[140:143], v[148:151], a[64:67], a[140:143]
  v_exp_f32_e64 v60, -v60
  v_mfma_f32_16x16x32_bf16 a[144:147], v[148:151], a[68:71], a[144:147]
  v_exp_f32_e64 v61, -v61
  v_mfma_f32_16x16x32_bf16 a[148:151], v[148:151], a[72:75], a[148:151]
  v_fma_f32 v58, v58, v53, v53
  v_fma_f32 v59, v59, v53, v53
  s_waitcnt vmcnt(30)
  v_mfma_f32_16x16x32_bf16 a[152:155], a[36:39], a[60:63], a[152:155]
  buffer_load_dwordx4 v[140:143], v2, s[8:11], s20 offen offset:0
  v_mfma_f32_16x16x32_bf16 a[156:159], a[36:39], a[64:67], a[156:159]
  v_fma_f32 v60, v60, v53, v53
  v_fma_f32 v61, v61, v53, v53
  v_mfma_f32_16x16x32_bf16 a[160:163], a[36:39], a[68:71], a[160:163]
  buffer_load_dwordx4 v[144:147], v2, s[8:11], s20 offen offset:1024
  v_mfma_f32_16x16x32_bf16 a[164:167], a[36:39], a[72:75], a[164:167]
  v_rcp_f32 v58, v58
  v_rcp_f32 v59, v59
  v_mfma_f32_16x16x32_bf16 a[168:171], a[40:43], a[60:63], a[168:171]
  buffer_load_dwordx4 v[148:151], v2, s[8:11], s20 offen offset:2048
  v_mfma_f32_16x16x32_bf16 a[172:175], a[40:43], a[64:67], a[172:175]
  v_rcp_f32 v60, v60
  v_mfma_f32_16x16x32_bf16 a[176:179], a[40:43], a[68:71], a[176:179]
  s_add_u32 s20, s20, 3072
  v_rcp_f32 v61, v61
  v_mfma_f32_16x16x32_bf16 a[180:183], a[40:43], a[72:75], a[180:183]
  v_mul_f32 v54, v54, v58
  v_mfma_f32_16x16x32_bf16 a[184:187], a[44:47], a[60:63], a[184:187]
  v_mul_f32 v55, v55, v59
  v_mul_f32 v56, v56, v60
  v_mul_f32 v57, v57, v61
  v_mfma_f32_16x16x32_bf16 a[188:191], a[44:47], a[64:67], a[188:191]
  v_cvt_pk_bf16_f32 v62, v54, v55
  v_cvt_pk_bf16_f32 v63, v56, v57
  v_mfma_f32_16x16x32_bf16 a[192:195], a[44:47], a[68:71], a[192:195]
  ds_write_b64 v12, v[62:63] offset:53248
  v_fma_f32 v54, v204, v21, v26
  v_mfma_f32_16x16x32_bf16 a[196:199], a[44:47], a[72:75], a[196:199]
  v_fma_f32 v55, v205, v21, v27
  v_fma_f32 v56, v206, v21, v28
  s_waitcnt vmcnt(30)
  v_mfma_f32_16x16x32_bf16 a[200:203], v[152:155], a[60:63], a[200:203]
  ds_read_b128 a[76:79], v8 offset:32768
  v_fma_f32 v57, v207, v21, v29
  v_fma_f32 v58, v54, v54, v52
  v_mfma_f32_16x16x32_bf16 a[204:207], v[152:155], a[64:67], a[204:207]
  buffer_load_dwordx4 a[36:39], v2, s[8:11], s20 offen offset:0
  v_mfma_f32_16x16x32_bf16 a[208:211], v[152:155], a[68:71], a[208:211]
  ds_read_b128 a[80:83], v8 offset:34816
  v_fma_f32 v59, v55, v55, v52
  v_fma_f32 v60, v56, v56, v52
  v_mfma_f32_16x16x32_bf16 a[212:215], v[152:155], a[72:75], a[212:215]
  buffer_load_dwordx4 a[40:43], v2, s[8:11], s20 offen offset:1024
  v_fma_f32 v61, v57, v57, v52
  v_mfma_f32_16x16x32_bf16 a[216:219], v[156:159], a[60:63], a[216:219]
  ds_read_b128 a[84:87], v8 offset:36864
  v_mul_f32 v58, v54, v58
  v_mfma_f32_16x16x32_bf16 a[220:223], v[156:159], a[64:67], a[220:223]
  buffer_load_dwordx4 a[44:47], v2, s[8:11], s20 offen offset:2048
  v_mul_f32 v59, v55, v59
  v_mfma_f32_16x16x32_bf16 a[224:227], v[156:159], a[68:71], a[224:227]
  ds_read_b128 a[88:91], v8 offset:38912
  v_mul_f32 v60, v56, v60
  v_mul_f32 v61, v57, v61
  v_mfma_f32_16x16x32_bf16 a[228:231], v[156:159], a[72:75], a[228:231]
  s_add_u32 s20, s20, 3072
  v_exp_f32_e64 v58, -v58
  v_mfma_f32_16x16x32_bf16 a[232:235], v[160:163], a[60:63], a[232:235]
  v_exp_f32_e64 v59, -v59
  v_mfma_f32_16x16x32_bf16 a[236:239], v[160:163], a[64:67], a[236:239]
  v_exp_f32_e64 v60, -v60
  v_mfma_f32_16x16x32_bf16 a[240:243], v[160:163], a[68:71], a[240:243]
  v_exp_f32_e64 v61, -v61
  v_fma_f32 v58, v58, v53, v53
  v_mfma_f32_16x16x32_bf16 a[244:247], v[160:163], a[72:75], a[244:247]
  v_fma_f32 v59, v59, v53, v53
  v_fma_f32 v60, v60, v53, v53
  v_fma_f32 v61, v61, v53, v53
  s_waitcnt vmcnt(30) lgkmcnt(0)
  v_mfma_f32_16x16x32_bf16 a[104:107], a[48:51], a[76:79], a[104:107]
  buffer_load_dwordx4 v[152:155], v2, s[8:11], s20 offen offset:0
  v_mfma_f32_16x16x32_bf16 a[108:111], a[48:51], a[80:83], a[108:111]
  v_rcp_f32 v58, v58
  v_mfma_f32_16x16x32_bf16 a[112:115], a[48:51], a[84:87], a[112:115]
  buffer_load_dwordx4 v[156:159], v2, s[8:11], s20 offen offset:1024
  v_rcp_f32 v59, v59
  v_mfma_f32_16x16x32_bf16 a[116:119], a[48:51], a[88:91], a[116:119]
  v_rcp_f32 v60, v60
  v_mfma_f32_16x16x32_bf16 a[120:123], a[52:55], a[76:79], a[120:123]
  buffer_load_dwordx4 v[160:163], v2, s[8:11], s20 offen offset:2048
  v_mfma_f32_16x16x32_bf16 a[124:127], a[52:55], a[80:83], a[124:127]
  v_rcp_f32 v61, v61
  v_mfma_f32_16x16x32_bf16 a[128:131], a[52:55], a[84:87], a[128:131]
  s_add_u32 s20, s20, 3072
  v_mul_f32 v54, v54, v58
  v_mul_f32 v55, v55, v59
  v_mfma_f32_16x16x32_bf16 a[132:135], a[52:55], a[88:91], a[132:135]
  v_mul_f32 v56, v56, v60
  v_mul_f32 v57, v57, v61
  v_mfma_f32_16x16x32_bf16 a[136:139], a[56:59], a[76:79], a[136:139]
  v_cvt_pk_bf16_f32 v64, v54, v55
  v_cvt_pk_bf16_f32 v65, v56, v57
  v_mfma_f32_16x16x32_bf16 a[140:143], a[56:59], a[80:83], a[140:143]
  ds_write_b64 v12, v[64:65] offset:55296
  v_fma_f32 v54, v208, v18, v30
  v_mfma_f32_16x16x32_bf16 a[144:147], a[56:59], a[84:87], a[144:147]
  v_fma_f32 v55, v209, v18, v31
  v_fma_f32 v56, v210, v18, v32
  v_fma_f32 v57, v211, v18, v33
  v_mfma_f32_16x16x32_bf16 a[148:151], a[56:59], a[88:91], a[148:151]
  v_fma_f32 v58, v54, v54, v52
  v_fma_f32 v59, v55, v55, v52
  s_waitcnt vmcnt(30)
  v_mfma_f32_16x16x32_bf16 a[152:155], v[80:83], a[76:79], a[152:155]
  buffer_load_dwordx4 a[48:51], v2, s[8:11], s20 offen offset:0
  v_fma_f32 v60, v56, v56, v52
  v_mfma_f32_16x16x32_bf16 a[156:159], v[80:83], a[80:83], a[156:159]
  v_fma_f32 v61, v57, v57, v52
  v_mul_f32 v58, v54, v58
  v_mfma_f32_16x16x32_bf16 a[160:163], v[80:83], a[84:87], a[160:163]
  buffer_load_dwordx4 a[52:55], v2, s[8:11], s20 offen offset:1024
  v_mul_f32 v59, v55, v59
  v_mfma_f32_16x16x32_bf16 a[164:167], v[80:83], a[88:91], a[164:167]
  v_mul_f32 v60, v56, v60
  v_mul_f32 v61, v57, v61
  v_mfma_f32_16x16x32_bf16 a[168:171], v[84:87], a[76:79], a[168:171]
  buffer_load_dwordx4 a[56:59], v2, s[8:11], s20 offen offset:2048
  v_mfma_f32_16x16x32_bf16 a[172:175], v[84:87], a[80:83], a[172:175]
  v_exp_f32_e64 v58, -v58
  v_exp_f32_e64 v59, -v59
  v_mfma_f32_16x16x32_bf16 a[176:179], v[84:87], a[84:87], a[176:179]
  s_add_u32 s20, s20, 3072
  v_exp_f32_e64 v60, -v60
  v_mfma_f32_16x16x32_bf16 a[180:183], v[84:87], a[88:91], a[180:183]
  v_exp_f32_e64 v61, -v61
  v_mfma_f32_16x16x32_bf16 a[184:187], v[88:91], a[76:79], a[184:187]
  v_fma_f32 v58, v58, v53, v53
  v_fma_f32 v59, v59, v53, v53
  v_mfma_f32_16x16x32_bf16 a[188:191], v[88:91], a[80:83], a[188:191]
  v_fma_f32 v60, v60, v53, v53
  v_fma_f32 v61, v61, v53, v53
  v_mfma_f32_16x16x32_bf16 a[192:195], v[88:91], a[84:87], a[192:195]
  v_rcp_f32 v58, v58
  v_rcp_f32 v59, v59
  v_mfma_f32_16x16x32_bf16 a[196:199], v[88:91], a[88:91], a[196:199]
  v_rcp_f32 v60, v60
  s_waitcnt vmcnt(30)
  v_mfma_f32_16x16x32_bf16 a[200:203], v[92:95], a[76:79], a[200:203]
  ds_read_b128 a[60:63], v7 offset:40960
  v_rcp_f32 v61, v61
  v_mfma_f32_16x16x32_bf16 a[204:207], v[92:95], a[80:83], a[204:207]
  buffer_load_dwordx4 v[80:83], v2, s[8:11], s20 offen offset:0
  v_mfma_f32_16x16x32_bf16 a[208:211], v[92:95], a[84:87], a[208:211]
  ds_read_b128 a[64:67], v7 offset:43008
  v_mul_f32 v54, v54, v58
  v_mfma_f32_16x16x32_bf16 a[212:215], v[92:95], a[88:91], a[212:215]
  buffer_load_dwordx4 v[84:87], v2, s[8:11], s20 offen offset:1024
  v_mul_f32 v55, v55, v59
  v_mfma_f32_16x16x32_bf16 a[216:219], v[96:99], a[76:79], a[216:219]
  ds_read_b128 a[68:71], v7 offset:45056
  v_mul_f32 v56, v56, v60
  v_mfma_f32_16x16x32_bf16 a[220:223], v[96:99], a[80:83], a[220:223]
  buffer_load_dwordx4 v[88:91], v2, s[8:11], s20 offen offset:2048
  v_mul_f32 v57, v57, v61
  v_mfma_f32_16x16x32_bf16 a[224:227], v[96:99], a[84:87], a[224:227]
  ds_read_b128 a[72:75], v7 offset:47104
  v_cvt_pk_bf16_f32 v62, v54, v55
  v_mfma_f32_16x16x32_bf16 a[228:231], v[96:99], a[88:91], a[228:231]
  s_add_u32 s20, s20, 3072
  v_cvt_pk_bf16_f32 v63, v56, v57
  v_mfma_f32_16x16x32_bf16 a[232:235], v[100:103], a[76:79], a[232:235]
  ds_write_b64 v13, v[62:63] offset:49152
  v_fma_f32 v54, v212, v19, v30
  v_fma_f32 v55, v213, v19, v31
  v_mfma_f32_16x16x32_bf16 a[236:239], v[100:103], a[80:83], a[236:239]
  v_fma_f32 v56, v214, v19, v32
  v_fma_f32 v57, v215, v19, v33
  v_mfma_f32_16x16x32_bf16 a[240:243], v[100:103], a[84:87], a[240:243]
  v_fma_f32 v58, v54, v54, v52
  v_fma_f32 v59, v55, v55, v52
  v_fma_f32 v60, v56, v56, v52
  v_mfma_f32_16x16x32_bf16 a[244:247], v[100:103], a[88:91], a[244:247]
  v_fma_f32 v61, v57, v57, v52
  v_mul_f32 v58, v54, v58
  s_waitcnt vmcnt(30) lgkmcnt(1)
  v_mfma_f32_16x16x32_bf16 a[104:107], v[104:107], a[60:63], a[104:107]
  buffer_load_dwordx4 v[92:95], v2, s[8:11], s20 offen offset:0
  v_mul_f32 v59, v55, v59
  v_mfma_f32_16x16x32_bf16 a[108:111], v[104:107], a[64:67], a[108:111]
  v_mul_f32 v60, v56, v60
  v_mul_f32 v61, v57, v61
  v_mfma_f32_16x16x32_bf16 a[112:115], v[104:107], a[68:71], a[112:115]
  buffer_load_dwordx4 v[96:99], v2, s[8:11], s20 offen offset:1024
  v_mfma_f32_16x16x32_bf16 a[116:119], v[104:107], a[72:75], a[116:119]
  v_exp_f32_e64 v58, -v58
  v_exp_f32_e64 v59, -v59
  v_mfma_f32_16x16x32_bf16 a[120:123], v[108:111], a[60:63], a[120:123]
  buffer_load_dwordx4 v[100:103], v2, s[8:11], s20 offen offset:2048
  v_mfma_f32_16x16x32_bf16 a[124:127], v[108:111], a[64:67], a[124:127]
  v_exp_f32_e64 v60, -v60
  v_mfma_f32_16x16x32_bf16 a[128:131], v[108:111], a[68:71], a[128:131]
  s_add_u32 s20, s20, 3072
  v_exp_f32_e64 v61, -v61
  v_mfma_f32_16x16x32_bf16 a[132:135], v[108:111], a[72:75], a[132:135]
  v_fma_f32 v58, v58, v53, v53
  v_fma_f32 v59, v59, v53, v53
  v_fma_f32 v60, v60, v53, v53
  v_mfma_f32_16x16x32_bf16 a[136:139], v[112:115], a[60:63], a[136:139]
  v_fma_f32 v61, v61, v53, v53
  v_rcp_f32 v58, v58
  v_mfma_f32_16x16x32_bf16 a[140:143], v[112:115], a[64:67], a[140:143]
  v_rcp_f32 v59, v59
  v_mfma_f32_16x16x32_bf16 a[144:147], v[112:115], a[68:71], a[144:147]
  v_rcp_f32 v60, v60
  v_mfma_f32_16x16x32_bf16 a[148:151], v[112:115], a[72:75], a[148:151]
  v_rcp_f32 v61, v61
  v_mul_f32 v54, v54, v58
  s_waitcnt vmcnt(30)
  v_mfma_f32_16x16x32_bf16 a[152:155], v[116:119], a[60:63], a[152:155]
  buffer_load_dwordx4 v[104:107], v2, s[8:11], s20 offen offset:0
  v_mfma_f32_16x16x32_bf16 a[156:159], v[116:119], a[64:67], a[156:159]
  v_mul_f32 v55, v55, v59
  v_mul_f32 v56, v56, v60
  v_mfma_f32_16x16x32_bf16 a[160:163], v[116:119], a[68:71], a[160:163]
  buffer_load_dwordx4 v[108:111], v2, s[8:11], s20 offen offset:1024
  v_mfma_f32_16x16x32_bf16 a[164:167], v[116:119], a[72:75], a[164:167]
  v_mul_f32 v57, v57, v61
  v_cvt_pk_bf16_f32 v64, v54, v55
  v_mfma_f32_16x16x32_bf16 a[168:171], v[120:123], a[60:63], a[168:171]
  buffer_load_dwordx4 v[112:115], v2, s[8:11], s20 offen offset:2048
  v_mfma_f32_16x16x32_bf16 a[172:175], v[120:123], a[64:67], a[172:175]
  v_cvt_pk_bf16_f32 v65, v56, v57
  ds_write_b64 v13, v[64:65] offset:51200
  v_mfma_f32_16x16x32_bf16 a[176:179], v[120:123], a[68:71], a[176:179]
  s_add_u32 s20, s20, 3072
  v_fma_f32 v54, v216, v20, v30
  v_mfma_f32_16x16x32_bf16 a[180:183], v[120:123], a[72:75], a[180:183]
  v_fma_f32 v55, v217, v20, v31
  v_fma_f32 v56, v218, v20, v32
  v_mfma_f32_16x16x32_bf16 a[184:187], v[124:127], a[60:63], a[184:187]
  v_fma_f32 v57, v219, v20, v33
  v_fma_f32 v58, v54, v54, v52
  v_mfma_f32_16x16x32_bf16 a[188:191], v[124:127], a[64:67], a[188:191]
  v_fma_f32 v59, v55, v55, v52
  v_fma_f32 v60, v56, v56, v52
  v_mfma_f32_16x16x32_bf16 a[192:195], v[124:127], a[68:71], a[192:195]
  v_fma_f32 v61, v57, v57, v52
  v_mul_f32 v58, v54, v58
  v_mfma_f32_16x16x32_bf16 a[196:199], v[124:127], a[72:75], a[196:199]
  v_mul_f32 v59, v55, v59
  v_mul_f32 v60, v56, v60
  s_waitcnt vmcnt(30)
  v_mfma_f32_16x16x32_bf16 a[200:203], a[0:3], a[60:63], a[200:203]
  ds_read_b128 a[76:79], v8 offset:40960
  v_mul_f32 v61, v57, v61
  v_exp_f32_e64 v58, -v58
  v_mfma_f32_16x16x32_bf16 a[204:207], a[0:3], a[64:67], a[204:207]
  buffer_load_dwordx4 v[116:119], v2, s[8:11], s20 offen offset:0
  v_mfma_f32_16x16x32_bf16 a[208:211], a[0:3], a[68:71], a[208:211]
  ds_read_b128 a[80:83], v8 offset:43008
  v_exp_f32_e64 v59, -v59
  v_mfma_f32_16x16x32_bf16 a[212:215], a[0:3], a[72:75], a[212:215]
  buffer_load_dwordx4 v[120:123], v2, s[8:11], s20 offen offset:1024
  v_exp_f32_e64 v60, -v60
  v_mfma_f32_16x16x32_bf16 a[216:219], a[4:7], a[60:63], a[216:219]
  ds_read_b128 a[84:87], v8 offset:45056
  v_exp_f32_e64 v61, -v61
  v_mfma_f32_16x16x32_bf16 a[220:223], a[4:7], a[64:67], a[220:223]
  buffer_load_dwordx4 v[124:127], v2, s[8:11], s20 offen offset:2048
  v_mfma_f32_16x16x32_bf16 a[224:227], a[4:7], a[68:71], a[224:227]
  ds_read_b128 a[88:91], v8 offset:47104
  v_fma_f32 v58, v58, v53, v53
  v_fma_f32 v59, v59, v53, v53
  v_mfma_f32_16x16x32_bf16 a[228:231], a[4:7], a[72:75], a[228:231]
  s_add_u32 s20, s20, 3072
  v_fma_f32 v60, v60, v53, v53
  v_fma_f32 v61, v61, v53, v53
  v_mfma_f32_16x16x32_bf16 a[232:235], a[8:11], a[60:63], a[232:235]
  v_rcp_f32 v58, v58
  v_rcp_f32 v59, v59
  v_mfma_f32_16x16x32_bf16 a[236:239], a[8:11], a[64:67], a[236:239]
  v_rcp_f32 v60, v60
  v_mfma_f32_16x16x32_bf16 a[240:243], a[8:11], a[68:71], a[240:243]
  v_rcp_f32 v61, v61
  v_mul_f32 v54, v54, v58
  v_mfma_f32_16x16x32_bf16 a[244:247], a[8:11], a[72:75], a[244:247]
  v_mul_f32 v55, v55, v59
  v_mul_f32 v56, v56, v60
  v_mul_f32 v57, v57, v61
  s_waitcnt vmcnt(30) lgkmcnt(0)
  v_mfma_f32_16x16x32_bf16 a[104:107], a[12:15], a[76:79], a[104:107]
  buffer_load_dwordx4 a[0:3], v2, s[8:11], s20 offen offset:0
  v_mfma_f32_16x16x32_bf16 a[108:111], a[12:15], a[80:83], a[108:111]
  v_cvt_pk_bf16_f32 v62, v54, v55
  v_cvt_pk_bf16_f32 v63, v56, v57
  v_mfma_f32_16x16x32_bf16 a[112:115], a[12:15], a[84:87], a[112:115]
  buffer_load_dwordx4 a[4:7], v2, s[8:11], s20 offen offset:1024
  v_mfma_f32_16x16x32_bf16 a[116:119], a[12:15], a[88:91], a[116:119]
  ds_write_b64 v13, v[62:63] offset:53248
  v_fma_f32 v54, v220, v21, v30
  v_mfma_f32_16x16x32_bf16 a[120:123], a[16:19], a[76:79], a[120:123]
  buffer_load_dwordx4 a[8:11], v2, s[8:11], s20 offen offset:2048
  v_fma_f32 v55, v221, v21, v31
  v_mfma_f32_16x16x32_bf16 a[124:127], a[16:19], a[80:83], a[124:127]
  v_fma_f32 v56, v222, v21, v32
  v_fma_f32 v57, v223, v21, v33
  v_mfma_f32_16x16x32_bf16 a[128:131], a[16:19], a[84:87], a[128:131]
  s_add_u32 s20, s20, 3072
  v_fma_f32 v58, v54, v54, v52
  v_mfma_f32_16x16x32_bf16 a[132:135], a[16:19], a[88:91], a[132:135]
  v_fma_f32 v59, v55, v55, v52
  v_fma_f32 v60, v56, v56, v52
  v_mfma_f32_16x16x32_bf16 a[136:139], a[20:23], a[76:79], a[136:139]
  v_fma_f32 v61, v57, v57, v52
  v_mul_f32 v58, v54, v58
  v_mfma_f32_16x16x32_bf16 a[140:143], a[20:23], a[80:83], a[140:143]
  v_mul_f32 v59, v55, v59
  v_mul_f32 v60, v56, v60
  v_mul_f32 v61, v57, v61
  v_mfma_f32_16x16x32_bf16 a[144:147], a[20:23], a[84:87], a[144:147]
  v_exp_f32_e64 v58, -v58
  v_mfma_f32_16x16x32_bf16 a[148:151], a[20:23], a[88:91], a[148:151]
  v_exp_f32_e64 v59, -v59
  s_waitcnt vmcnt(30)
  v_mfma_f32_16x16x32_bf16 a[152:155], v[128:131], a[76:79], a[152:155]
  buffer_load_dwordx4 a[12:15], v2, s[8:11], s20 offen offset:0
  v_mfma_f32_16x16x32_bf16 a[156:159], v[128:131], a[80:83], a[156:159]
  v_exp_f32_e64 v60, -v60
  v_exp_f32_e64 v61, -v61
  v_mfma_f32_16x16x32_bf16 a[160:163], v[128:131], a[84:87], a[160:163]
  buffer_load_dwordx4 a[16:19], v2, s[8:11], s20 offen offset:1024
  v_mfma_f32_16x16x32_bf16 a[164:167], v[128:131], a[88:91], a[164:167]
  v_fma_f32 v58, v58, v53, v53
  v_fma_f32 v59, v59, v53, v53
  v_mfma_f32_16x16x32_bf16 a[168:171], v[132:135], a[76:79], a[168:171]
  buffer_load_dwordx4 a[20:23], v2, s[8:11], s20 offen offset:2048
  v_fma_f32 v60, v60, v53, v53
  v_mfma_f32_16x16x32_bf16 a[172:175], v[132:135], a[80:83], a[172:175]
  v_fma_f32 v61, v61, v53, v53
  v_rcp_f32 v58, v58
  v_mfma_f32_16x16x32_bf16 a[176:179], v[132:135], a[84:87], a[176:179]
  s_add_u32 s20, s20, 3072
  v_mfma_f32_16x16x32_bf16 a[180:183], v[132:135], a[88:91], a[180:183]
  v_rcp_f32 v59, v59
  v_rcp_f32 v60, v60
  v_mfma_f32_16x16x32_bf16 a[184:187], v[136:139], a[76:79], a[184:187]
  v_rcp_f32 v61, v61
  v_mfma_f32_16x16x32_bf16 a[188:191], v[136:139], a[80:83], a[188:191]
  v_mul_f32 v54, v54, v58
  v_mul_f32 v55, v55, v59
  v_mfma_f32_16x16x32_bf16 a[192:195], v[136:139], a[84:87], a[192:195]
  v_mul_f32 v56, v56, v60
  v_mul_f32 v57, v57, v61
  v_cvt_pk_bf16_f32 v64, v54, v55
  v_mfma_f32_16x16x32_bf16 a[196:199], v[136:139], a[88:91], a[196:199]
  v_cvt_pk_bf16_f32 v65, v56, v57
  ds_write_b64 v13, v[64:65] offset:55296
  s_waitcnt vmcnt(30) lgkmcnt(0)
  s_barrier
  v_mfma_f32_16x16x32_bf16 a[200:203], a[24:27], a[76:79], a[200:203]
  ds_read_b128 a[60:63], v7 offset:49152
  v_mfma_f32_16x16x32_bf16 a[204:207], a[24:27], a[80:83], a[204:207]
  buffer_load_dwordx4 v[128:131], v2, s[8:11], s20 offen offset:0
  v_mfma_f32_16x16x32_bf16 a[208:211], a[24:27], a[84:87], a[208:211]
  ds_read_b128 a[64:67], v7 offset:51200
  v_mfma_f32_16x16x32_bf16 a[212:215], a[24:27], a[88:91], a[212:215]
  buffer_load_dwordx4 v[132:135], v2, s[8:11], s20 offen offset:1024
  v_mfma_f32_16x16x32_bf16 a[216:219], a[28:31], a[76:79], a[216:219]
  ds_read_b128 a[68:71], v7 offset:53248
  v_mfma_f32_16x16x32_bf16 a[220:223], a[28:31], a[80:83], a[220:223]
  buffer_load_dwordx4 v[136:139], v2, s[8:11], s20 offen offset:2048
  v_mfma_f32_16x16x32_bf16 a[224:227], a[28:31], a[84:87], a[224:227]
  ds_read_b128 a[72:75], v7 offset:55296
  v_mfma_f32_16x16x32_bf16 a[228:231], a[28:31], a[88:91], a[228:231]
  s_add_u32 s20, s20, 3072
  v_mfma_f32_16x16x32_bf16 a[232:235], a[32:35], a[76:79], a[232:235]
  v_mfma_f32_16x16x32_bf16 a[236:239], a[32:35], a[80:83], a[236:239]
  v_mfma_f32_16x16x32_bf16 a[240:243], a[32:35], a[84:87], a[240:243]
  v_mfma_f32_16x16x32_bf16 a[244:247], a[32:35], a[88:91], a[244:247]
  s_waitcnt vmcnt(30) lgkmcnt(0)
  v_mfma_f32_16x16x32_bf16 a[104:107], v[140:143], a[60:63], a[104:107]
  ds_read_b128 a[76:79], v8 offset:49152
  v_mfma_f32_16x16x32_bf16 a[108:111], v[140:143], a[64:67], a[108:111]
  buffer_load_dwordx4 a[24:27], v2, s[8:11], s20 offen offset:0
  v_mfma_f32_16x16x32_bf16 a[112:115], v[140:143], a[68:71], a[112:115]
  ds_read_b128 a[80:83], v8 offset:51200
  v_mfma_f32_16x16x32_bf16 a[116:119], v[140:143], a[72:75], a[116:119]
  buffer_load_dwordx4 a[28:31], v2, s[8:11], s20 offen offset:1024
  v_mfma_f32_16x16x32_bf16 a[120:123], v[144:147], a[60:63], a[120:123]
  ds_read_b128 a[84:87], v8 offset:53248
  v_mfma_f32_16x16x32_bf16 a[124:127], v[144:147], a[64:67], a[124:127]
  buffer_load_dwordx4 a[32:35], v2, s[8:11], s20 offen offset:2048
  v_mfma_f32_16x16x32_bf16 a[128:131], v[144:147], a[68:71], a[128:131]
  ds_read_b128 a[88:91], v8 offset:55296
  v_mfma_f32_16x16x32_bf16 a[132:135], v[144:147], a[72:75], a[132:135]
  s_add_u32 s20, s20, 3072
  v_mfma_f32_16x16x32_bf16 a[136:139], v[148:151], a[60:63], a[136:139]
  v_mfma_f32_16x16x32_bf16 a[140:143], v[148:151], a[64:67], a[140:143]
  v_mfma_f32_16x16x32_bf16 a[144:147], v[148:151], a[68:71], a[144:147]
  v_mfma_f32_16x16x32_bf16 a[148:151], v[148:151], a[72:75], a[148:151]
  s_waitcnt vmcnt(30) lgkmcnt(0)
  v_mfma_f32_16x16x32_bf16 a[104:107], a[36:39], a[76:79], a[104:107]
  ds_read_b128 a[60:63], v7 offset:57344
  v_mfma_f32_16x16x32_bf16 a[108:111], a[36:39], a[80:83], a[108:111]
  buffer_load_dwordx4 v[140:143], v2, s[8:11], s20 offen offset:0
  v_mfma_f32_16x16x32_bf16 a[112:115], a[36:39], a[84:87], a[112:115]
  ds_read_b128 a[64:67], v7 offset:59392
  v_mfma_f32_16x16x32_bf16 a[116:119], a[36:39], a[88:91], a[116:119]
  buffer_load_dwordx4 v[144:147], v2, s[8:11], s20 offen offset:1024
  v_mfma_f32_16x16x32_bf16 a[120:123], a[40:43], a[76:79], a[120:123]
  ds_read_b128 a[68:71], v7 offset:61440
  v_mfma_f32_16x16x32_bf16 a[124:127], a[40:43], a[80:83], a[124:127]
  buffer_load_dwordx4 v[148:151], v2, s[8:11], s20 offen offset:2048
  v_mfma_f32_16x16x32_bf16 a[128:131], a[40:43], a[84:87], a[128:131]
  ds_read_b128 a[72:75], v7 offset:63488
  v_mfma_f32_16x16x32_bf16 a[132:135], a[40:43], a[88:91], a[132:135]
  s_add_u32 s20, s20, 3072
  v_mfma_f32_16x16x32_bf16 a[136:139], a[44:47], a[76:79], a[136:139]
  v_mfma_f32_16x16x32_bf16 a[140:143], a[44:47], a[80:83], a[140:143]
  v_mfma_f32_16x16x32_bf16 a[144:147], a[44:47], a[84:87], a[144:147]
  v_mfma_f32_16x16x32_bf16 a[148:151], a[44:47], a[88:91], a[148:151]
  s_waitcnt vmcnt(30) lgkmcnt(0)
  v_mfma_f32_16x16x32_bf16 a[104:107], v[152:155], a[60:63], a[104:107]
  ds_read_b128 a[76:79], v8 offset:57344
  v_mfma_f32_16x16x32_bf16 a[108:111], v[152:155], a[64:67], a[108:111]
  buffer_load_dwordx4 a[36:39], v2, s[8:11], s20 offen offset:0
  v_mfma_f32_16x16x32_bf16 a[112:115], v[152:155], a[68:71], a[112:115]
  ds_read_b128 a[80:83], v8 offset:59392
  v_mfma_f32_16x16x32_bf16 a[116:119], v[152:155], a[72:75], a[116:119]
  buffer_load_dwordx4 a[40:43], v2, s[8:11], s20 offen offset:1024
  v_mfma_f32_16x16x32_bf16 a[120:123], v[156:159], a[60:63], a[120:123]
  ds_read_b128 a[84:87], v8 offset:61440
  v_mfma_f32_16x16x32_bf16 a[124:127], v[156:159], a[64:67], a[124:127]
  buffer_load_dwordx4 a[44:47], v2, s[8:11], s20 offen offset:2048
  v_mfma_f32_16x16x32_bf16 a[128:131], v[156:159], a[68:71], a[128:131]
  ds_read_b128 a[88:91], v8 offset:63488
  v_mfma_f32_16x16x32_bf16 a[132:135], v[156:159], a[72:75], a[132:135]
  s_add_u32 s20, s20, 3072
  v_mfma_f32_16x16x32_bf16 a[136:139], v[160:163], a[60:63], a[136:139]
  v_mfma_f32_16x16x32_bf16 a[140:143], v[160:163], a[64:67], a[140:143]
  v_mfma_f32_16x16x32_bf16 a[144:147], v[160:163], a[68:71], a[144:147]
  v_mfma_f32_16x16x32_bf16 a[148:151], v[160:163], a[72:75], a[148:151]
  s_waitcnt vmcnt(30) lgkmcnt(0)
  v_mfma_f32_16x16x32_bf16 a[104:107], a[48:51], a[76:79], a[104:107]
  ds_read_b128 a[60:63], v9 offset:0
  v_mfma_f32_16x16x32_bf16 a[108:111], a[48:51], a[80:83], a[108:111]
  buffer_load_dwordx4 v[152:155], v2, s[8:11], s20 offen offset:0
  v_mfma_f32_16x16x32_bf16 a[112:115], a[48:51], a[84:87], a[112:115]
  ds_read_b128 a[64:67], v9 offset:2048
  v_mfma_f32_16x16x32_bf16 a[116:119], a[48:51], a[88:91], a[116:119]
  buffer_load_dwordx4 v[156:159], v2, s[8:11], s20 offen offset:1024
  v_mfma_f32_16x16x32_bf16 a[120:123], a[52:55], a[76:79], a[120:123]
  ds_read_b128 a[68:71], v9 offset:4096
  v_mfma_f32_16x16x32_bf16 a[124:127], a[52:55], a[80:83], a[124:127]
  buffer_load_dwordx4 v[160:163], v2, s[8:11], s20 offen offset:2048
  v_mfma_f32_16x16x32_bf16 a[128:131], a[52:55], a[84:87], a[128:131]
  ds_read_b128 a[72:75], v9 offset:6144
  v_mfma_f32_16x16x32_bf16 a[132:135], a[52:55], a[88:91], a[132:135]
  s_add_u32 s20, s20, 3072
  v_mfma_f32_16x16x32_bf16 a[136:139], a[56:59], a[76:79], a[136:139]
  v_mfma_f32_16x16x32_bf16 a[140:143], a[56:59], a[80:83], a[140:143]
  v_mfma_f32_16x16x32_bf16 a[144:147], a[56:59], a[84:87], a[144:147]
  v_mfma_f32_16x16x32_bf16 a[148:151], a[56:59], a[88:91], a[148:151]
  s_waitcnt vmcnt(30) lgkmcnt(0)
  v_mfma_f32_16x16x32_bf16 a[104:107], v[80:83], a[60:63], a[104:107]
  ds_read_b128 a[76:79], v10 offset:0
  v_mfma_f32_16x16x32_bf16 a[108:111], v[80:83], a[64:67], a[108:111]
  buffer_load_dwordx4 a[48:51], v2, s[8:11], s20 offen offset:0
  v_mfma_f32_16x16x32_bf16 a[112:115], v[80:83], a[68:71], a[112:115]
  ds_read_b128 a[80:83], v10 offset:2048
  v_mfma_f32_16x16x32_bf16 a[116:119], v[80:83], a[72:75], a[116:119]
  buffer_load_dwordx4 a[52:55], v2, s[8:11], s20 offen offset:1024
  v_mfma_f32_16x16x32_bf16 a[120:123], v[84:87], a[60:63], a[120:123]
  ds_read_b128 a[84:87], v10 offset:4096
  v_mfma_f32_16x16x32_bf16 a[124:127], v[84:87], a[64:67], a[124:127]
  buffer_load_dwordx4 a[56:59], v2, s[8:11], s20 offen offset:2048
  v_mfma_f32_16x16x32_bf16 a[128:131], v[84:87], a[68:71], a[128:131]
  ds_read_b128 a[88:91], v10 offset:6144
  v_mfma_f32_16x16x32_bf16 a[132:135], v[84:87], a[72:75], a[132:135]
  s_add_u32 s20, s20, 3072
  v_mfma_f32_16x16x32_bf16 a[136:139], v[88:91], a[60:63], a[136:139]
  v_mfma_f32_16x16x32_bf16 a[140:143], v[88:91], a[64:67], a[140:143]
  v_mfma_f32_16x16x32_bf16 a[144:147], v[88:91], a[68:71], a[144:147]
  v_mfma_f32_16x16x32_bf16 a[148:151], v[88:91], a[72:75], a[148:151]
  s_waitcnt vmcnt(30) lgkmcnt(0)
  v_mfma_f32_16x16x32_bf16 a[104:107], v[92:95], a[76:79], a[104:107]
  ds_read_b128 a[60:63], v7 offset:49152
  v_mfma_f32_16x16x32_bf16 a[108:111], v[92:95], a[80:83], a[108:111]
  buffer_load_dwordx4 v[80:83], v2, s[8:11], s20 offen offset:0
  v_mfma_f32_16x16x32_bf16 a[112:115], v[92:95], a[84:87], a[112:115]
  ds_read_b128 a[64:67], v7 offset:51200
  v_mfma_f32_16x16x32_bf16 a[116:119], v[92:95], a[88:91], a[116:119]
  buffer_load_dwordx4 v[84:87], v2, s[8:11], s20 offen offset:1024
  v_mfma_f32_16x16x32_bf16 a[120:123], v[96:99], a[76:79], a[120:123]
  ds_read_b128 a[68:71], v7 offset:53248
  v_mfma_f32_16x16x32_bf16 a[124:127], v[96:99], a[80:83], a[124:127]
  buffer_load_dwordx4 v[88:91], v2, s[8:11], s20 offen offset:2048
  v_mfma_f32_16x16x32_bf16 a[128:131], v[96:99], a[84:87], a[128:131]
  ds_read_b128 a[72:75], v7 offset:55296
  v_mfma_f32_16x16x32_bf16 a[132:135], v[96:99], a[88:91], a[132:135]
  s_add_u32 s20, s20, 3072
  v_mfma_f32_16x16x32_bf16 a[136:139], v[100:103], a[76:79], a[136:139]
  v_mfma_f32_16x16x32_bf16 a[140:143], v[100:103], a[80:83], a[140:143]
  v_mfma_f32_16x16x32_bf16 a[144:147], v[100:103], a[84:87], a[144:147]
  v_mfma_f32_16x16x32_bf16 a[148:151], v[100:103], a[88:91], a[148:151]
  s_waitcnt vmcnt(30) lgkmcnt(0)
  v_mfma_f32_16x16x32_bf16 a[152:155], v[104:107], a[60:63], a[152:155]
  ds_read_b128 a[76:79], v8 offset:49152
  v_accvgpr_read_b32 v54, a104
  v_accvgpr_read_b32 v55, a105
  v_mfma_f32_16x16x32_bf16 a[156:159], v[104:107], a[64:67], a[156:159]
  buffer_load_dwordx4 v[92:95], v2, s[8:11], s20 offen offset:0
  v_accvgpr_read_b32 v56, a106
  v_mfma_f32_16x16x32_bf16 a[160:163], v[104:107], a[68:71], a[160:163]
  ds_read_b128 a[80:83], v8 offset:51200
  v_accvgpr_read_b32 v57, a107
  v_mfma_f32_16x16x32_bf16 a[164:167], v[104:107], a[72:75], a[164:167]
  buffer_load_dwordx4 v[96:99], v2, s[8:11], s20 offen offset:1024
  v_accvgpr_read_b32 v58, a108
  v_mfma_f32_16x16x32_bf16 a[168:171], v[108:111], a[60:63], a[168:171]
  ds_read_b128 a[84:87], v8 offset:53248
  v_accvgpr_read_b32 v59, a109
  v_accvgpr_read_b32 v60, a110
  v_mfma_f32_16x16x32_bf16 a[172:175], v[108:111], a[64:67], a[172:175]
  buffer_load_dwordx4 v[100:103], v2, s[8:11], s20 offen offset:2048
  v_accvgpr_read_b32 v61, a111
  v_mfma_f32_16x16x32_bf16 a[176:179], v[108:111], a[68:71], a[176:179]
  ds_read_b128 a[88:91], v8 offset:55296
  v_cvt_pk_bf16_f32 v72, v54, v55
  v_mfma_f32_16x16x32_bf16 a[180:183], v[108:111], a[72:75], a[180:183]
  s_add_u32 s20, s20, 3072
  v_cvt_pk_bf16_f32 v73, v56, v57
  v_cvt_pk_bf16_f32 v74, v58, v59
  v_mfma_f32_16x16x32_bf16 a[184:187], v[112:115], a[60:63], a[184:187]
  v_cvt_pk_bf16_f32 v75, v60, v61
  buffer_store_dwordx4 v[72:75], v2, s[8:11], s22 offen sc1
  v_mfma_f32_16x16x32_bf16 a[188:191], v[112:115], a[64:67], a[188:191]
  s_add_u32 s22, s22, 1024
  v_accvgpr_read_b32 v54, a112
  v_accvgpr_read_b32 v55, a113
  v_mfma_f32_16x16x32_bf16 a[192:195], v[112:115], a[68:71], a[192:195]
  v_accvgpr_read_b32 v56, a114
  v_accvgpr_read_b32 v57, a115
  v_mfma_f32_16x16x32_bf16 a[196:199], v[112:115], a[72:75], a[196:199]
  v_accvgpr_read_b32 v58, a116
  v_accvgpr_read_b32 v59, a117
  v_accvgpr_read_b32 v60, a118
  s_waitcnt vmcnt(31) lgkmcnt(0)
  v_mfma_f32_16x16x32_bf16 a[152:155], v[116:119], a[76:79], a[152:155]
  ds_read_b128 a[60:63], v7 offset:57344
  v_accvgpr_read_b32 v61, a119
  v_mfma_f32_16x16x32_bf16 a[156:159], v[116:119], a[80:83], a[156:159]
  v_cvt_pk_bf16_f32 v76, v54, v55
  v_cvt_pk_bf16_f32 v77, v56, v57
  v_cvt_pk_bf16_f32 v78, v58, v59
  v_mfma_f32_16x16x32_bf16 a[160:163], v[116:119], a[84:87], a[160:163]
  ds_read_b128 a[64:67], v7 offset:59392
  v_cvt_pk_bf16_f32 v79, v60, v61
  v_mfma_f32_16x16x32_bf16 a[164:167], v[116:119], a[88:91], a[164:167]
  buffer_store_dwordx4 v[76:79], v2, s[8:11], s22 offen sc1
  v_mfma_f32_16x16x32_bf16 a[168:171], v[120:123], a[76:79], a[168:171]
  ds_read_b128 a[68:71], v7 offset:61440
  s_add_u32 s22, s22, 1024
  v_mfma_f32_16x16x32_bf16 a[172:175], v[120:123], a[80:83], a[172:175]
  v_accvgpr_read_b32 v54, a120
  v_accvgpr_read_b32 v55, a121
  v_accvgpr_read_b32 v56, a122
  v_mfma_f32_16x16x32_bf16 a[176:179], v[120:123], a[84:87], a[176:179]
  ds_read_b128 a[72:75], v7 offset:63488
  v_accvgpr_read_b32 v57, a123
  v_mfma_f32_16x16x32_bf16 a[180:183], v[120:123], a[88:91], a[180:183]
  v_accvgpr_read_b32 v58, a124
  v_accvgpr_read_b32 v59, a125
  v_mfma_f32_16x16x32_bf16 a[184:187], v[124:127], a[76:79], a[184:187]
  v_accvgpr_read_b32 v60, a126
  v_accvgpr_read_b32 v61, a127
  v_mfma_f32_16x16x32_bf16 a[188:191], v[124:127], a[80:83], a[188:191]
  v_cvt_pk_bf16_f32 v72, v54, v55
  v_cvt_pk_bf16_f32 v73, v56, v57
  v_cvt_pk_bf16_f32 v74, v58, v59
  v_mfma_f32_16x16x32_bf16 a[192:195], v[124:127], a[84:87], a[192:195]
  v_cvt_pk_bf16_f32 v75, v60, v61
  v_mfma_f32_16x16x32_bf16 a[196:199], v[124:127], a[88:91], a[196:199]
  buffer_store_dwordx4 v[72:75], v2, s[8:11], s22 offen sc1
  s_add_u32 s22, s22, 1024
  s_waitcnt vmcnt(30) lgkmcnt(0)
  v_mfma_f32_16x16x32_bf16 a[152:155], a[0:3], a[60:63], a[152:155]
  ds_read_b128 a[76:79], v8 offset:57344
  v_accvgpr_read_b32 v54, a128
  v_mfma_f32_16x16x32_bf16 a[156:159], a[0:3], a[64:67], a[156:159]
  v_accvgpr_read_b32 v55, a129
  v_accvgpr_read_b32 v56, a130
  v_mfma_f32_16x16x32_bf16 a[160:163], a[0:3], a[68:71], a[160:163]
  ds_read_b128 a[80:83], v8 offset:59392
  v_accvgpr_read_b32 v57, a131
  v_accvgpr_read_b32 v58, a132
  v_mfma_f32_16x16x32_bf16 a[164:167], a[0:3], a[72:75], a[164:167]
  v_accvgpr_read_b32 v59, a133
  v_accvgpr_read_b32 v60, a134
  v_mfma_f32_16x16x32_bf16 a[168:171], a[4:7], a[60:63], a[168:171]
  ds_read_b128 a[84:87], v8 offset:61440
  v_accvgpr_read_b32 v61, a135
  v_mfma_f32_16x16x32_bf16 a[172:175], a[4:7], a[64:67], a[172:175]
  v_cvt_pk_bf16_f32 v76, v54, v55
  v_cvt_pk_bf16_f32 v77, v56, v57
  v_mfma_f32_16x16x32_bf16 a[176:179], a[4:7], a[68:71], a[176:179]
  ds_read_b128 a[88:91], v8 offset:63488
  v_cvt_pk_bf16_f32 v78, v58, v59
  v_mfma_f32_16x16x32_bf16 a[180:183], a[4:7], a[72:75], a[180:183]
  v_cvt_pk_bf16_f32 v79, v60, v61
  buffer_store_dwordx4 v[76:79], v2, s[8:11], s22 offen sc1
  v_mfma_f32_16x16x32_bf16 a[184:187], a[8:11], a[60:63], a[184:187]
  s_add_u32 s22, s22, 1024
  v_accvgpr_read_b32 v54, a136
  v_mfma_f32_16x16x32_bf16 a[188:191], a[8:11], a[64:67], a[188:191]
  v_accvgpr_read_b32 v55, a137
  v_accvgpr_read_b32 v56, a138
  v_mfma_f32_16x16x32_bf16 a[192:195], a[8:11], a[68:71], a[192:195]
  v_accvgpr_read_b32 v57, a139
  v_accvgpr_read_b32 v58, a140
  v_mfma_f32_16x16x32_bf16 a[196:199], a[8:11], a[72:75], a[196:199]
  v_accvgpr_read_b32 v59, a141
  v_accvgpr_read_b32 v60, a142
  s_waitcnt vmcnt(28) lgkmcnt(0)
  v_mfma_f32_16x16x32_bf16 a[152:155], a[12:15], a[76:79], a[152:155]
  ds_read_b128 a[60:63], v9 offset:0
  v_accvgpr_read_b32 v61, a143
  v_mfma_f32_16x16x32_bf16 a[156:159], a[12:15], a[80:83], a[156:159]
  v_cvt_pk_bf16_f32 v72, v54, v55
  v_cvt_pk_bf16_f32 v73, v56, v57
  v_cvt_pk_bf16_f32 v74, v58, v59
  v_mfma_f32_16x16x32_bf16 a[160:163], a[12:15], a[84:87], a[160:163]
  ds_read_b128 a[64:67], v9 offset:2048
  v_cvt_pk_bf16_f32 v75, v60, v61
  v_mfma_f32_16x16x32_bf16 a[164:167], a[12:15], a[88:91], a[164:167]
  buffer_store_dwordx4 v[72:75], v2, s[8:11], s22 offen sc1
  v_mfma_f32_16x16x32_bf16 a[168:171], a[16:19], a[76:79], a[168:171]
  ds_read_b128 a[68:71], v9 offset:4096
  s_add_u32 s22, s22, 1024
  v_mfma_f32_16x16x32_bf16 a[172:175], a[16:19], a[80:83], a[172:175]
  v_accvgpr_read_b32 v54, a144
  v_accvgpr_read_b32 v55, a145
  v_accvgpr_read_b32 v56, a146
  v_mfma_f32_16x16x32_bf16 a[176:179], a[16:19], a[84:87], a[176:179]
  ds_read_b128 a[72:75], v9 offset:6144
  v_accvgpr_read_b32 v57, a147
  v_mfma_f32_16x16x32_bf16 a[180:183], a[16:19], a[88:91], a[180:183]
  v_accvgpr_read_b32 v58, a148
  v_accvgpr_read_b32 v59, a149
  v_mfma_f32_16x16x32_bf16 a[184:187], a[20:23], a[76:79], a[184:187]
  v_accvgpr_read_b32 v60, a150
  v_accvgpr_read_b32 v61, a151
  v_mfma_f32_16x16x32_bf16 a[188:191], a[20:23], a[80:83], a[188:191]
  v_cvt_pk_bf16_f32 v76, v54, v55
  v_cvt_pk_bf16_f32 v77, v56, v57
  v_cvt_pk_bf16_f32 v78, v58, v59
  v_mfma_f32_16x16x32_bf16 a[192:195], a[20:23], a[84:87], a[192:195]
  v_cvt_pk_bf16_f32 v79, v60, v61
  v_mfma_f32_16x16x32_bf16 a[196:199], a[20:23], a[88:91], a[196:199]
  buffer_store_dwordx4 v[76:79], v2, s[8:11], s22 offen sc1
  s_add_u32 s22, s22, 1024
  s_waitcnt vmcnt(27) lgkmcnt(0)
  v_mfma_f32_16x16x32_bf16 a[152:155], v[128:131], a[60:63], a[152:155]
  ds_read_b128 a[76:79], v10 offset:0
  v_mfma_f32_16x16x32_bf16 a[156:159], v[128:131], a[64:67], a[156:159]
  v_mfma_f32_16x16x32_bf16 a[160:163], v[128:131], a[68:71], a[160:163]
  ds_read_b128 a[80:83], v10 offset:2048
  v_mfma_f32_16x16x32_bf16 a[164:167], v[128:131], a[72:75], a[164:167]
  v_mfma_f32_16x16x32_bf16 a[168:171], v[132:135], a[60:63], a[168:171]
  ds_read_b128 a[84:87], v10 offset:4096
  v_mfma_f32_16x16x32_bf16 a[172:175], v[132:135], a[64:67], a[172:175]
  v_mfma_f32_16x16x32_bf16 a[176:179], v[132:135], a[68:71], a[176:179]
  ds_read_b128 a[88:91], v10 offset:6144
  v_mfma_f32_16x16x32_bf16 a[180:183], v[132:135], a[72:75], a[180:183]
  v_mfma_f32_16x16x32_bf16 a[184:187], v[136:139], a[60:63], a[184:187]
  v_mfma_f32_16x16x32_bf16 a[188:191], v[136:139], a[64:67], a[188:191]
  v_mfma_f32_16x16x32_bf16 a[192:195], v[136:139], a[68:71], a[192:195]
  v_mfma_f32_16x16x32_bf16 a[196:199], v[136:139], a[72:75], a[196:199]
  s_waitcnt vmcnt(24) lgkmcnt(0)
  v_mfma_f32_16x16x32_bf16 a[152:155], a[24:27], a[76:79], a[152:155]
  ds_read_b128 a[60:63], v7 offset:49152
  v_mfma_f32_16x16x32_bf16 a[156:159], a[24:27], a[80:83], a[156:159]
  v_mfma_f32_16x16x32_bf16 a[160:163], a[24:27], a[84:87], a[160:163]
  ds_read_b128 a[64:67], v7 offset:51200
  v_mfma_f32_16x16x32_bf16 a[164:167], a[24:27], a[88:91], a[164:167]
  v_mfma_f32_16x16x32_bf16 a[168:171], a[28:31], a[76:79], a[168:171]
  ds_read_b128 a[68:71], v7 offset:53248
  v_mfma_f32_16x16x32_bf16 a[172:175], a[28:31], a[80:83], a[172:175]
  v_mfma_f32_16x16x32_bf16 a[176:179], a[28:31], a[84:87], a[176:179]
  ds_read_b128 a[72:75], v7 offset:55296
  v_mfma_f32_16x16x32_bf16 a[180:183], a[28:31], a[88:91], a[180:183]
  v_mfma_f32_16x16x32_bf16 a[184:187], a[32:35], a[76:79], a[184:187]
  v_mfma_f32_16x16x32_bf16 a[188:191], a[32:35], a[80:83], a[188:191]
  v_mfma_f32_16x16x32_bf16 a[192:195], a[32:35], a[84:87], a[192:195]
  v_mfma_f32_16x16x32_bf16 a[196:199], a[32:35], a[88:91], a[196:199]
  s_waitcnt vmcnt(21) lgkmcnt(0)
  v_mfma_f32_16x16x32_bf16 a[200:203], v[140:143], a[60:63], a[200:203]
  ds_read_b128 a[76:79], v8 offset:49152
  v_accvgpr_read_b32 v54, a152
  v_mfma_f32_16x16x32_bf16 a[204:207], v[140:143], a[64:67], a[204:207]
  v_accvgpr_read_b32 v55, a153
  v_accvgpr_read_b32 v56, a154
  v_mfma_f32_16x16x32_bf16 a[208:211], v[140:143], a[68:71], a[208:211]
  ds_read_b128 a[80:83], v8 offset:51200
  v_accvgpr_read_b32 v57, a155
  v_accvgpr_read_b32 v58, a156
  v_mfma_f32_16x16x32_bf16 a[212:215], v[140:143], a[72:75], a[212:215]
  v_accvgpr_read_b32 v59, a157
  v_accvgpr_read_b32 v60, a158
  v_mfma_f32_16x16x32_bf16 a[216:219], v[144:147], a[60:63], a[216:219]
  ds_read_b128 a[84:87], v8 offset:53248
  v_accvgpr_read_b32 v61, a159
  v_mfma_f32_16x16x32_bf16 a[220:223], v[144:147], a[64:67], a[220:223]
  v_cvt_pk_bf16_f32 v72, v54, v55
  v_cvt_pk_bf16_f32 v73, v56, v57
  v_mfma_f32_16x16x32_bf16 a[224:227], v[144:147], a[68:71], a[224:227]
  ds_read_b128 a[88:91], v8 offset:55296
  v_cvt_pk_bf16_f32 v74, v58, v59
  v_mfma_f32_16x16x32_bf16 a[228:231], v[144:147], a[72:75], a[228:231]
  v_cvt_pk_bf16_f32 v75, v60, v61
  buffer_store_dwordx4 v[72:75], v2, s[8:11], s22 offen sc1
  v_mfma_f32_16x16x32_bf16 a[232:235], v[148:151], a[60:63], a[232:235]
  s_add_u32 s22, s22, 1024
  v_accvgpr_read_b32 v54, a160
  v_mfma_f32_16x16x32_bf16 a[236:239], v[148:151], a[64:67], a[236:239]
  v_accvgpr_read_b32 v55, a161
  v_accvgpr_read_b32 v56, a162
  v_mfma_f32_16x16x32_bf16 a[240:243], v[148:151], a[68:71], a[240:243]
  v_accvgpr_read_b32 v57, a163
  v_accvgpr_read_b32 v58, a164
  v_mfma_f32_16x16x32_bf16 a[244:247], v[148:151], a[72:75], a[244:247]
  v_accvgpr_read_b32 v59, a165
  v_accvgpr_read_b32 v60, a166
  s_waitcnt vmcnt(19) lgkmcnt(0)
  v_mfma_f32_16x16x32_bf16 a[200:203], a[36:39], a[76:79], a[200:203]
  ds_read_b128 a[60:63], v7 offset:57344
  v_accvgpr_read_b32 v61, a167
  v_mfma_f32_16x16x32_bf16 a[204:207], a[36:39], a[80:83], a[204:207]
  v_cvt_pk_bf16_f32 v76, v54, v55
  v_cvt_pk_bf16_f32 v77, v56, v57
  v_cvt_pk_bf16_f32 v78, v58, v59
  v_mfma_f32_16x16x32_bf16 a[208:211], a[36:39], a[84:87], a[208:211]
  ds_read_b128 a[64:67], v7 offset:59392
  v_cvt_pk_bf16_f32 v79, v60, v61
  v_mfma_f32_16x16x32_bf16 a[212:215], a[36:39], a[88:91], a[212:215]
  buffer_store_dwordx4 v[76:79], v2, s[8:11], s22 offen sc1
  v_mfma_f32_16x16x32_bf16 a[216:219], a[40:43], a[76:79], a[216:219]
  ds_read_b128 a[68:71], v7 offset:61440
  s_add_u32 s22, s22, 1024
  v_mfma_f32_16x16x32_bf16 a[220:223], a[40:43], a[80:83], a[220:223]
  v_accvgpr_read_b32 v54, a168
  v_accvgpr_read_b32 v55, a169
  v_accvgpr_read_b32 v56, a170
  v_mfma_f32_16x16x32_bf16 a[224:227], a[40:43], a[84:87], a[224:227]
  ds_read_b128 a[72:75], v7 offset:63488
  v_accvgpr_read_b32 v57, a171
  v_mfma_f32_16x16x32_bf16 a[228:231], a[40:43], a[88:91], a[228:231]
  v_accvgpr_read_b32 v58, a172
  v_accvgpr_read_b32 v59, a173
  v_mfma_f32_16x16x32_bf16 a[232:235], a[44:47], a[76:79], a[232:235]
  v_accvgpr_read_b32 v60, a174
  v_accvgpr_read_b32 v61, a175
  v_mfma_f32_16x16x32_bf16 a[236:239], a[44:47], a[80:83], a[236:239]
  v_cvt_pk_bf16_f32 v72, v54, v55
  v_cvt_pk_bf16_f32 v73, v56, v57
  v_cvt_pk_bf16_f32 v74, v58, v59
  v_mfma_f32_16x16x32_bf16 a[240:243], a[44:47], a[84:87], a[240:243]
  v_cvt_pk_bf16_f32 v75, v60, v61
  v_mfma_f32_16x16x32_bf16 a[244:247], a[44:47], a[88:91], a[244:247]
  buffer_store_dwordx4 v[72:75], v2, s[8:11], s22 offen sc1
  s_add_u32 s22, s22, 1024
  s_waitcnt vmcnt(18) lgkmcnt(0)
  v_mfma_f32_16x16x32_bf16 a[200:203], v[152:155], a[60:63], a[200:203]
  ds_read_b128 a[76:79], v8 offset:57344
  v_accvgpr_read_b32 v54, a176
  v_mfma_f32_16x16x32_bf16 a[204:207], v[152:155], a[64:67], a[204:207]
  v_accvgpr_read_b32 v55, a177
  v_accvgpr_read_b32 v56, a178
  v_mfma_f32_16x16x32_bf16 a[208:211], v[152:155], a[68:71], a[208:211]
  ds_read_b128 a[80:83], v8 offset:59392
  v_accvgpr_read_b32 v57, a179
  v_accvgpr_read_b32 v58, a180
  v_mfma_f32_16x16x32_bf16 a[212:215], v[152:155], a[72:75], a[212:215]
  v_accvgpr_read_b32 v59, a181
  v_accvgpr_read_b32 v60, a182
  v_mfma_f32_16x16x32_bf16 a[216:219], v[156:159], a[60:63], a[216:219]
  ds_read_b128 a[84:87], v8 offset:61440
  v_accvgpr_read_b32 v61, a183
  v_mfma_f32_16x16x32_bf16 a[220:223], v[156:159], a[64:67], a[220:223]
  v_cvt_pk_bf16_f32 v76, v54, v55
  v_cvt_pk_bf16_f32 v77, v56, v57
  v_mfma_f32_16x16x32_bf16 a[224:227], v[156:159], a[68:71], a[224:227]
  ds_read_b128 a[88:91], v8 offset:63488
  v_cvt_pk_bf16_f32 v78, v58, v59
  v_mfma_f32_16x16x32_bf16 a[228:231], v[156:159], a[72:75], a[228:231]
  v_cvt_pk_bf16_f32 v79, v60, v61
  buffer_store_dwordx4 v[76:79], v2, s[8:11], s22 offen sc1
  v_mfma_f32_16x16x32_bf16 a[232:235], v[160:163], a[60:63], a[232:235]
  s_add_u32 s22, s22, 1024
  v_accvgpr_read_b32 v54, a184
  v_mfma_f32_16x16x32_bf16 a[236:239], v[160:163], a[64:67], a[236:239]
  v_accvgpr_read_b32 v55, a185
  v_accvgpr_read_b32 v56, a186
  v_mfma_f32_16x16x32_bf16 a[240:243], v[160:163], a[68:71], a[240:243]
  v_accvgpr_read_b32 v57, a187
  v_accvgpr_read_b32 v58, a188
  v_mfma_f32_16x16x32_bf16 a[244:247], v[160:163], a[72:75], a[244:247]
  v_accvgpr_read_b32 v59, a189
  v_accvgpr_read_b32 v60, a190
  s_waitcnt vmcnt(16) lgkmcnt(0)
  v_mfma_f32_16x16x32_bf16 a[200:203], a[48:51], a[76:79], a[200:203]
  ds_read_b128 a[60:63], v9 offset:0
  v_accvgpr_read_b32 v61, a191
  v_mfma_f32_16x16x32_bf16 a[204:207], a[48:51], a[80:83], a[204:207]
  v_cvt_pk_bf16_f32 v72, v54, v55
  v_cvt_pk_bf16_f32 v73, v56, v57
  v_cvt_pk_bf16_f32 v74, v58, v59
  v_mfma_f32_16x16x32_bf16 a[208:211], a[48:51], a[84:87], a[208:211]
  ds_read_b128 a[64:67], v9 offset:2048
  v_cvt_pk_bf16_f32 v75, v60, v61
  v_mfma_f32_16x16x32_bf16 a[212:215], a[48:51], a[88:91], a[212:215]
  buffer_store_dwordx4 v[72:75], v2, s[8:11], s22 offen sc1
  v_mfma_f32_16x16x32_bf16 a[216:219], a[52:55], a[76:79], a[216:219]
  ds_read_b128 a[68:71], v9 offset:4096
  s_add_u32 s22, s22, 1024
  v_mfma_f32_16x16x32_bf16 a[220:223], a[52:55], a[80:83], a[220:223]
  v_accvgpr_read_b32 v54, a192
  v_accvgpr_read_b32 v55, a193
  v_accvgpr_read_b32 v56, a194
  v_mfma_f32_16x16x32_bf16 a[224:227], a[52:55], a[84:87], a[224:227]
  ds_read_b128 a[72:75], v9 offset:6144
  v_accvgpr_read_b32 v57, a195
  v_mfma_f32_16x16x32_bf16 a[228:231], a[52:55], a[88:91], a[228:231]
  v_accvgpr_read_b32 v58, a196
  v_accvgpr_read_b32 v59, a197
  v_mfma_f32_16x16x32_bf16 a[232:235], a[56:59], a[76:79], a[232:235]
  v_accvgpr_read_b32 v60, a198
  v_accvgpr_read_b32 v61, a199
  v_mfma_f32_16x16x32_bf16 a[236:239], a[56:59], a[80:83], a[236:239]
  v_cvt_pk_bf16_f32 v76, v54, v55
  v_cvt_pk_bf16_f32 v77, v56, v57
  v_cvt_pk_bf16_f32 v78, v58, v59
  v_mfma_f32_16x16x32_bf16 a[240:243], a[56:59], a[84:87], a[240:243]
  v_cvt_pk_bf16_f32 v79, v60, v61
  v_mfma_f32_16x16x32_bf16 a[244:247], a[56:59], a[88:91], a[244:247]
  buffer_store_dwordx4 v[76:79], v2, s[8:11], s22 offen sc1
  s_add_u32 s22, s22, 1024
  s_waitcnt vmcnt(15) lgkmcnt(0)
  v_mfma_f32_16x16x32_bf16 a[200:203], v[80:83], a[60:63], a[200:203]
  ds_read_b128 a[76:79], v10 offset:0
  v_mfma_f32_16x16x32_bf16 a[204:207], v[80:83], a[64:67], a[204:207]
  v_mfma_f32_16x16x32_bf16 a[208:211], v[80:83], a[68:71], a[208:211]
  ds_read_b128 a[80:83], v10 offset:2048
  v_mfma_f32_16x16x32_bf16 a[212:215], v[80:83], a[72:75], a[212:215]
  v_mfma_f32_16x16x32_bf16 a[216:219], v[84:87], a[60:63], a[216:219]
  ds_read_b128 a[84:87], v10 offset:4096
  v_mfma_f32_16x16x32_bf16 a[220:223], v[84:87], a[64:67], a[220:223]
  v_mfma_f32_16x16x32_bf16 a[224:227], v[84:87], a[68:71], a[224:227]
  ds_read_b128 a[88:91], v10 offset:6144
  v_mfma_f32_16x16x32_bf16 a[228:231], v[84:87], a[72:75], a[228:231]
  v_mfma_f32_16x16x32_bf16 a[232:235], v[88:91], a[60:63], a[232:235]
  v_mfma_f32_16x16x32_bf16 a[236:239], v[88:91], a[64:67], a[236:239]
  v_mfma_f32_16x16x32_bf16 a[240:243], v[88:91], a[68:71], a[240:243]
  v_mfma_f32_16x16x32_bf16 a[244:247], v[88:91], a[72:75], a[244:247]
  s_waitcnt vmcnt(12) lgkmcnt(0)
  v_mfma_f32_16x16x32_bf16 a[200:203], v[92:95], a[76:79], a[200:203]
  v_mfma_f32_16x16x32_bf16 a[204:207], v[92:95], a[80:83], a[204:207]
  v_mfma_f32_16x16x32_bf16 a[208:211], v[92:95], a[84:87], a[208:211]
  v_mfma_f32_16x16x32_bf16 a[212:215], v[92:95], a[88:91], a[212:215]
  v_mfma_f32_16x16x32_bf16 a[216:219], v[96:99], a[76:79], a[216:219]
  v_mfma_f32_16x16x32_bf16 a[220:223], v[96:99], a[80:83], a[220:223]
  v_mfma_f32_16x16x32_bf16 a[224:227], v[96:99], a[84:87], a[224:227]
  v_mfma_f32_16x16x32_bf16 a[228:231], v[96:99], a[88:91], a[228:231]
  v_mfma_f32_16x16x32_bf16 a[232:235], v[100:103], a[76:79], a[232:235]
  v_mfma_f32_16x16x32_bf16 a[236:239], v[100:103], a[80:83], a[236:239]
  v_mfma_f32_16x16x32_bf16 a[240:243], v[100:103], a[84:87], a[240:243]
  v_mfma_f32_16x16x32_bf16 a[244:247], v[100:103], a[88:91], a[244:247]
  s_nop 7
  s_lshl_b32 s25, s17, 8
  s_add_u32 s25, s25, 0x6d0000
  s_cmp_eq_u32 s18, 0
  s_cbranch_scc1 k4_kernel_w0
  v_accvgpr_read_b32 v54, a200
  v_accvgpr_read_b32 v55, a201
  v_accvgpr_read_b32 v56, a202
  v_accvgpr_read_b32 v57, a203
  v_accvgpr_read_b32 v58, a204
  v_accvgpr_read_b32 v59, a205
  v_accvgpr_read_b32 v60, a206
  v_accvgpr_read_b32 v61, a207
  v_cvt_pk_bf16_f32 v72, v54, v55
  v_cvt_pk_bf16_f32 v73, v56, v57
  v_cvt_pk_bf16_f32 v74, v58, v59
  v_cvt_pk_bf16_f32 v75, v60, v61
  buffer_store_dwordx4 v[72:75], v2, s[8:11], s22 offen sc1
  s_add_u32 s22, s22, 1024
  v_accvgpr_read_b32 v54, a208
  v_accvgpr_read_b32 v55, a209
  v_accvgpr_read_b32 v56, a210
  v_accvgpr_read_b32 v57, a211
  v_accvgpr_read_b32 v58, a212
  v_accvgpr_read_b32 v59, a213
  v_accvgpr_read_b32 v60, a214
  v_accvgpr_read_b32 v61, a215
  v_cvt_pk_bf16_f32 v76, v54, v55
  v_cvt_pk_bf16_f32 v77, v56, v57
  v_cvt_pk_bf16_f32 v78, v58, v59
  v_cvt_pk_bf16_f32 v79, v60, v61
  buffer_store_dwordx4 v[76:79], v2, s[8:11], s22 offen sc1
  s_add_u32 s22, s22, 1024
  v_accvgpr_read_b32 v54, a216
  v_accvgpr_read_b32 v55, a217
  v_accvgpr_read_b32 v56, a218
  v_accvgpr_read_b32 v57, a219
  v_accvgpr_read_b32 v58, a220
  v_accvgpr_read_b32 v59, a221
  v_accvgpr_read_b32 v60, a222
  v_accvgpr_read_b32 v61, a223
  v_cvt_pk_bf16_f32 v72, v54, v55
  v_cvt_pk_bf16_f32 v73, v56, v57
  v_cvt_pk_bf16_f32 v74, v58, v59
  v_cvt_pk_bf16_f32 v75, v60, v61
  buffer_store_dwordx4 v[72:75], v2, s[8:11], s22 offen sc1
  s_add_u32 s22, s22, 1024
  v_accvgpr_read_b32 v54, a224
  v_accvgpr_read_b32 v55, a225
  v_accvgpr_read_b32 v56, a226
  v_accvgpr_read_b32 v57, a227
  v_accvgpr_read_b32 v58, a228
  v_accvgpr_read_b32 v59, a229
  v_accvgpr_read_b32 v60, a230
  v_accvgpr_read_b32 v61, a231
  v_cvt_pk_bf16_f32 v76, v54, v55
  v_cvt_pk_bf16_f32 v77, v56, v57
  v_cvt_pk_bf16_f32 v78, v58, v59
  v_cvt_pk_bf16_f32 v79, v60, v61
  buffer_store_dwordx4 v[76:79], v2, s[8:11], s22 offen sc1
  s_add_u32 s22, s22, 1024
  v_accvgpr_read_b32 v54, a232
  v_accvgpr_read_b32 v55, a233
  v_accvgpr_read_b32 v56, a234
  v_accvgpr_read_b32 v57, a235
  v_accvgpr_read_b32 v58, a236
  v_accvgpr_read_b32 v59, a237
  v_accvgpr_read_b32 v60, a238
  v_accvgpr_read_b32 v61, a239
  v_cvt_pk_bf16_f32 v72, v54, v55
  v_cvt_pk_bf16_f32 v73, v56, v57
  v_cvt_pk_bf16_f32 v74, v58, v59
  v_cvt_pk_bf16_f32 v75, v60, v61
  buffer_store_dwordx4 v[72:75], v2, s[8:11], s22 offen sc1
  s_add_u32 s22, s22, 1024
  v_accvgpr_read_b32 v54, a240
  v_accvgpr_read_b32 v55, a241
  v_accvgpr_read_b32 v56, a242
  v_accvgpr_read_b32 v57, a243
  v_accvgpr_read_b32 v58, a244
  v_accvgpr_read_b32 v59, a245
  v_accvgpr_read_b32 v60, a246
  v_accvgpr_read_b32 v61, a247
  v_cvt_pk_bf16_f32 v76, v54, v55
  v_cvt_pk_bf16_f32 v77, v56, v57
  v_cvt_pk_bf16_f32 v78, v58, v59
  v_cvt_pk_bf16_f32 v79, v60, v61
  buffer_store_dwordx4 v[76:79], v2, s[8:11], s22 offen sc1
  s_add_u32 s22, s22, 1024
  s_waitcnt vmcnt(6)
  s_barrier
  v_and_b32 v62, 15, v1
  v_lshrrev_b32 v63, 4, v1
  s_movk_i32 s27, 1152
  v_mul_lo_u32 v64, v62, s27
  v_lshl_add_u32 v64, v63, 3, v64
  v_lshlrev_b32 v65, 2, v62
  v_lshlrev_b32 v66, 3, v63
  v_mov_b32 v68, 0x00003f80
  v_mov_b32 v69, 0x3f800000
  v_and_b32 v70, 1, v63
  v_lshlrev_b32 v70, 3, v70
  v_lshl_add_u32 v70, v62, 7, v70
  v_lshrrev_b32 v71, 1, v63
  v_lshrrev_b32 v72, 1, v62
  s_mov_b32 s36, s32
  s_mov_b32 s37, s33
  s_mov_b32 s38, 1152
  s_mov_b32 s39, 0x20000
  s_mov_b32 s40, s34
  s_mov_b32 s41, s35
  s_mov_b32 s42, 2359296
  s_mov_b32 s43, 0x20000
  v_mov_b32 v60, 147712
  s_mul_i32 s65, s16, 3
  s_add_u32 s65, s65, s18
  s_sub_u32 s65, s65, 1
  s_waitcnt vmcnt(0)
  s_barrier
  ds_read_b32 v61, v60
  s_waitcnt lgkmcnt(0)
  v_readfirstlane_b32 s27, v61
  s_nop 3
  s_cmp_eq_u32 s27, 0
  s_cbranch_scc1 k4_kernel_done
  s_mov_b32 s64, 0
  s_mul_hi_u32 s28, s65, 0x2aaaaaab
  s_mul_i32 s29, s28, 6
  s_sub_u32 s31, s65, s29
  s_mul_i32 s29, s28, 18
  s_mul_i32 s30, s64, 6
  s_add_u32 s29, s29, s30
  s_add_u32 s27, s29, s31
  s_mul_i32 s28, s28, 144
  s_mul_i32 s30, s64, 48
  s_add_u32 s28, s28, s30
  s_lshr_b32 s30, s31, 1
  s_lshl_b32 s30, s30, 4
  s_add_u32 s28, s28, s30
  s_and_b32 s31, s31, 1
  s_lshl_b32 s31, s31, 5
  s_lshl_b32 s30, s17, 6
  s_add_u32 s31, s31, s30
  s_mul_i32 s30, s17, 72
  s_add_u32 s30, s30, s27
  s_lshl_b32 s30, s30, 10
  s_add_u32 s30, s30, 0x1360000
  buffer_load_dwordx4 v[80:83], v2, s[8:11], s30 offen sc1
  s_add_u32 s30, s30, 2359296
  buffer_load_dwordx4 v[84:87], v2, s[8:11], s30 offen sc1
  s_add_u32 s30, s30, 2359296
  buffer_load_dwordx4 v[88:91], v2, s[8:11], s30 offen sc1
  s_add_u32 s30, s30, 2359296
  buffer_load_dwordx4 v[92:95], v2, s[8:11], s30 offen sc1
  s_add_u32 s30, s30, 2359296
  buffer_load_dwordx4 v[96:99], v2, s[8:11], s30 offen sc1
  s_add_u32 s30, s30, 2359296
  buffer_load_dwordx4 v[100:103], v2, s[8:11], s30 offen sc1
  s_add_u32 s30, s30, 2359296
  buffer_load_dwordx4 v[104:107], v2, s[8:11], s30 offen sc1
  s_add_u32 s30, s30, 2359296
  buffer_load_dwordx4 v[108:111], v2, s[8:11], s30 offen sc1
  s_mul_i32 s30, s31, 1152
  s_lshl_b32 s29, s28, 1
  s_add_u32 s80, s30, s29
  s_add_u32 s81, s80, 18432
  s_bfe_u32 s30, s28, 0x30003
  v_add_u32 v73, s30, v71
  v_xor_b32 v73, v73, v72
  v_lshl_add_u32 v73, v73, 4, v70
  s_lshr_b32 s30, s28, 6
  s_lshl_b32 s30, s30, 13
  s_and_b32 s19, s31, 63
  s_lshl_b32 s19, s19, 7
  s_add_u32 s30, s30, s19
  v_add_u32 v73, s30, v73
  ds_read_b64 v[112:113], v73
  ds_read_b64 v[114:115], v73 offset:2048
  s_lshl_b32 s30, s31, 2
  s_add_u32 s30, s30, 0x6c0000
  buffer_load_dword v116, v65, s[8:11], s30 offen
  buffer_load_dword v117, v65, s[8:11], s30 offen offset:64
  buffer_load_dwordx2 v[118:119], v66, s[36:39], s29 offen
  s_mov_b32 s64, 1
  s_mul_hi_u32 s28, s65, 0x2aaaaaab
  s_mul_i32 s29, s28, 6
  s_sub_u32 s31, s65, s29
  s_mul_i32 s29, s28, 18
  s_mul_i32 s30, s64, 6
  s_add_u32 s29, s29, s30
  s_add_u32 s27, s29, s31
  s_mul_i32 s28, s28, 144
  s_mul_i32 s30, s64, 48
  s_add_u32 s28, s28, s30
  s_lshr_b32 s30, s31, 1
  s_lshl_b32 s30, s30, 4
  s_add_u32 s28, s28, s30
  s_and_b32 s31, s31, 1
  s_lshl_b32 s31, s31, 5
  s_lshl_b32 s30, s17, 6
  s_add_u32 s31, s31, s30
  s_mul_i32 s30, s17, 72
  s_add_u32 s30, s30, s27
  s_lshl_b32 s30, s30, 10
  s_add_u32 s30, s30, 0x1360000
  buffer_load_dwordx4 v[120:123], v2, s[8:11], s30 offen sc1
  s_add_u32 s30, s30, 2359296
  buffer_load_dwordx4 v[124:127], v2, s[8:11], s30 offen sc1
  s_add_u32 s30, s30, 2359296
  buffer_load_dwordx4 v[128:131], v2, s[8:11], s30 offen sc1
  s_add_u32 s30, s30, 2359296
  buffer_load_dwordx4 v[132:135], v2, s[8:11], s30 offen sc1
  s_add_u32 s30, s30, 2359296
  buffer_load_dwordx4 v[136:139], v2, s[8:11], s30 offen sc1
  s_add_u32 s30, s30, 2359296
  buffer_load_dwordx4 v[140:143], v2, s[8:11], s30 offen sc1
  s_add_u32 s30, s30, 2359296
  buffer_load_dwordx4 v[144:147], v2, s[8:11], s30 offen sc1
  s_add_u32 s30, s30, 2359296
  buffer_load_dwordx4 v[148:151], v2, s[8:11], s30 offen sc1
  s_mul_i32 s30, s31, 1152
  s_lshl_b32 s29, s28, 1
  s_add_u32 s84, s30, s29
  s_add_u32 s85, s84, 18432
  s_bfe_u32 s30, s28, 0x30003
  v_add_u32 v73, s30, v71
  v_xor_b32 v73, v73, v72
  v_lshl_add_u32 v73, v73, 4, v70
  s_lshr_b32 s30, s28, 6
  s_lshl_b32 s30, s30, 13
  s_and_b32 s19, s31, 63
  s_lshl_b32 s19, s19, 7
  s_add_u32 s30, s30, s19
  v_add_u32 v73, s30, v73
  ds_read_b64 v[152:153], v73
  ds_read_b64 v[154:155], v73 offset:2048
  s_lshl_b32 s30, s31, 2
  s_add_u32 s30, s30, 0x6c0000
  buffer_load_dword v156, v65, s[8:11], s30 offen
  buffer_load_dword v157, v65, s[8:11], s30 offen offset:64
  buffer_load_dwordx2 v[158:159], v66, s[36:39], s29 offen
  s_waitcnt vmcnt(11) lgkmcnt(0)
  v_lshlrev_b32 v216, 16, v118
  v_and_b32 v217, 0xffff0000, v118
  v_lshlrev_b32 v218, 16, v119
  v_and_b32 v219, 0xffff0000, v119
  v_dot2_f32_bf16 v208, v80, v68, v216
  v_dot2_f32_bf16 v209, v80, v69, v217
  v_dot2_f32_bf16 v210, v81, v68, v218
  v_dot2_f32_bf16 v211, v81, v69, v219
  v_dot2_f32_bf16 v212, v82, v68, v216
  v_dot2_f32_bf16 v213, v82, v69, v217
  v_dot2_f32_bf16 v214, v83, v68, v218
  v_dot2_f32_bf16 v215, v83, v69, v219
  v_dot2_f32_bf16 v208, v84, v68, v208
  v_dot2_f32_bf16 v209, v84, v69, v209
  v_dot2_f32_bf16 v210, v85, v68, v210
  v_dot2_f32_bf16 v211, v85, v69, v211
  v_dot2_f32_bf16 v212, v86, v68, v212
  v_dot2_f32_bf16 v213, v86, v69, v213
  v_dot2_f32_bf16 v214, v87, v68, v214
  v_dot2_f32_bf16 v215, v87, v69, v215
  v_dot2_f32_bf16 v208, v88, v68, v208
  v_dot2_f32_bf16 v209, v88, v69, v209
  v_dot2_f32_bf16 v210, v89, v68, v210
  v_dot2_f32_bf16 v211, v89, v69, v211
  v_dot2_f32_bf16 v212, v90, v68, v212
  v_dot2_f32_bf16 v213, v90, v69, v213
  v_dot2_f32_bf16 v214, v91, v68, v214
  v_dot2_f32_bf16 v215, v91, v69, v215
  v_dot2_f32_bf16 v208, v92, v68, v208
  v_dot2_f32_bf16 v209, v92, v69, v209
  v_dot2_f32_bf16 v210, v93, v68, v210
  v_dot2_f32_bf16 v211, v93, v69, v211
  v_dot2_f32_bf16 v212, v94, v68, v212
  v_dot2_f32_bf16 v213, v94, v69, v213
  v_dot2_f32_bf16 v214, v95, v68, v214
  v_dot2_f32_bf16 v215, v95, v69, v215
  v_dot2_f32_bf16 v208, v96, v68, v208
  v_dot2_f32_bf16 v209, v96, v69, v209
  v_dot2_f32_bf16 v210, v97, v68, v210
  v_dot2_f32_bf16 v211, v97, v69, v211
  v_dot2_f32_bf16 v212, v98, v68, v212
  v_dot2_f32_bf16 v213, v98, v69, v213
  v_dot2_f32_bf16 v214, v99, v68, v214
  v_dot2_f32_bf16 v215, v99, v69, v215
  v_dot2_f32_bf16 v208, v100, v68, v208
  v_dot2_f32_bf16 v209, v100, v69, v209
  v_dot2_f32_bf16 v210, v101, v68, v210
  v_dot2_f32_bf16 v211, v101, v69, v211
  v_dot2_f32_bf16 v212, v102, v68, v212
  v_dot2_f32_bf16 v213, v102, v69, v213
  v_dot2_f32_bf16 v214, v103, v68, v214
  v_dot2_f32_bf16 v215, v103, v69, v215
  v_dot2_f32_bf16 v208, v104, v68, v208
  v_dot2_f32_bf16 v209, v104, v69, v209
  v_dot2_f32_bf16 v210, v105, v68, v210
  v_dot2_f32_bf16 v211, v105, v69, v211
  v_dot2_f32_bf16 v212, v106, v68, v212
  v_dot2_f32_bf16 v213, v106, v69, v213
  v_dot2_f32_bf16 v214, v107, v68, v214
  v_dot2_f32_bf16 v215, v107, v69, v215
  v_dot2_f32_bf16 v208, v108, v68, v208
  v_dot2_f32_bf16 v209, v108, v69, v209
  v_dot2_f32_bf16 v210, v109, v68, v210
  v_dot2_f32_bf16 v211, v109, v69, v211
  v_dot2_f32_bf16 v212, v110, v68, v212
  v_dot2_f32_bf16 v213, v110, v69, v213
  v_dot2_f32_bf16 v214, v111, v68, v214
  v_dot2_f32_bf16 v215, v111, v69, v215
  v_dot2_f32_bf16 v208, v112, v68, v208
  v_dot2_f32_bf16 v209, v112, v69, v209
  v_dot2_f32_bf16 v210, v113, v68, v210
  v_dot2_f32_bf16 v211, v113, v69, v211
  v_dot2_f32_bf16 v212, v114, v68, v212
  v_dot2_f32_bf16 v213, v114, v69, v213
  v_dot2_f32_bf16 v214, v115, v68, v214
  v_dot2_f32_bf16 v215, v115, v69, v215
  v_add_f32 v208, v208, v116
  v_add_f32 v209, v209, v116
  v_add_f32 v210, v210, v116
  v_add_f32 v211, v211, v116
  v_add_f32 v212, v212, v117
  v_add_f32 v213, v213, v117
  v_add_f32 v214, v214, v117
  v_add_f32 v215, v215, v117
  v_cvt_pk_bf16_f32 v224, v208, v209
  v_cvt_pk_bf16_f32 v225, v210, v211
  v_cvt_pk_bf16_f32 v226, v212, v213
  v_cvt_pk_bf16_f32 v227, v214, v215
  buffer_store_dwordx2 v[224:225], v64, s[40:43], s80 offen
  buffer_store_dwordx2 v[226:227], v64, s[40:43], s81 offen
  s_waitcnt vmcnt(2)
  v_lshlrev_b32 v216, 16, v158
  v_and_b32 v217, 0xffff0000, v158
  v_lshlrev_b32 v218, 16, v159
  v_and_b32 v219, 0xffff0000, v159
  v_dot2_f32_bf16 v208, v120, v68, v216
  v_dot2_f32_bf16 v209, v120, v69, v217
  v_dot2_f32_bf16 v210, v121, v68, v218
  v_dot2_f32_bf16 v211, v121, v69, v219
  v_dot2_f32_bf16 v212, v122, v68, v216
  v_dot2_f32_bf16 v213, v122, v69, v217
  v_dot2_f32_bf16 v214, v123, v68, v218
  v_dot2_f32_bf16 v215, v123, v69, v219
  v_dot2_f32_bf16 v208, v124, v68, v208
  v_dot2_f32_bf16 v209, v124, v69, v209
  v_dot2_f32_bf16 v210, v125, v68, v210
  v_dot2_f32_bf16 v211, v125, v69, v211
  v_dot2_f32_bf16 v212, v126, v68, v212
  v_dot2_f32_bf16 v213, v126, v69, v213
  v_dot2_f32_bf16 v214, v127, v68, v214
  v_dot2_f32_bf16 v215, v127, v69, v215
  v_dot2_f32_bf16 v208, v128, v68, v208
  v_dot2_f32_bf16 v209, v128, v69, v209
  v_dot2_f32_bf16 v210, v129, v68, v210
  v_dot2_f32_bf16 v211, v129, v69, v211
  v_dot2_f32_bf16 v212, v130, v68, v212
  v_dot2_f32_bf16 v213, v130, v69, v213
  v_dot2_f32_bf16 v214, v131, v68, v214
  v_dot2_f32_bf16 v215, v131, v69, v215
  v_dot2_f32_bf16 v208, v132, v68, v208
  v_dot2_f32_bf16 v209, v132, v69, v209
  v_dot2_f32_bf16 v210, v133, v68, v210
  v_dot2_f32_bf16 v211, v133, v69, v211
  v_dot2_f32_bf16 v212, v134, v68, v212
  v_dot2_f32_bf16 v213, v134, v69, v213
  v_dot2_f32_bf16 v214, v135, v68, v214
  v_dot2_f32_bf16 v215, v135, v69, v215
  v_dot2_f32_bf16 v208, v136, v68, v208
  v_dot2_f32_bf16 v209, v136, v69, v209
  v_dot2_f32_bf16 v210, v137, v68, v210
  v_dot2_f32_bf16 v211, v137, v69, v211
  v_dot2_f32_bf16 v212, v138, v68, v212
  v_dot2_f32_bf16 v213, v138, v69, v213
  v_dot2_f32_bf16 v214, v139, v68, v214
  v_dot2_f32_bf16 v215, v139, v69, v215
  v_dot2_f32_bf16 v208, v140, v68, v208
  v_dot2_f32_bf16 v209, v140, v69, v209
  v_dot2_f32_bf16 v210, v141, v68, v210
  v_dot2_f32_bf16 v211, v141, v69, v211
  v_dot2_f32_bf16 v212, v142, v68, v212
  v_dot2_f32_bf16 v213, v142, v69, v213
  v_dot2_f32_bf16 v214, v143, v68, v214
  v_dot2_f32_bf16 v215, v143, v69, v215
  v_dot2_f32_bf16 v208, v144, v68, v208
  v_dot2_f32_bf16 v209, v144, v69, v209
  v_dot2_f32_bf16 v210, v145, v68, v210
  v_dot2_f32_bf16 v211, v145, v69, v211
  v_dot2_f32_bf16 v212, v146, v68, v212
  v_dot2_f32_bf16 v213, v146, v69, v213
  v_dot2_f32_bf16 v214, v147, v68, v214
  v_dot2_f32_bf16 v215, v147, v69, v215
  v_dot2_f32_bf16 v208, v148, v68, v208
  v_dot2_f32_bf16 v209, v148, v69, v209
  v_dot2_f32_bf16 v210, v149, v68, v210
  v_dot2_f32_bf16 v211, v149, v69, v211
  v_dot2_f32_bf16 v212, v150, v68, v212
  v_dot2_f32_bf16 v213, v150, v69, v213
  v_dot2_f32_bf16 v214, v151, v68, v214
  v_dot2_f32_bf16 v215, v151, v69, v215
  v_dot2_f32_bf16 v208, v152, v68, v208
  v_dot2_f32_bf16 v209, v152, v69, v209
  v_dot2_f32_bf16 v210, v153, v68, v210
  v_dot2_f32_bf16 v211, v153, v69, v211
  v_dot2_f32_bf16 v212, v154, v68, v212
  v_dot2_f32_bf16 v213, v154, v69, v213
  v_dot2_f32_bf16 v214, v155, v68, v214
  v_dot2_f32_bf16 v215, v155, v69, v215
  v_add_f32 v208, v208, v156
  v_add_f32 v209, v209, v156
  v_add_f32 v210, v210, v156
  v_add_f32 v211, v211, v156
  v_add_f32 v212, v212, v157
  v_add_f32 v213, v213, v157
  v_add_f32 v214, v214, v157
  v_add_f32 v215, v215, v157
  v_cvt_pk_bf16_f32 v224, v208, v209
  v_cvt_pk_bf16_f32 v225, v210, v211
  v_cvt_pk_bf16_f32 v226, v212, v213
  v_cvt_pk_bf16_f32 v227, v214, v215
  buffer_store_dwordx2 v[224:225], v64, s[40:43], s84 offen
  buffer_store_dwordx2 v[226:227], v64, s[40:43], s85 offen
  s_branch k4_kernel_done
k4_kernel_w0:
  v_accvgpr_read_b32 v54, a200
  v_accvgpr_read_b32 v55, a201
  v_accvgpr_read_b32 v56, a202
  v_accvgpr_read_b32 v57, a203
  v_accvgpr_read_b32 v58, a204
  v_accvgpr_read_b32 v59, a205
  v_accvgpr_read_b32 v60, a206
  v_accvgpr_read_b32 v61, a207
  v_cvt_pk_bf16_f32 v72, v54, v55
  v_cvt_pk_bf16_f32 v73, v56, v57
  v_cvt_pk_bf16_f32 v74, v58, v59
  v_cvt_pk_bf16_f32 v75, v60, v61
  buffer_store_dwordx4 v[72:75], v2, s[8:11], s22 offen sc1
  s_add_u32 s22, s22, 1024
  v_accvgpr_read_b32 v54, a208
  v_accvgpr_read_b32 v55, a209
  v_accvgpr_read_b32 v56, a210
  v_accvgpr_read_b32 v57, a211
  v_accvgpr_read_b32 v58, a212
  v_accvgpr_read_b32 v59, a213
  v_accvgpr_read_b32 v60, a214
  v_accvgpr_read_b32 v61, a215
  v_cvt_pk_bf16_f32 v76, v54, v55
  v_cvt_pk_bf16_f32 v77, v56, v57
  v_cvt_pk_bf16_f32 v78, v58, v59
  v_cvt_pk_bf16_f32 v79, v60, v61
  buffer_store_dwordx4 v[76:79], v2, s[8:11], s22 offen sc1
  s_add_u32 s22, s22, 1024
  v_accvgpr_read_b32 v54, a216
  v_accvgpr_read_b32 v55, a217
  v_accvgpr_read_b32 v56, a218
  v_accvgpr_read_b32 v57, a219
  v_accvgpr_read_b32 v58, a220
  v_accvgpr_read_b32 v59, a221
  v_accvgpr_read_b32 v60, a222
  v_accvgpr_read_b32 v61, a223
  v_cvt_pk_bf16_f32 v72, v54, v55
  v_cvt_pk_bf16_f32 v73, v56, v57
  v_cvt_pk_bf16_f32 v74, v58, v59
  v_cvt_pk_bf16_f32 v75, v60, v61
  buffer_store_dwordx4 v[72:75], v2, s[8:11], s22 offen sc1
  s_add_u32 s22, s22, 1024
  v_accvgpr_read_b32 v54, a224
  v_accvgpr_read_b32 v55, a225
  v_accvgpr_read_b32 v56, a226
  v_accvgpr_read_b32 v57, a227
  v_accvgpr_read_b32 v58, a228
  v_accvgpr_read_b32 v59, a229
  v_accvgpr_read_b32 v60, a230
  v_accvgpr_read_b32 v61, a231
  v_cvt_pk_bf16_f32 v76, v54, v55
  v_cvt_pk_bf16_f32 v77, v56, v57
  v_cvt_pk_bf16_f32 v78, v58, v59
  v_cvt_pk_bf16_f32 v79, v60, v61
  buffer_store_dwordx4 v[76:79], v2, s[8:11], s22 offen sc1
  s_add_u32 s22, s22, 1024
  v_accvgpr_read_b32 v54, a232
  v_accvgpr_read_b32 v55, a233
  v_accvgpr_read_b32 v56, a234
  v_accvgpr_read_b32 v57, a235
  v_accvgpr_read_b32 v58, a236
  v_accvgpr_read_b32 v59, a237
  v_accvgpr_read_b32 v60, a238
  v_accvgpr_read_b32 v61, a239
  v_cvt_pk_bf16_f32 v72, v54, v55
  v_cvt_pk_bf16_f32 v73, v56, v57
  v_cvt_pk_bf16_f32 v74, v58, v59
  v_cvt_pk_bf16_f32 v75, v60, v61
  buffer_store_dwordx4 v[72:75], v2, s[8:11], s22 offen sc1
  s_add_u32 s22, s22, 1024
  v_accvgpr_read_b32 v54, a240
  v_accvgpr_read_b32 v55, a241
  v_accvgpr_read_b32 v56, a242
  v_accvgpr_read_b32 v57, a243
  v_accvgpr_read_b32 v58, a244
  v_accvgpr_read_b32 v59, a245
  v_accvgpr_read_b32 v60, a246
  v_accvgpr_read_b32 v61, a247
  v_cvt_pk_bf16_f32 v76, v54, v55
  v_cvt_pk_bf16_f32 v77, v56, v57
  v_cvt_pk_bf16_f32 v78, v58, v59
  v_cvt_pk_bf16_f32 v79, v60, v61
  buffer_store_dwordx4 v[76:79], v2, s[8:11], s22 offen sc1
  s_add_u32 s22, s22, 1024
  s_waitcnt vmcnt(6)
  s_barrier
  s_mov_b64 exec, 1
  v_mov_b32 v240, 1
  s_lshl_b32 s27, s16, 2
  v_mov_b32 v241, s27
  s_add_u32 s28, s25, 64
  buffer_store_dword v240, v241, s[8:11], s28 offen sc1
  s_mov_b64 exec, 0xff
  v_lshlrev_b32 v242, 2, v1
  buffer_load_dword v243, v242, s[8:11], s28 offen sc1
  s_mov_b64 exec, -1
  v_and_b32 v62, 15, v1
  v_lshrrev_b32 v63, 4, v1
  s_movk_i32 s27, 1152
  v_mul_lo_u32 v64, v62, s27
  v_lshl_add_u32 v64, v63, 3, v64
  v_lshlrev_b32 v65, 2, v62
  v_lshlrev_b32 v66, 3, v63
  v_mov_b32 v68, 0x00003f80
  v_mov_b32 v69, 0x3f800000
  v_and_b32 v70, 1, v63
  v_lshlrev_b32 v70, 3, v70
  v_lshl_add_u32 v70, v62, 7, v70
  v_lshrrev_b32 v71, 1, v63
  v_lshrrev_b32 v72, 1, v62
  s_mov_b32 s36, s32
  s_mov_b32 s37, s33
  s_mov_b32 s38, 1152
  s_mov_b32 s39, 0x20000
  s_mov_b32 s40, s34
  s_mov_b32 s41, s35
  s_mov_b32 s42, 2359296
  s_mov_b32 s43, 0x20000
  s_mov_b64 exec, 0xff
  s_waitcnt vmcnt(7)
  buffer_load_dword v243, v242, s[8:11], s28 offen sc1
  s_mov_b32 s29, 64
  s_mov_b32 s66, 0
k4_kernel_pa:
  s_waitcnt vmcnt(0)
  v_cmp_eq_u32 vcc, 1, v243
  s_nop 3
  s_cmp_eq_u32 vcc_lo, 0xff
  s_cbranch_scc1 k4_kernel_paok
  s_sub_u32 s29, s29, 1
  s_cmp_eq_u32 s29, 0
  s_cbranch_scc1 k4_kernel_papub
  buffer_load_dword v243, v242, s[8:11], s28 offen sc1
  s_branch k4_kernel_pa
k4_kernel_paok:
  s_mov_b32 s66, 1
k4_kernel_papub:
  s_mov_b64 exec, 1
  v_mov_b32 v243, s66
  v_mov_b32 v242, 147712
  ds_write_b32 v242, v243
  s_waitcnt lgkmcnt(0)
  s_barrier
  s_lshl_b32 s26, 1, s16
  s_mov_b64 exec, 1
  v_mov_b32 v240, 0
  v_mov_b32 v241, 1
  buffer_atomic_add v241, v240, s[8:11], s25 offen sc0
  s_waitcnt vmcnt(0)
  v_readfirstlane_b32 s27, v241
  s_nop 3
  s_and_b32 s28, s27, 0xff
  s_cmp_eq_u32 s28, 7
  s_cbranch_scc0 k4_kernel_spin0
  s_lshr_b32 s27, s27, 8
  s_and_b32 s27, s27, 0xff
  s_or_b32 s26, s26, s27
  s_branch k4_kernel_pub
k4_kernel_spin0:
  s_mov_b32 s29, 4000
k4_kernel_spin:
  buffer_load_dword v241, v240, s[8:11], s25 offen sc1
  s_waitcnt vmcnt(0)
  v_readfirstlane_b32 s27, v241
  s_nop 3
  s_and_b32 s28, s27, 0xff
  s_cmp_eq_u32 s28, 8
  s_cbranch_scc1 k4_kernel_pub
  s_sub_u32 s29, s29, 1
  s_cmp_lg_u32 s29, 0
  s_cbranch_scc1 k4_kernel_spin
  s_lshl_b32 s27, s26, 8
  v_mov_b32 v241, s27
  buffer_atomic_or v241, v240, s[8:11], s25 offen sc0
  s_waitcnt vmcnt(0)
  v_readfirstlane_b32 s27, v241
  s_nop 3
  s_and_b32 s28, s27, 0xff
  s_cmp_eq_u32 s28, 8
  s_cselect_b32 s26, s26, 0
k4_kernel_pub:
  s_mov_b64 exec, -1
  s_mov_b32 s68, s26
k4_kernel_loop:
  s_cmp_eq_u32 s68, 0
  s_cbranch_scc1 k4_kernel_done
  s_ff1_i32_b32 s67, s68
  s_bitset0_b32 s68, s67
  s_mov_b32 s64, 2
k4_kernel_grp:
  s_mul_i32 s65, s67, 3
  s_add_u32 s65, s65, 0
  s_mul_hi_u32 s28, s65, 0x2aaaaaab
  s_mul_i32 s29, s28, 6
  s_sub_u32 s31, s65, s29
  s_mul_i32 s29, s28, 18
  s_mul_i32 s30, s64, 6
  s_add_u32 s29, s29, s30
  s_add_u32 s27, s29, s31
  s_mul_i32 s28, s28, 144
  s_mul_i32 s30, s64, 48
  s_add_u32 s28, s28, s30
  s_lshr_b32 s30, s31, 1
  s_lshl_b32 s30, s30, 4
  s_add_u32 s28, s28, s30
  s_and_b32 s31, s31, 1
  s_lshl_b32 s31, s31, 5
  s_lshl_b32 s30, s17, 6
  s_add_u32 s31, s31, s30
  s_mul_i32 s30, s17, 72
  s_add_u32 s30, s30, s27
  s_lshl_b32 s30, s30, 10
  s_add_u32 s30, s30, 0x1360000
  buffer_load_dwordx4 v[80:83], v2, s[8:11], s30 offen sc1
  s_add_u32 s30, s30, 2359296
  buffer_load_dwordx4 v[84:87], v2, s[8:11], s30 offen sc1
  s_add_u32 s30, s30, 2359296
  buffer_load_dwordx4 v[88:91], v2, s[8:11], s30 offen sc1
  s_add_u32 s30, s30, 2359296
  buffer_load_dwordx4 v[92:95], v2, s[8:11], s30 offen sc1
  s_add_u32 s30, s30, 2359296
  buffer_load_dwordx4 v[96:99], v2, s[8:11], s30 offen sc1
  s_add_u32 s30, s30, 2359296
  buffer_load_dwordx4 v[100:103], v2, s[8:11], s30 offen sc1
  s_add_u32 s30, s30, 2359296
  buffer_load_dwordx4 v[104:107], v2, s[8:11], s30 offen sc1
  s_add_u32 s30, s30, 2359296
  buffer_load_dwordx4 v[108:111], v2, s[8:11], s30 offen sc1
  s_mul_i32 s30, s31, 1152
  s_lshl_b32 s29, s28, 1
  s_add_u32 s80, s30, s29
  s_add_u32 s81, s80, 18432
  s_bfe_u32 s30, s28, 0x30003
  v_add_u32 v73, s30, v71
  v_xor_b32 v73, v73, v72
  v_lshl_add_u32 v73, v73, 4, v70
  s_lshr_b32 s30, s28, 6
  s_lshl_b32 s30, s30, 13
  s_and_b32 s19, s31, 63
  s_lshl_b32 s19, s19, 7
  s_add_u32 s30, s30, s19
  v_add_u32 v73, s30, v73
  ds_read_b64 v[112:113], v73
  ds_read_b64 v[114:115], v73 offset:2048
  s_lshl_b32 s30, s31, 2
  s_add_u32 s30, s30, 0x6c0000
  buffer_load_dword v116, v65, s[8:11], s30 offen
  buffer_load_dword v117, v65, s[8:11], s30 offen offset:64
  buffer_load_dwordx2 v[118:119], v66, s[36:39], s29 offen
  s_mul_i32 s65, s67, 3
  s_add_u32 s65, s65, 1
  s_mul_hi_u32 s28, s65, 0x2aaaaaab
  s_mul_i32 s29, s28, 6
  s_sub_u32 s31, s65, s29
  s_mul_i32 s29, s28, 18
  s_mul_i32 s30, s64, 6
  s_add_u32 s29, s29, s30
  s_add_u32 s27, s29, s31
  s_mul_i32 s28, s28, 144
  s_mul_i32 s30, s64, 48
  s_add_u32 s28, s28, s30
  s_lshr_b32 s30, s31, 1
  s_lshl_b32 s30, s30, 4
  s_add_u32 s28, s28, s30
  s_and_b32 s31, s31, 1
  s_lshl_b32 s31, s31, 5
  s_lshl_b32 s30, s17, 6
  s_add_u32 s31, s31, s30
  s_mul_i32 s30, s17, 72
  s_add_u32 s30, s30, s27
  s_lshl_b32 s30, s30, 10
  s_add_u32 s30, s30, 0x1360000
  buffer_load_dwordx4 v[120:123], v2, s[8:11], s30 offen sc1
  s_add_u32 s30, s30, 2359296
  buffer_load_dwordx4 v[124:127], v2, s[8:11], s30 offen sc1
  s_add_u32 s30, s30, 2359296
  buffer_load_dwordx4 v[128:131], v2, s[8:11], s30 offen sc1
  s_add_u32 s30, s30, 2359296
  buffer_load_dwordx4 v[132:135], v2, s[8:11], s30 offen sc1
  s_add_u32 s30, s30, 2359296
  buffer_load_dwordx4 v[136:139], v2, s[8:11], s30 offen sc1
  s_add_u32 s30, s30, 2359296
  buffer_load_dwordx4 v[140:143], v2, s[8:11], s30 offen sc1
  s_add_u32 s30, s30, 2359296
  buffer_load_dwordx4 v[144:147], v2, s[8:11], s30 offen sc1
  s_add_u32 s30, s30, 2359296
  buffer_load_dwordx4 v[148:151], v2, s[8:11], s30 offen sc1
  s_mul_i32 s30, s31, 1152
  s_lshl_b32 s29, s28, 1
  s_add_u32 s84, s30, s29
  s_add_u32 s85, s84, 18432
  s_bfe_u32 s30, s28, 0x30003
  v_add_u32 v73, s30, v71
  v_xor_b32 v73, v73, v72
  v_lshl_add_u32 v73, v73, 4, v70
  s_lshr_b32 s30, s28, 6
  s_lshl_b32 s30, s30, 13
  s_and_b32 s19, s31, 63
  s_lshl_b32 s19, s19, 7
  s_add_u32 s30, s30, s19
  v_add_u32 v73, s30, v73
  ds_read_b64 v[152:153], v73
  ds_read_b64 v[154:155], v73 offset:2048
  s_lshl_b32 s30, s31, 2
  s_add_u32 s30, s30, 0x6c0000
  buffer_load_dword v156, v65, s[8:11], s30 offen
  buffer_load_dword v157, v65, s[8:11], s30 offen offset:64
  buffer_load_dwordx2 v[158:159], v66, s[36:39], s29 offen
  s_mul_i32 s65, s67, 3
  s_add_u32 s65, s65, 2
  s_mul_hi_u32 s28, s65, 0x2aaaaaab
  s_mul_i32 s29, s28, 6
  s_sub_u32 s31, s65, s29
  s_mul_i32 s29, s28, 18
  s_mul_i32 s30, s64, 6
  s_add_u32 s29, s29, s30
  s_add_u32 s27, s29, s31
  s_mul_i32 s28, s28, 144
  s_mul_i32 s30, s64, 48
  s_add_u32 s28, s28, s30
  s_lshr_b32 s30, s31, 1
  s_lshl_b32 s30, s30, 4
  s_add_u32 s28, s28, s30
  s_and_b32 s31, s31, 1
  s_lshl_b32 s31, s31, 5
  s_lshl_b32 s30, s17, 6
  s_add_u32 s31, s31, s30
  s_mul_i32 s30, s17, 72
  s_add_u32 s30, s30, s27
  s_lshl_b32 s30, s30, 10
  s_add_u32 s30, s30, 0x1360000
  buffer_load_dwordx4 v[160:163], v2, s[8:11], s30 offen sc1
  s_add_u32 s30, s30, 2359296
  buffer_load_dwordx4 v[164:167], v2, s[8:11], s30 offen sc1
  s_add_u32 s30, s30, 2359296
  buffer_load_dwordx4 v[168:171], v2, s[8:11], s30 offen sc1
  s_add_u32 s30, s30, 2359296
  buffer_load_dwordx4 v[172:175], v2, s[8:11], s30 offen sc1
  s_add_u32 s30, s30, 2359296
  buffer_load_dwordx4 v[176:179], v2, s[8:11], s30 offen sc1
  s_add_u32 s30, s30, 2359296
  buffer_load_dwordx4 v[180:183], v2, s[8:11], s30 offen sc1
  s_add_u32 s30, s30, 2359296
  buffer_load_dwordx4 v[184:187], v2, s[8:11], s30 offen sc1
  s_add_u32 s30, s30, 2359296
  buffer_load_dwordx4 v[188:191], v2, s[8:11], s30 offen sc1
  s_mul_i32 s30, s31, 1152
  s_lshl_b32 s29, s28, 1
  s_add_u32 s88, s30, s29
  s_add_u32 s89, s88, 18432
  s_bfe_u32 s30, s28, 0x30003
  v_add_u32 v73, s30, v71
  v_xor_b32 v73, v73, v72
  v_lshl_add_u32 v73, v73, 4, v70
  s_lshr_b32 s30, s28, 6
  s_lshl_b32 s30, s30, 13
  s_and_b32 s19, s31, 63
  s_lshl_b32 s19, s19, 7
  s_add_u32 s30, s30, s19
  v_add_u32 v73, s30, v73
  ds_read_b64 v[192:193], v73
  ds_read_b64 v[194:195], v73 offset:2048
  s_lshl_b32 s30, s31, 2
  s_add_u32 s30, s30, 0x6c0000
  buffer_load_dword v196, v65, s[8:11], s30 offen
  buffer_load_dword v197, v65, s[8:11], s30 offen offset:64
  buffer_load_dwordx2 v[198:199], v66, s[36:39], s29 offen
  s_waitcnt vmcnt(22) lgkmcnt(0)
  v_lshlrev_b32 v216, 16, v118
  v_and_b32 v217, 0xffff0000, v118
  v_lshlrev_b32 v218, 16, v119
  v_and_b32 v219, 0xffff0000, v119
  v_dot2_f32_bf16 v208, v80, v68, v216
  v_dot2_f32_bf16 v209, v80, v69, v217
  v_dot2_f32_bf16 v210, v81, v68, v218
  v_dot2_f32_bf16 v211, v81, v69, v219
  v_dot2_f32_bf16 v212, v82, v68, v216
  v_dot2_f32_bf16 v213, v82, v69, v217
  v_dot2_f32_bf16 v214, v83, v68, v218
  v_dot2_f32_bf16 v215, v83, v69, v219
  v_dot2_f32_bf16 v208, v84, v68, v208
  v_dot2_f32_bf16 v209, v84, v69, v209
  v_dot2_f32_bf16 v210, v85, v68, v210
  v_dot2_f32_bf16 v211, v85, v69, v211
  v_dot2_f32_bf16 v212, v86, v68, v212
  v_dot2_f32_bf16 v213, v86, v69, v213
  v_dot2_f32_bf16 v214, v87, v68, v214
  v_dot2_f32_bf16 v215, v87, v69, v215
  v_dot2_f32_bf16 v208, v88, v68, v208
  v_dot2_f32_bf16 v209, v88, v69, v209
  v_dot2_f32_bf16 v210, v89, v68, v210
  v_dot2_f32_bf16 v211, v89, v69, v211
  v_dot2_f32_bf16 v212, v90, v68, v212
  v_dot2_f32_bf16 v213, v90, v69, v213
  v_dot2_f32_bf16 v214, v91, v68, v214
  v_dot2_f32_bf16 v215, v91, v69, v215
  v_dot2_f32_bf16 v208, v92, v68, v208
  v_dot2_f32_bf16 v209, v92, v69, v209
  v_dot2_f32_bf16 v210, v93, v68, v210
  v_dot2_f32_bf16 v211, v93, v69, v211
  v_dot2_f32_bf16 v212, v94, v68, v212
  v_dot2_f32_bf16 v213, v94, v69, v213
  v_dot2_f32_bf16 v214, v95, v68, v214
  v_dot2_f32_bf16 v215, v95, v69, v215
  v_dot2_f32_bf16 v208, v96, v68, v208
  v_dot2_f32_bf16 v209, v96, v69, v209
  v_dot2_f32_bf16 v210, v97, v68, v210
  v_dot2_f32_bf16 v211, v97, v69, v211
  v_dot2_f32_bf16 v212, v98, v68, v212
  v_dot2_f32_bf16 v213, v98, v69, v213
  v_dot2_f32_bf16 v214, v99, v68, v214
  v_dot2_f32_bf16 v215, v99, v69, v215
  v_dot2_f32_bf16 v208, v100, v68, v208
  v_dot2_f32_bf16 v209, v100, v69, v209
  v_dot2_f32_bf16 v210, v101, v68, v210
  v_dot2_f32_bf16 v211, v101, v69, v211
  v_dot2_f32_bf16 v212, v102, v68, v212
  v_dot2_f32_bf16 v213, v102, v69, v213
  v_dot2_f32_bf16 v214, v103, v68, v214
  v_dot2_f32_bf16 v215, v103, v69, v215
  v_dot2_f32_bf16 v208, v104, v68, v208
  v_dot2_f32_bf16 v209, v104, v69, v209
  v_dot2_f32_bf16 v210, v105, v68, v210
  v_dot2_f32_bf16 v211, v105, v69, v211
  v_dot2_f32_bf16 v212, v106, v68, v212
  v_dot2_f32_bf16 v213, v106, v69, v213
  v_dot2_f32_bf16 v214, v107, v68, v214
  v_dot2_f32_bf16 v215, v107, v69, v215
  v_dot2_f32_bf16 v208, v108, v68, v208
  v_dot2_f32_bf16 v209, v108, v69, v209
  v_dot2_f32_bf16 v210, v109, v68, v210
  v_dot2_f32_bf16 v211, v109, v69, v211
  v_dot2_f32_bf16 v212, v110, v68, v212
  v_dot2_f32_bf16 v213, v110, v69, v213
  v_dot2_f32_bf16 v214, v111, v68, v214
  v_dot2_f32_bf16 v215, v111, v69, v215
  v_dot2_f32_bf16 v208, v112, v68, v208
  v_dot2_f32_bf16 v209, v112, v69, v209
  v_dot2_f32_bf16 v210, v113, v68, v210
  v_dot2_f32_bf16 v211, v113, v69, v211
  v_dot2_f32_bf16 v212, v114, v68, v212
  v_dot2_f32_bf16 v213, v114, v69, v213
  v_dot2_f32_bf16 v214, v115, v68, v214
  v_dot2_f32_bf16 v215, v115, v69, v215
  v_add_f32 v208, v208, v116
  v_add_f32 v209, v209, v116
  v_add_f32 v210, v210, v116
  v_add_f32 v211, v211, v116
  v_add_f32 v212, v212, v117
  v_add_f32 v213, v213, v117
  v_add_f32 v214, v214, v117
  v_add_f32 v215, v215, v117
  v_cvt_pk_bf16_f32 v224, v208, v209
  v_cvt_pk_bf16_f32 v225, v210, v211
  v_cvt_pk_bf16_f32 v226, v212, v213
  v_cvt_pk_bf16_f32 v227, v214, v215
  buffer_store_dwordx2 v[224:225], v64, s[40:43], s80 offen
  buffer_store_dwordx2 v[226:227], v64, s[40:43], s81 offen
  s_waitcnt vmcnt(13)
  v_lshlrev_b32 v216, 16, v158
  v_and_b32 v217, 0xffff0000, v158
  v_lshlrev_b32 v218, 16, v159
  v_and_b32 v219, 0xffff0000, v159
  v_dot2_f32_bf16 v208, v120, v68, v216
  v_dot2_f32_bf16 v209, v120, v69, v217
  v_dot2_f32_bf16 v210, v121, v68, v218
  v_dot2_f32_bf16 v211, v121, v69, v219
  v_dot2_f32_bf16 v212, v122, v68, v216
  v_dot2_f32_bf16 v213, v122, v69, v217
  v_dot2_f32_bf16 v214, v123, v68, v218
  v_dot2_f32_bf16 v215, v123, v69, v219
  v_dot2_f32_bf16 v208, v124, v68, v208
  v_dot2_f32_bf16 v209, v124, v69, v209
  v_dot2_f32_bf16 v210, v125, v68, v210
  v_dot2_f32_bf16 v211, v125, v69, v211
  v_dot2_f32_bf16 v212, v126, v68, v212
  v_dot2_f32_bf16 v213, v126, v69, v213
  v_dot2_f32_bf16 v214, v127, v68, v214
  v_dot2_f32_bf16 v215, v127, v69, v215
  v_dot2_f32_bf16 v208, v128, v68, v208
  v_dot2_f32_bf16 v209, v128, v69, v209
  v_dot2_f32_bf16 v210, v129, v68, v210
  v_dot2_f32_bf16 v211, v129, v69, v211
  v_dot2_f32_bf16 v212, v130, v68, v212
  v_dot2_f32_bf16 v213, v130, v69, v213
  v_dot2_f32_bf16 v214, v131, v68, v214
  v_dot2_f32_bf16 v215, v131, v69, v215
  v_dot2_f32_bf16 v208, v132, v68, v208
  v_dot2_f32_bf16 v209, v132, v69, v209
  v_dot2_f32_bf16 v210, v133, v68, v210
  v_dot2_f32_bf16 v211, v133, v69, v211
  v_dot2_f32_bf16 v212, v134, v68, v212
  v_dot2_f32_bf16 v213, v134, v69, v213
  v_dot2_f32_bf16 v214, v135, v68, v214
  v_dot2_f32_bf16 v215, v135, v69, v215
  v_dot2_f32_bf16 v208, v136, v68, v208
  v_dot2_f32_bf16 v209, v136, v69, v209
  v_dot2_f32_bf16 v210, v137, v68, v210
  v_dot2_f32_bf16 v211, v137, v69, v211
  v_dot2_f32_bf16 v212, v138, v68, v212
  v_dot2_f32_bf16 v213, v138, v69, v213
  v_dot2_f32_bf16 v214, v139, v68, v214
  v_dot2_f32_bf16 v215, v139, v69, v215
  v_dot2_f32_bf16 v208, v140, v68, v208
  v_dot2_f32_bf16 v209, v140, v69, v209
  v_dot2_f32_bf16 v210, v141, v68, v210
  v_dot2_f32_bf16 v211, v141, v69, v211
  v_dot2_f32_bf16 v212, v142, v68, v212
  v_dot2_f32_bf16 v213, v142, v69, v213
  v_dot2_f32_bf16 v214, v143, v68, v214
  v_dot2_f32_bf16 v215, v143, v69, v215
  v_dot2_f32_bf16 v208, v144, v68, v208
  v_dot2_f32_bf16 v209, v144, v69, v209
  v_dot2_f32_bf16 v210, v145, v68, v210
  v_dot2_f32_bf16 v211, v145, v69, v211
  v_dot2_f32_bf16 v212, v146, v68, v212
  v_dot2_f32_bf16 v213, v146, v69, v213
  v_dot2_f32_bf16 v214, v147, v68, v214
  v_dot2_f32_bf16 v215, v147, v69, v215
  v_dot2_f32_bf16 v208, v148, v68, v208
  v_dot2_f32_bf16 v209, v148, v69, v209
  v_dot2_f32_bf16 v210, v149, v68, v210
  v_dot2_f32_bf16 v211, v149, v69, v211
  v_dot2_f32_bf16 v212, v150, v68, v212
  v_dot2_f32_bf16 v213, v150, v69, v213
  v_dot2_f32_bf16 v214, v151, v68, v214
  v_dot2_f32_bf16 v215, v151, v69, v215
  v_dot2_f32_bf16 v208, v152, v68, v208
  v_dot2_f32_bf16 v209, v152, v69, v209
  v_dot2_f32_bf16 v210, v153, v68, v210
  v_dot2_f32_bf16 v211, v153, v69, v211
  v_dot2_f32_bf16 v212, v154, v68, v212
  v_dot2_f32_bf16 v213, v154, v69, v213
  v_dot2_f32_bf16 v214, v155, v68, v214
  v_dot2_f32_bf16 v215, v155, v69, v215
  v_add_f32 v208, v208, v156
  v_add_f32 v209, v209, v156
  v_add_f32 v210, v210, v156
  v_add_f32 v211, v211, v156
  v_add_f32 v212, v212, v157
  v_add_f32 v213, v213, v157
  v_add_f32 v214, v214, v157
  v_add_f32 v215, v215, v157
  v_cvt_pk_bf16_f32 v224, v208, v209
  v_cvt_pk_bf16_f32 v225, v210, v211
  v_cvt_pk_bf16_f32 v226, v212, v213
  v_cvt_pk_bf16_f32 v227, v214, v215
  buffer_store_dwordx2 v[224:225], v64, s[40:43], s84 offen
  buffer_store_dwordx2 v[226:227], v64, s[40:43], s85 offen
  s_waitcnt vmcnt(4)
  v_lshlrev_b32 v216, 16, v198
  v_and_b32 v217, 0xffff0000, v198
  v_lshlrev_b32 v218, 16, v199
  v_and_b32 v219, 0xffff0000, v199
  v_dot2_f32_bf16 v208, v160, v68, v216
  v_dot2_f32_bf16 v209, v160, v69, v217
  v_dot2_f32_bf16 v210, v161, v68, v218
  v_dot2_f32_bf16 v211, v161, v69, v219
  v_dot2_f32_bf16 v212, v162, v68, v216
  v_dot2_f32_bf16 v213, v162, v69, v217
  v_dot2_f32_bf16 v214, v163, v68, v218
  v_dot2_f32_bf16 v215, v163, v69, v219
  v_dot2_f32_bf16 v208, v164, v68, v208
  v_dot2_f32_bf16 v209, v164, v69, v209
  v_dot2_f32_bf16 v210, v165, v68, v210
  v_dot2_f32_bf16 v211, v165, v69, v211
  v_dot2_f32_bf16 v212, v166, v68, v212
  v_dot2_f32_bf16 v213, v166, v69, v213
  v_dot2_f32_bf16 v214, v167, v68, v214
  v_dot2_f32_bf16 v215, v167, v69, v215
  v_dot2_f32_bf16 v208, v168, v68, v208
  v_dot2_f32_bf16 v209, v168, v69, v209
  v_dot2_f32_bf16 v210, v169, v68, v210
  v_dot2_f32_bf16 v211, v169, v69, v211
  v_dot2_f32_bf16 v212, v170, v68, v212
  v_dot2_f32_bf16 v213, v170, v69, v213
  v_dot2_f32_bf16 v214, v171, v68, v214
  v_dot2_f32_bf16 v215, v171, v69, v215
  v_dot2_f32_bf16 v208, v172, v68, v208
  v_dot2_f32_bf16 v209, v172, v69, v209
  v_dot2_f32_bf16 v210, v173, v68, v210
  v_dot2_f32_bf16 v211, v173, v69, v211
  v_dot2_f32_bf16 v212, v174, v68, v212
  v_dot2_f32_bf16 v213, v174, v69, v213
  v_dot2_f32_bf16 v214, v175, v68, v214
  v_dot2_f32_bf16 v215, v175, v69, v215
  v_dot2_f32_bf16 v208, v176, v68, v208
  v_dot2_f32_bf16 v209, v176, v69, v209
  v_dot2_f32_bf16 v210, v177, v68, v210
  v_dot2_f32_bf16 v211, v177, v69, v211
  v_dot2_f32_bf16 v212, v178, v68, v212
  v_dot2_f32_bf16 v213, v178, v69, v213
  v_dot2_f32_bf16 v214, v179, v68, v214
  v_dot2_f32_bf16 v215, v179, v69, v215
  v_dot2_f32_bf16 v208, v180, v68, v208
  v_dot2_f32_bf16 v209, v180, v69, v209
  v_dot2_f32_bf16 v210, v181, v68, v210
  v_dot2_f32_bf16 v211, v181, v69, v211
  v_dot2_f32_bf16 v212, v182, v68, v212
  v_dot2_f32_bf16 v213, v182, v69, v213
  v_dot2_f32_bf16 v214, v183, v68, v214
  v_dot2_f32_bf16 v215, v183, v69, v215
  v_dot2_f32_bf16 v208, v184, v68, v208
  v_dot2_f32_bf16 v209, v184, v69, v209
  v_dot2_f32_bf16 v210, v185, v68, v210
  v_dot2_f32_bf16 v211, v185, v69, v211
  v_dot2_f32_bf16 v212, v186, v68, v212
  v_dot2_f32_bf16 v213, v186, v69, v213
  v_dot2_f32_bf16 v214, v187, v68, v214
  v_dot2_f32_bf16 v215, v187, v69, v215
  v_dot2_f32_bf16 v208, v188, v68, v208
  v_dot2_f32_bf16 v209, v188, v69, v209
  v_dot2_f32_bf16 v210, v189, v68, v210
  v_dot2_f32_bf16 v211, v189, v69, v211
  v_dot2_f32_bf16 v212, v190, v68, v212
  v_dot2_f32_bf16 v213, v190, v69, v213
  v_dot2_f32_bf16 v214, v191, v68, v214
  v_dot2_f32_bf16 v215, v191, v69, v215
  v_dot2_f32_bf16 v208, v192, v68, v208
  v_dot2_f32_bf16 v209, v192, v69, v209
  v_dot2_f32_bf16 v210, v193, v68, v210
  v_dot2_f32_bf16 v211, v193, v69, v211
  v_dot2_f32_bf16 v212, v194, v68, v212
  v_dot2_f32_bf16 v213, v194, v69, v213
  v_dot2_f32_bf16 v214, v195, v68, v214
  v_dot2_f32_bf16 v215, v195, v69, v215
  v_add_f32 v208, v208, v196
  v_add_f32 v209, v209, v196
  v_add_f32 v210, v210, v196
  v_add_f32 v211, v211, v196
  v_add_f32 v212, v212, v197
  v_add_f32 v213, v213, v197
  v_add_f32 v214, v214, v197
  v_add_f32 v215, v215, v197
  v_cvt_pk_bf16_f32 v224, v208, v209
  v_cvt_pk_bf16_f32 v225, v210, v211
  v_cvt_pk_bf16_f32 v226, v212, v213
  v_cvt_pk_bf16_f32 v227, v214, v215
  buffer_store_dwordx2 v[224:225], v64, s[40:43], s88 offen
  buffer_store_dwordx2 v[226:227], v64, s[40:43], s89 offen
  s_cmp_eq_u32 s64, 1
  s_cbranch_scc1 k4_kernel_loop
  s_cmp_eq_u32 s64, 0
  s_cselect_b32 s27, 1, 0
  s_cmp_eq_u32 s64, 2
  s_cbranch_scc0 k4_kernel_nx
  s_cmp_eq_u32 s67, s16
  s_cbranch_scc0 k4_kernel_nx
  s_cmp_eq_u32 s66, 1
  s_cbranch_scc1 k4_kernel_loop
k4_kernel_nx:
  s_mov_b32 s64, s27
  s_branch k4_kernel_grp
k4_kernel_done:
k4_kernel_end:
  s_endpgm
text_end:
  s_endpgm
.section .rodata,"a"
.p2align 6
.amdhsa_kernel k1_kernel
  .amdhsa_next_free_vgpr 216
  .amdhsa_next_free_sgpr 64
  .amdhsa_accum_offset 216
  .amdhsa_group_segment_fixed_size 0
  .amdhsa_kernarg_size 88
  .amdhsa_user_sgpr_count 2
  .amdhsa_user_sgpr_kernarg_segment_ptr 1
  .amdhsa_system_sgpr_workgroup_id_x 1
  .amdhsa_float_denorm_mode_32 3
.end_amdhsa_kernel
.p2align 6
.amdhsa_kernel k2_kernel
  .amdhsa_next_free_vgpr 168
  .amdhsa_next_free_sgpr 64
  .amdhsa_accum_offset 168
  .amdhsa_group_segment_fixed_size 0
  .amdhsa_kernarg_size 88
  .amdhsa_user_sgpr_count 2
  .amdhsa_user_sgpr_kernarg_segment_ptr 1
  .amdhsa_system_sgpr_workgroup_id_x 1
  .amdhsa_float_denorm_mode_32 3
.end_amdhsa_kernel
.p2align 6
.amdhsa_kernel k3_kernel
  .amdhsa_next_free_vgpr 200
  .amdhsa_next_free_sgpr 48
  .amdhsa_accum_offset 200
  .amdhsa_group_segment_fixed_size 0
  .amdhsa_kernarg_size 88
  .amdhsa_user_sgpr_count 2
  .amdhsa_user_sgpr_kernarg_segment_ptr 1
  .amdhsa_system_sgpr_workgroup_id_x 1
  .amdhsa_float_denorm_mode_32 3
.end_amdhsa_kernel
.p2align 6
.amdhsa_kernel k4_kernel
  .amdhsa_next_free_vgpr 504
  .amdhsa_next_free_sgpr 100
  .amdhsa_accum_offset 256
  .amdhsa_group_segment_fixed_size 0
  .amdhsa_kernarg_size 88
  .amdhsa_user_sgpr_count 2
  .amdhsa_user_sgpr_kernarg_segment_ptr 1
  .amdhsa_system_sgpr_workgroup_id_x 1
  .amdhsa_float_denorm_mode_32 3
.end_amdhsa_kernel
```
